```python
import torch

def _softmax(x, axis=-1):
    return torch.softmax(x, dim=axis)
def _gelu(x):
    return torch.nn.functional.gelu(x, approximate="tanh")
def _silu(x):
    return torch.nn.functional.silu(x)
def _sigmoid(x):
    return torch.sigmoid(x)
def _layernorm(x, axis=-1, eps=1e-5):
    m = x.mean(dim=axis, keepdim=True)
    v = x.var(dim=axis, keepdim=True, unbiased=False)
    return (x - m) / torch.sqrt(v + eps)
def _scatter_add(tgt, idx, src, axis=0):
    return tgt.clone().index_add_(axis, idx, src)
def _segment_sum(src, seg, n):
    out = torch.zeros((n,) + src.shape[1:], dtype=src.dtype)
    return out.index_add_(0, seg, src)
def _pad(x, pw):
    flat = tuple(v for pair in reversed(pw) for v in pair)
    return torch.nn.functional.pad(x, flat)

kernel_name = 'sequential_preLN__spectral_gfnet__dense_activation_squared_relu__prompt'

def setup_inputs():

    _w = (lambda a: (lambda t: t.to(torch.bfloat16) if t.is_floating_point() else t)(torch.as_tensor(a)))
    def _A_setup():
        B, S, D = 1, 2048, 512
        Df = D // 2 + 1
        return {
            "x": _w((lambda *s: torch.randn(*s, dtype=torch.bfloat16) * 0.05)(B, S, D)),
            "w_r": _w((lambda *s: torch.randn(*s, dtype=torch.bfloat16) * 0.4)(S, Df) * 0.02),
            "w_i": _w((lambda *s: torch.randn(*s, dtype=torch.bfloat16) * 0.4)(S, Df) * 0.02),
        }
    _A_in = _A_setup()

    def _B_setup():
        B, S, D, F = 1, 2048, 512, 1376
        return {
            "x": _w((lambda *s: torch.randn(*s, dtype=torch.bfloat16) * 0.05)(B, S, D)),
            "w1": _w((lambda *s: torch.randn(*s, dtype=torch.bfloat16) * 0.05)(D, F)),
            "b1": _w((lambda *s: torch.randn(*s, dtype=torch.bfloat16) * 0.2)(F)),
            "w2": _w((lambda *s: torch.randn(*s, dtype=torch.bfloat16) * 0.05)(F, D)),
            "b2": _w((lambda *s: torch.randn(*s, dtype=torch.bfloat16) * 0.8)(D)),
        }
    _B_in = _B_setup()

    return {
        "A_x": _A_in["x"],
        "A_w_r": _A_in["w_r"],
        "A_w_i": _A_in["w_i"],
        "B_x": _B_in["x"],
        "B_w1": _B_in["w1"],
        "B_b1": _B_in["b1"],
        "B_w2": _B_in["w2"],
        "B_b2": _B_in["b2"],
    }

def reference(A_x, A_w_r, A_w_i, B_x, B_w1, B_b1, B_w2, B_b2):
    def _A_ref(x, w_r, w_i):
        B, S, D = x.shape
        X = (lambda x, axes=(-2,-1): torch.fft.rfft2(x.float(), dim=axes))(x, axes=(-2, -1))
        W = w_r + 1j * w_i
        X = X * W
        y = (lambda x, s, axes=(-2,-1): torch.fft.irfft2(x, s=s, dim=axes).to(torch.bfloat16))(X, (S, D), axes=(-2, -1))
        return y

    def _B_ref(x, w1, b1, w2, b2):
        h = torch.einsum("bsd,df->bsf", x, w1) + b1
        zero = torch.zeros_like(h)
        r = torch.where(h > zero, h, zero)
        h = r * r
        out = torch.einsum("bsf,fd->bsd", h, w2) + b2
        return out

    x = A_x
    h = x + _A_ref(_layernorm(x, axis=-1), A_w_r, A_w_i)
    h2 = h + _B_ref(_layernorm(h, axis=-1), B_w1, B_b1, B_w2, B_b2)
    return h2
```

```asm
; @launch grid=(256,1,1) block=(256,1,1) lds=133120
.amdgcn_target "amdgcn-amd-amdhsa--gfx950"
.text
.globl sequential_preLN__spectral_gfnet__dense_activation_squared_relu__prompt_kernel
.p2align 8
.type sequential_preLN__spectral_gfnet__dense_activation_squared_relu__prompt_kernel,@function
sequential_preLN__spectral_gfnet__dense_activation_squared_relu__prompt_kernel:
    s_cmp_ge_u32 s2, 256
    s_cbranch_scc1 L_end
    s_load_dwordx2 s[8:9], s[0:1], 0
    s_load_dwordx2 s[12:13], s[0:1], 8
    s_load_dwordx2 s[16:17], s[0:1], 16
    s_load_dwordx2 s[20:21], s[0:1], 32
    s_load_dwordx2 s[28:29], s[0:1], 48
    s_load_dwordx2 s[44:45], s[0:1], 80
    s_load_dwordx2 s[40:41], s[0:1], 72
    s_load_dwordx2 s[24:25], s[0:1], 40
    s_load_dwordx2 s[32:33], s[0:1], 56
    s_load_dwordx2 s[36:37], s[0:1], 64
    v_and_b32 v1, 63, v0
    v_lshrrev_b32 v3, 6, v0
    v_lshlrev_b32 v2, 4, v1
    v_readfirstlane_b32 s3, v3
    s_mov_b32 s10, 2097152
    s_mov_b32 s11, 0x20000
    s_mov_b32 s14, 1052672
    s_mov_b32 s15, 0x20000
    s_mov_b32 s18, 1052672
    s_mov_b32 s19, 0x20000
    s_mov_b32 s22, 1409024
    s_mov_b32 s23, 0x20000
    s_mov_b32 s26, 2752
    s_mov_b32 s27, 0x20000
    s_mov_b32 s30, 1409024
    s_mov_b32 s31, 0x20000
    s_mov_b32 s34, 1024
    s_mov_b32 s35, 0x20000
    s_mov_b32 s38, 2097152
    s_mov_b32 s39, 0x20000
    s_mov_b32 s42, 256
    s_mov_b32 s43, 0x20000
    s_mov_b32 s46, 22020096
    s_mov_b32 s47, 0x20000
    s_mov_b32 s48, 0x10000
    s_and_b32 s4, s2, 7
    s_lshr_b32 s5, s2, 3
    s_lshr_b32 s6, s5, 2
    s_lshl_b32 s6, s6, 3
    s_add_u32 s6, s6, s4
    s_and_b32 s7, s5, 3
    s_and_b32 s51, s3, 1
    s_lshr_b32 s52, s3, 1
    s_lshl_b32 s53, s51, 7
    s_lshl_b32 s52, s52, 14
    s_lshl_b32 s51, s51, 12
    s_or_b32 s53, s53, s52
    s_or_b32 s53, s53, s51
    v_xor_b32 v24, s53, v2
    v_xor_b32 v25, 1040, v24
    v_xor_b32 v26, 2080, v24
    v_xor_b32 v27, 3120, v24
    v_xor_b32 v28, 8256, v24
    v_xor_b32 v29, 9296, v24
    v_xor_b32 v30, 10336, v24
    v_xor_b32 v31, 11376, v24
    s_lshl_b32 s54, s6, 15
    s_lshl_b32 s55, s3, 13
    s_lshl_b32 s56, s7, 13
    s_add_u32 s56, s56, s54
    s_lshl_b32 s57, s3, 11
    s_add_u32 s56, s56, s57
    s_mov_b32 m0, s55
    v_and_b32 v3, 31, v1
    v_lshrrev_b32 v6, 5, v1
    v_and_b32 v5, 19, v3
    v_and_b32 v4, 4, v3
    v_lshl_or_b32 v5, v4, 1, v5
    v_and_b32 v4, 8, v3
    v_lshrrev_b32 v4, 1, v4
    v_or_b32 v5, v5, v4
    s_lshl_b32 s50, s7, 7
    s_lshl_b32 s51, s3, 5
    s_add_u32 s50, s50, s51
    v_add_u32 v7, s50, v5
    v_add_u32 v14, 2, v7
    v_lshrrev_b32 v3, 4, v1
    v_mul_u32_u24 v3, 514, v3
    v_bfe_u32 v4, v1, 2, 2
    v_mul_u32_u24 v4, 32896, v4
    v_add_u32 v3, v3, v4
    v_and_b32 v4, 3, v1
    v_lshl_add_u32 v32, v4, 4, v3
    s_lshr_b32 s58, s5, 3
    s_lshl_b32 s59, s58, 2
    s_add_u32 s59, s59, s3
    s_mul_i32 s60, s59, 2056
    s_mul_i32 s61, s4, 131584
    s_add_u32 s60, s60, s61
    s_and_b32 s59, s5, 7
    s_lshl_b32 s61, s59, 6
    s_add_u32 s60, s60, s61
    s_add_u32 s60, s60, 2
    s_lshl_b32 s61, s3, 11
    s_add_u32 s61, s61, 65536
    s_lshr_b32 s51, s5, 3
    s_lshl_b32 s62, s51, 4
    s_lshl_b32 s51, s4, 1
    s_add_u32 s62, s62, s51
    s_bfe_u32 s51, s5, 0x10002
    s_add_u32 s62, s62, s51
    v_lshrrev_b32 v3, 1, v14
    v_and_b32 v4, 1, v14
    v_cmp_eq_u32 vcc, 0x1ff, v7
    v_lshrrev_b32 v15, 5, v1
    v_cvt_f32_u32 v15, v15
    v_cndmask_b32 v3, v3, 0, vcc
    v_cndmask_b32 v4, v4, 0, vcc
    v_cvt_f32_u32 v3, v3
    v_cvt_f32_u32 v4, v4
    v_mul_f32 v8, 0x3b000000, v3
    v_mul_f32 v4, 0x3e800000, v4
    v_mul_f32 v15, 0x41000000, v15
    v_fma_f32 v9, v8, v15, v4
    v_lshlrev_b32 v11, 30, v14
    v_and_b32 v11, 0x80000000, v11
    v_lshrrev_b32 v3, 1, v14
    v_and_b32 v3, v3, v14
    v_lshrrev_b32 v4, 2, v14
    v_xor_b32 v3, v3, v4
    v_bfe_i32 v3, v3, 0, 1
    v_and_b32 v10, 0x80008000, v3
    v_cmp_lt_u32 vcc, 0x1fd, v7
    v_mov_b32 v12, 0x3d800000
    v_mov_b32 v13, 0x3d3504f3
    v_cndmask_b32 v12, v12, v13, vcc
    v_xor_b32 v11, v11, v12
    v_cos_f32 v16, v9
    v_fmamk_f32 v17, v8, 0x3f800000, v9
    v_fmamk_f32 v18, v8, 0x40000000, v9
    v_fmamk_f32 v19, v8, 0x40400000, v9
    v_fmamk_f32 v20, v8, 0x40800000, v9
    v_fmamk_f32 v21, v8, 0x40a00000, v9
    v_fmamk_f32 v22, v8, 0x40c00000, v9
    v_fmamk_f32 v23, v8, 0x40e00000, v9
    v_cos_f32 v17, v17
    v_cos_f32 v18, v18
    v_cos_f32 v19, v19
    v_cos_f32 v20, v20
    v_cos_f32 v21, v21
    v_cos_f32 v22, v22
    v_cos_f32 v23, v23
    v_cvt_pk_bf16_f32 v128, v16, v17
    v_cvt_pk_bf16_f32 v129, v18, v19
    v_cvt_pk_bf16_f32 v130, v20, v21
    v_cvt_pk_bf16_f32 v131, v22, v23
    v_fmamk_f32 v16, v8, 0x41800000, v9
    v_fmamk_f32 v17, v8, 0x41880000, v9
    v_fmamk_f32 v18, v8, 0x41900000, v9
    v_fmamk_f32 v19, v8, 0x41980000, v9
    v_fmamk_f32 v20, v8, 0x41a00000, v9
    v_fmamk_f32 v21, v8, 0x41a80000, v9
    v_fmamk_f32 v22, v8, 0x41b00000, v9
    v_fmamk_f32 v23, v8, 0x41b80000, v9
    v_cos_f32 v16, v16
    v_cos_f32 v17, v17
    v_cos_f32 v18, v18
    v_cos_f32 v19, v19
    v_cos_f32 v20, v20
    v_cos_f32 v21, v21
    v_cos_f32 v22, v22
    v_cos_f32 v23, v23
    v_cvt_pk_bf16_f32 v132, v16, v17
    v_cvt_pk_bf16_f32 v133, v18, v19
    v_cvt_pk_bf16_f32 v134, v20, v21
    v_cvt_pk_bf16_f32 v135, v22, v23
    v_fmamk_f32 v16, v8, 0x42000000, v9
    v_fmamk_f32 v17, v8, 0x42040000, v9
    v_fmamk_f32 v18, v8, 0x42080000, v9
    v_fmamk_f32 v19, v8, 0x420c0000, v9
    v_fmamk_f32 v20, v8, 0x42100000, v9
    v_fmamk_f32 v21, v8, 0x42140000, v9
    v_fmamk_f32 v22, v8, 0x42180000, v9
    v_fmamk_f32 v23, v8, 0x421c0000, v9
    v_cos_f32 v16, v16
    v_cos_f32 v17, v17
    v_cos_f32 v18, v18
    v_cos_f32 v19, v19
    v_cos_f32 v20, v20
    v_cos_f32 v21, v21
    v_cos_f32 v22, v22
    v_cos_f32 v23, v23
    v_cvt_pk_bf16_f32 v136, v16, v17
    v_cvt_pk_bf16_f32 v137, v18, v19
    v_cvt_pk_bf16_f32 v138, v20, v21
    v_cvt_pk_bf16_f32 v139, v22, v23
    s_waitcnt lgkmcnt(0)
    s_or_b32 s49, s2, s3
    s_cmp_lg_u32 s49, 0
    s_cbranch_scc1 L_noinit
    v_lshlrev_b32 v3, 8, v1
    v_mov_b32 v4, 0
    buffer_store_dword v4, v3, s[44:47], 0 offen sc1
    s_movk_i32 s51, 0x4000
    buffer_store_dword v4, v3, s[44:47], s51 offen sc1
L_noinit:
    buffer_load_dwordx4 v24, s[8:11], s54 offen  lds
    s_add_u32 m0, m0, 1024
    s_nop 0
    buffer_load_dwordx4 v25, s[8:11], s54 offen  lds
    s_add_u32 m0, m0, 1024
    s_nop 0
    buffer_load_dwordx4 v26, s[8:11], s54 offen  lds
    s_add_u32 m0, m0, 1024
    s_nop 0
    buffer_load_dwordx4 v27, s[8:11], s54 offen  lds
    s_add_u32 m0, m0, 1024
    s_nop 0
    buffer_load_dwordx4 v28, s[8:11], s54 offen  lds
    s_add_u32 m0, m0, 1024
    s_nop 0
    buffer_load_dwordx4 v29, s[8:11], s54 offen  lds
    s_add_u32 m0, m0, 1024
    s_nop 0
    buffer_load_dwordx4 v30, s[8:11], s54 offen  lds
    s_add_u32 m0, m0, 1024
    s_nop 0
    buffer_load_dwordx4 v31, s[8:11], s54 offen  lds
    s_mov_b32 m0, s61
    s_nop 0
    buffer_load_dwordx4 v32, s[12:15], s60 offen  lds
    s_add_u32 m0, m0, 1024
    s_nop 0
    buffer_load_dwordx4 v32, s[16:19], s60 offen  lds
    v_fmamk_f32 v16, v8, 0x42400000, v9
    v_fmamk_f32 v17, v8, 0x42440000, v9
    v_fmamk_f32 v18, v8, 0x42480000, v9
    v_fmamk_f32 v19, v8, 0x424c0000, v9
    v_fmamk_f32 v20, v8, 0x42500000, v9
    v_fmamk_f32 v21, v8, 0x42540000, v9
    v_fmamk_f32 v22, v8, 0x42580000, v9
    v_fmamk_f32 v23, v8, 0x425c0000, v9
    v_cos_f32 v16, v16
    v_cos_f32 v17, v17
    v_cos_f32 v18, v18
    v_cos_f32 v19, v19
    v_cos_f32 v20, v20
    v_cos_f32 v21, v21
    v_cos_f32 v22, v22
    v_cos_f32 v23, v23
    v_cvt_pk_bf16_f32 v140, v16, v17
    v_cvt_pk_bf16_f32 v141, v18, v19
    v_cvt_pk_bf16_f32 v142, v20, v21
    v_cvt_pk_bf16_f32 v143, v22, v23
    v_fmamk_f32 v16, v8, 0x42800000, v9
    v_fmamk_f32 v17, v8, 0x42820000, v9
    v_fmamk_f32 v18, v8, 0x42840000, v9
    v_fmamk_f32 v19, v8, 0x42860000, v9
    v_fmamk_f32 v20, v8, 0x42880000, v9
    v_fmamk_f32 v21, v8, 0x428a0000, v9
    v_fmamk_f32 v22, v8, 0x428c0000, v9
    v_fmamk_f32 v23, v8, 0x428e0000, v9
    v_cos_f32 v16, v16
    v_cos_f32 v17, v17
    v_cos_f32 v18, v18
    v_cos_f32 v19, v19
    v_cos_f32 v20, v20
    v_cos_f32 v21, v21
    v_cos_f32 v22, v22
    v_cos_f32 v23, v23
    v_cvt_pk_bf16_f32 v144, v16, v17
    v_cvt_pk_bf16_f32 v145, v18, v19
    v_cvt_pk_bf16_f32 v146, v20, v21
    v_cvt_pk_bf16_f32 v147, v22, v23
    v_fmamk_f32 v16, v8, 0x42a00000, v9
    v_fmamk_f32 v17, v8, 0x42a20000, v9
    v_fmamk_f32 v18, v8, 0x42a40000, v9
    v_fmamk_f32 v19, v8, 0x42a60000, v9
    v_fmamk_f32 v20, v8, 0x42a80000, v9
    v_fmamk_f32 v21, v8, 0x42aa0000, v9
    v_fmamk_f32 v22, v8, 0x42ac0000, v9
    v_fmamk_f32 v23, v8, 0x42ae0000, v9
    v_cos_f32 v16, v16
    v_cos_f32 v17, v17
    v_cos_f32 v18, v18
    v_cos_f32 v19, v19
    v_cos_f32 v20, v20
    v_cos_f32 v21, v21
    v_cos_f32 v22, v22
    v_cos_f32 v23, v23
    v_cvt_pk_bf16_f32 v148, v16, v17
    v_cvt_pk_bf16_f32 v149, v18, v19
    v_cvt_pk_bf16_f32 v150, v20, v21
    v_cvt_pk_bf16_f32 v151, v22, v23
    v_fmamk_f32 v16, v8, 0x42c00000, v9
    v_fmamk_f32 v17, v8, 0x42c20000, v9
    v_fmamk_f32 v18, v8, 0x42c40000, v9
    v_fmamk_f32 v19, v8, 0x42c60000, v9
    v_fmamk_f32 v20, v8, 0x42c80000, v9
    v_fmamk_f32 v21, v8, 0x42ca0000, v9
    v_fmamk_f32 v22, v8, 0x42cc0000, v9
    v_fmamk_f32 v23, v8, 0x42ce0000, v9
    v_cos_f32 v16, v16
    v_cos_f32 v17, v17
    v_cos_f32 v18, v18
    v_cos_f32 v19, v19
    v_cos_f32 v20, v20
    v_cos_f32 v21, v21
    v_cos_f32 v22, v22
    v_cos_f32 v23, v23
    v_cvt_pk_bf16_f32 v152, v16, v17
    v_cvt_pk_bf16_f32 v153, v18, v19
    v_cvt_pk_bf16_f32 v154, v20, v21
    v_cvt_pk_bf16_f32 v155, v22, v23
    v_fmamk_f32 v16, v8, 0x42e00000, v9
    v_fmamk_f32 v17, v8, 0x42e20000, v9
    v_fmamk_f32 v18, v8, 0x42e40000, v9
    v_fmamk_f32 v19, v8, 0x42e60000, v9
    v_fmamk_f32 v20, v8, 0x42e80000, v9
    v_fmamk_f32 v21, v8, 0x42ea0000, v9
    v_fmamk_f32 v22, v8, 0x42ec0000, v9
    v_fmamk_f32 v23, v8, 0x42ee0000, v9
    v_cos_f32 v16, v16
    v_cos_f32 v17, v17
    v_cos_f32 v18, v18
    v_cos_f32 v19, v19
    v_cos_f32 v20, v20
    v_cos_f32 v21, v21
    v_cos_f32 v22, v22
    v_cos_f32 v23, v23
    v_cvt_pk_bf16_f32 v156, v16, v17
    v_cvt_pk_bf16_f32 v157, v18, v19
    v_cvt_pk_bf16_f32 v158, v20, v21
    v_cvt_pk_bf16_f32 v159, v22, v23
    v_and_b32 v3, 31, v1
    v_and_b32 v4, 15, v3
    v_xor_b32 v4, v4, v6
    v_lshlrev_b32 v4, 4, v4
    v_lshl_or_b32 v104, v3, 10, v4
    v_xor_b32 v105, 32, v104
    v_xor_b32 v106, 64, v104
    v_xor_b32 v107, 96, v104
    v_xor_b32 v108, 128, v104
    v_xor_b32 v109, 160, v104
    v_xor_b32 v110, 192, v104
    v_xor_b32 v111, 224, v104
    v_lshlrev_b32 v28, 5, v7
    v_lshl_add_u32 v28, v6, 4, v28
    s_lshl_b32 s67, s6, 15
    s_add_u32 s67, s67, 1048576
    s_add_u32 s68, s67, 16384
    s_lshl_b32 s64, s58, 11
    s_lshl_b32 s65, s4, 8
    s_add_u32 s64, s64, s65
    s_lshl_b32 s65, s3, 6
    s_add_u32 s64, s64, s65
    s_add_u32 s64, s64, 3145728
    s_add_u32 s65, s64, 131072
    s_lshl_b32 s69, s4, 8
    s_lshl_b32 s51, s7, 3
    s_lshl_b32 s52, s3, 1
    s_add_u32 s51, s51, s52
    s_and_b32 s52, s51, 19
    s_bfe_u32 s53, s51, 0x10002
    s_lshl_b32 s53, s53, 3
    s_or_b32 s52, s52, s53
    s_bfe_u32 s53, s51, 0x10003
    s_lshl_b32 s53, s53, 2
    s_or_b32 s52, s52, s53
    s_lshl_b32 s52, s52, 10
    v_add_u32 v34, s52, v2
    v_lshrrev_b32 v3, 2, v1
    v_lshlrev_b32 v3, 6, v3
    v_and_b32 v4, 3, v1
    v_lshl_add_u32 v3, v4, 3, v3
    v_add_u32 v35, s61, v3
    v_and_b32 v3, 15, v1
    v_lshl_add_u32 v3, s59, 5, v3
    v_lshlrev_b32 v33, 13, v3
    v_lshrrev_b32 v4, 4, v1
    v_lshl_add_u32 v33, v4, 4, v33
    s_cmp_ge_u32 s62, 44
    s_cbranch_scc1 L_dma_w2
    s_add_u32 m0, s55, 32768
    v_lshrrev_b32 v3, 2, v1
    v_mul_u32_u24 v3, 2752, v3
    v_and_b32 v4, 3, v1
    v_lshl_add_u32 v3, v4, 4, v3
    s_mul_i32 s51, s3, 352256
    s_lshl_b32 s52, s62, 6
    s_add_u32 s51, s51, s52
    buffer_load_dwordx4 v3, s[20:23], s51 offen  lds
    s_add_u32 m0, m0, 1024
    s_add_u32 s51, s51, 44032
    buffer_load_dwordx4 v3, s[20:23], s51 offen  lds
    s_add_u32 m0, m0, 1024
    s_add_u32 s51, s51, 44032
    buffer_load_dwordx4 v3, s[20:23], s51 offen  lds
    s_add_u32 m0, m0, 1024
    s_add_u32 s51, s51, 44032
    buffer_load_dwordx4 v3, s[20:23], s51 offen  lds
    s_add_u32 m0, m0, 1024
    s_add_u32 s51, s51, 44032
    buffer_load_dwordx4 v3, s[20:23], s51 offen  lds
    s_add_u32 m0, m0, 1024
    s_add_u32 s51, s51, 44032
    buffer_load_dwordx4 v3, s[20:23], s51 offen  lds
    s_add_u32 m0, m0, 1024
    s_add_u32 s51, s51, 44032
    buffer_load_dwordx4 v3, s[20:23], s51 offen  lds
    s_add_u32 m0, m0, 1024
    s_add_u32 s51, s51, 44032
    buffer_load_dwordx4 v3, s[20:23], s51 offen  lds
    s_waitcnt vmcnt(8)
    s_branch L_dma_done
L_dma_w2:
    s_add_u32 m0, s55, 32768
    s_sub_u32 s66, s62, 44
    s_lshl_b32 s66, s66, 2
    s_add_u32 s66, s66, s7
    s_lshl_b32 s66, s66, 2
    s_add_u32 s66, s66, s3
    v_lshrrev_b32 v3, 3, v1
    v_lshlrev_b32 v3, 10, v3
    v_and_b32 v4, 7, v1
    v_lshl_add_u32 v3, v4, 4, v3
    s_lshr_b32 s51, s66, 3
    s_lshl_b32 s51, s51, 14
    s_and_b32 s52, s66, 7
    s_lshl_b32 s52, s52, 7
    s_add_u32 s51, s51, s52
    buffer_load_dwordx4 v3, s[28:31], s51 offen  lds
    s_add_u32 m0, m0, 1024
    s_add_u32 s51, s51, 8192
    buffer_load_dwordx4 v3, s[28:31], s51 offen  lds
    s_add_u32 m0, m0, 1024
    s_add_u32 s51, s51, 647168
    buffer_load_dwordx4 v3, s[28:31], s51 offen  lds
    s_add_u32 m0, m0, 1024
    s_add_u32 s51, s51, 8192
    buffer_load_dwordx4 v3, s[28:31], s51 offen  lds
    s_add_u32 m0, m0, 1024
    s_add_u32 s51, s51, 647168
    buffer_load_dwordx4 v3, s[28:31], s51 offen  lds
    s_add_u32 m0, m0, 1024
    s_add_u32 s51, s51, 8192
    buffer_load_dwordx4 v3, s[28:31], s51 offen  lds
    s_waitcnt vmcnt(6)
L_dma_done:
    s_cmp_lg_u32 s49, 0
    s_cbranch_scc1 L_noflag
    v_mov_b32 v3, 1
    v_mov_b32 v4, 0
    s_mov_b64 exec, 1
    buffer_store_dword v3, v4, s[40:43], 0 offen sc1
    s_mov_b64 exec, -1
L_noflag:
    ds_read_b64_tr_b16 v[56:57], v35 offset:0
    ds_read_b64_tr_b16 v[58:59], v35 offset:1024
    ds_read_b64_tr_b16 v[60:61], v35 offset:32
    ds_read_b64_tr_b16 v[62:63], v35 offset:1056
    s_getpc_b64 s[52:53]
L_pc:
    s_lshl_b32 s51, s5, 10
    s_min_u32 s51, s51, L_end - L_pc - 1024
    v_add_u32 v3, s51, v2
    global_load_dwordx4 v[16:19], v3, s[52:53]
    s_barrier
    ds_read_b128 v[64:67], v34 offset:0
    ds_read_b128 v[68:71], v34 offset:1024
    ds_read_b128 a[0:3], v104 offset:0
    ds_read_b128 a[4:7], v105 offset:0
    ds_read_b128 a[8:11], v106 offset:0
    ds_read_b128 a[12:15], v107 offset:0
    ds_read_b128 a[16:19], v108 offset:0
    ds_read_b128 a[20:23], v109 offset:0
    ds_read_b128 a[24:27], v110 offset:0
    s_waitcnt lgkmcnt(9)
    buffer_store_dwordx4 v[56:59], v33, s[44:47], s64 offen sc1
    buffer_store_dwordx4 v[60:63], v33, s[44:47], s65 offen sc1
    s_waitcnt lgkmcnt(7)
    v_lshlrev_b32 v72, 16, v64
    v_and_b32 v73, 0xffff0000, v64
    v_lshlrev_b32 v74, 16, v65
    v_and_b32 v75, 0xffff0000, v65
    v_lshlrev_b32 v76, 16, v66
    v_and_b32 v77, 0xffff0000, v66
    v_lshlrev_b32 v78, 16, v67
    v_and_b32 v79, 0xffff0000, v67
    v_lshlrev_b32 v80, 16, v68
    v_and_b32 v81, 0xffff0000, v68
    v_lshlrev_b32 v82, 16, v69
    v_and_b32 v83, 0xffff0000, v69
    v_lshlrev_b32 v84, 16, v70
    v_and_b32 v85, 0xffff0000, v70
    v_lshlrev_b32 v86, 16, v71
    v_and_b32 v87, 0xffff0000, v71
    ds_read_b128 a[28:31], v111 offset:0
    s_waitcnt lgkmcnt(6)
    v_mfma_f32_32x32x16_bf16 v[112:127], a[0:3], v[128:131], 0
    v_xor_b32_dpp v160, v128, v10 quad_perm:[1,0,2,3] row_mask:0xf bank_mask:0xf
    v_xor_b32_dpp v161, v129, v10 quad_perm:[1,0,2,3] row_mask:0xf bank_mask:0xf
    ds_read_b128 a[0:3], v104 offset:512
    v_mfma_f32_32x32x16_bf16 v[112:127], a[4:7], v[132:135], v[112:127]
    v_xor_b32_dpp v162, v130, v10 quad_perm:[1,0,2,3] row_mask:0xf bank_mask:0xf
    v_xor_b32_dpp v163, v131, v10 quad_perm:[1,0,2,3] row_mask:0xf bank_mask:0xf
    ds_read_b128 a[4:7], v105 offset:512
    s_waitcnt lgkmcnt(6)
    v_mfma_f32_32x32x16_bf16 v[112:127], a[8:11], v[136:139], v[112:127]
    v_xor_b32_dpp v164, v132, v10 quad_perm:[1,0,2,3] row_mask:0xf bank_mask:0xf
    v_xor_b32_dpp v165, v133, v10 quad_perm:[1,0,2,3] row_mask:0xf bank_mask:0xf
    ds_read_b128 a[8:11], v106 offset:512
    v_mfma_f32_32x32x16_bf16 v[112:127], a[12:15], v[140:143], v[112:127]
    v_xor_b32_dpp v166, v134, v10 quad_perm:[1,0,2,3] row_mask:0xf bank_mask:0xf
    v_xor_b32_dpp v167, v135, v10 quad_perm:[1,0,2,3] row_mask:0xf bank_mask:0xf
    ds_read_b128 a[12:15], v107 offset:512
    s_waitcnt lgkmcnt(6)
    v_mfma_f32_32x32x16_bf16 v[112:127], a[16:19], v[144:147], v[112:127]
    v_xor_b32_dpp v168, v136, v10 quad_perm:[1,0,2,3] row_mask:0xf bank_mask:0xf
    v_xor_b32_dpp v169, v137, v10 quad_perm:[1,0,2,3] row_mask:0xf bank_mask:0xf
    v_xor_b32_dpp v170, v138, v10 quad_perm:[1,0,2,3] row_mask:0xf bank_mask:0xf
    ds_read_b128 a[16:19], v108 offset:512
    v_mfma_f32_32x32x16_bf16 v[112:127], a[20:23], v[148:151], v[112:127]
    v_xor_b32_dpp v171, v139, v10 quad_perm:[1,0,2,3] row_mask:0xf bank_mask:0xf
    v_xor_b32_dpp v172, v140, v10 quad_perm:[1,0,2,3] row_mask:0xf bank_mask:0xf
    ds_read_b128 a[20:23], v109 offset:512
    s_waitcnt lgkmcnt(6)
    v_mfma_f32_32x32x16_bf16 v[112:127], a[24:27], v[152:155], v[112:127]
    v_xor_b32_dpp v173, v141, v10 quad_perm:[1,0,2,3] row_mask:0xf bank_mask:0xf
    v_xor_b32_dpp v174, v142, v10 quad_perm:[1,0,2,3] row_mask:0xf bank_mask:0xf
    ds_read_b128 a[24:27], v110 offset:512
    v_mfma_f32_32x32x16_bf16 v[112:127], a[28:31], v[156:159], v[112:127]
    v_xor_b32_dpp v175, v143, v10 quad_perm:[1,0,2,3] row_mask:0xf bank_mask:0xf
    v_xor_b32_dpp v176, v144, v10 quad_perm:[1,0,2,3] row_mask:0xf bank_mask:0xf
    ds_read_b128 a[28:31], v111 offset:512
    s_waitcnt lgkmcnt(6)
    v_mfma_f32_32x32x16_bf16 v[192:207], a[0:3], v[128:131], 0
    v_xor_b32_dpp v177, v145, v10 quad_perm:[1,0,2,3] row_mask:0xf bank_mask:0xf
    v_xor_b32_dpp v178, v146, v10 quad_perm:[1,0,2,3] row_mask:0xf bank_mask:0xf
    ds_read_b128 a[0:3], v104 offset:256
    v_mfma_f32_32x32x16_bf16 v[192:207], a[4:7], v[132:135], v[192:207]
    v_xor_b32_dpp v179, v147, v10 quad_perm:[1,0,2,3] row_mask:0xf bank_mask:0xf
    v_xor_b32_dpp v180, v148, v10 quad_perm:[1,0,2,3] row_mask:0xf bank_mask:0xf
    v_xor_b32_dpp v181, v149, v10 quad_perm:[1,0,2,3] row_mask:0xf bank_mask:0xf
    ds_read_b128 a[4:7], v105 offset:256
    s_waitcnt lgkmcnt(6)
    v_mfma_f32_32x32x16_bf16 v[192:207], a[8:11], v[136:139], v[192:207]
    v_xor_b32_dpp v182, v150, v10 quad_perm:[1,0,2,3] row_mask:0xf bank_mask:0xf
    v_xor_b32_dpp v183, v151, v10 quad_perm:[1,0,2,3] row_mask:0xf bank_mask:0xf
    ds_read_b128 a[8:11], v106 offset:256
    v_mfma_f32_32x32x16_bf16 v[192:207], a[12:15], v[140:143], v[192:207]
    v_xor_b32_dpp v184, v152, v10 quad_perm:[1,0,2,3] row_mask:0xf bank_mask:0xf
    v_xor_b32_dpp v185, v153, v10 quad_perm:[1,0,2,3] row_mask:0xf bank_mask:0xf
    ds_read_b128 a[12:15], v107 offset:256
    s_waitcnt lgkmcnt(6)
    v_mfma_f32_32x32x16_bf16 v[192:207], a[16:19], v[144:147], v[192:207]
    v_xor_b32_dpp v186, v154, v10 quad_perm:[1,0,2,3] row_mask:0xf bank_mask:0xf
    v_xor_b32_dpp v187, v155, v10 quad_perm:[1,0,2,3] row_mask:0xf bank_mask:0xf
    ds_read_b128 a[16:19], v108 offset:256
    v_mfma_f32_32x32x16_bf16 v[192:207], a[20:23], v[148:151], v[192:207]
    v_xor_b32_dpp v188, v156, v10 quad_perm:[1,0,2,3] row_mask:0xf bank_mask:0xf
    v_xor_b32_dpp v189, v157, v10 quad_perm:[1,0,2,3] row_mask:0xf bank_mask:0xf
    ds_read_b128 a[20:23], v109 offset:256
    s_waitcnt lgkmcnt(6)
    v_mfma_f32_32x32x16_bf16 v[192:207], a[24:27], v[152:155], v[192:207]
    v_xor_b32_dpp v190, v158, v10 quad_perm:[1,0,2,3] row_mask:0xf bank_mask:0xf
    v_xor_b32_dpp v191, v159, v10 quad_perm:[1,0,2,3] row_mask:0xf bank_mask:0xf
    v_add_f32 v88, v72, v73
    ds_read_b128 a[24:27], v110 offset:256
    v_mfma_f32_32x32x16_bf16 v[192:207], a[28:31], v[156:159], v[192:207]
    v_add_f32 v89, v80, v81
    v_add_f32 v88, v88, v74
    ds_read_b128 a[28:31], v111 offset:256
    s_waitcnt lgkmcnt(6)
    v_mfma_f32_32x32x16_bf16 v[112:127], a[0:3], v[160:163], v[112:127]
    v_add_f32 v89, v89, v82
    v_add_f32 v88, v88, v75
    ds_read_b128 a[0:3], v104 offset:768
    v_mfma_f32_32x32x16_bf16 v[112:127], a[4:7], v[164:167], v[112:127]
    v_add_f32 v89, v89, v83
    v_add_f32 v88, v88, v76
    ds_read_b128 a[4:7], v105 offset:768
    s_waitcnt lgkmcnt(6)
    v_mfma_f32_32x32x16_bf16 v[112:127], a[8:11], v[168:171], v[112:127]
    v_add_f32 v89, v89, v84
    v_add_f32 v88, v88, v77
    ds_read_b128 a[8:11], v106 offset:768
    v_mfma_f32_32x32x16_bf16 v[112:127], a[12:15], v[172:175], v[112:127]
    v_add_f32 v89, v89, v85
    v_add_f32 v88, v88, v78
    v_add_f32 v89, v89, v86
    ds_read_b128 a[12:15], v107 offset:768
    s_waitcnt lgkmcnt(6)
    v_mfma_f32_32x32x16_bf16 v[112:127], a[16:19], v[176:179], v[112:127]
    v_add_f32 v88, v88, v79
    v_add_f32 v89, v89, v87
    ds_read_b128 a[16:19], v108 offset:768
    v_mfma_f32_32x32x16_bf16 v[112:127], a[20:23], v[180:183], v[112:127]
    v_add_f32_dpp v88, v88, v88 quad_perm:[1,0,3,2] row_mask:0xf bank_mask:0xf
    v_add_f32_dpp v89, v89, v89 quad_perm:[1,0,3,2] row_mask:0xf bank_mask:0xf
    ds_read_b128 a[20:23], v109 offset:768
    s_waitcnt lgkmcnt(6)
    v_mfma_f32_32x32x16_bf16 v[112:127], a[24:27], v[184:187], v[112:127]
    v_add_f32_dpp v88, v88, v88 quad_perm:[2,3,0,1] row_mask:0xf bank_mask:0xf
    v_add_f32_dpp v89, v89, v89 quad_perm:[2,3,0,1] row_mask:0xf bank_mask:0xf
    ds_read_b128 a[24:27], v110 offset:768
    v_mfma_f32_32x32x16_bf16 v[112:127], a[28:31], v[188:191], v[112:127]
    v_add_f32_dpp v88, v88, v88 row_half_mirror row_mask:0xf bank_mask:0xf
    v_add_f32_dpp v89, v89, v89 row_half_mirror row_mask:0xf bank_mask:0xf
    ds_read_b128 a[28:31], v111 offset:768
    s_waitcnt lgkmcnt(6)
    v_mfma_f32_32x32x16_bf16 v[192:207], a[0:3], v[160:163], v[192:207]
    v_add_f32_dpp v88, v88, v88 row_mirror row_mask:0xf bank_mask:0xf
    v_add_f32_dpp v89, v89, v89 row_mirror row_mask:0xf bank_mask:0xf
    s_nop 0
    v_add_f32_dpp v88, v88, v88 row_bcast:15 row_mask:0xa bank_mask:0xf
    v_mfma_f32_32x32x16_bf16 v[192:207], a[4:7], v[164:167], v[192:207]
    v_add_f32_dpp v89, v89, v89 row_bcast:15 row_mask:0xa bank_mask:0xf
    v_add_f32_dpp v88, v88, v88 row_bcast:31 row_mask:0xc bank_mask:0xf
    s_waitcnt lgkmcnt(4)
    v_mfma_f32_32x32x16_bf16 v[192:207], a[8:11], v[168:171], v[192:207]
    v_add_f32_dpp v89, v89, v89 row_bcast:31 row_mask:0xc bank_mask:0xf
    v_mul_f32 v88, 0x3b000000, v88
    v_mfma_f32_32x32x16_bf16 v[192:207], a[12:15], v[172:175], v[192:207]
    v_mul_f32 v89, 0x3b000000, v89
    v_readlane_b32 s51, v88, 63
    s_waitcnt lgkmcnt(2)
    v_mfma_f32_32x32x16_bf16 v[192:207], a[16:19], v[176:179], v[192:207]
    v_readlane_b32 s52, v89, 63
    v_subrev_f32 v72, s51, v72
    v_mfma_f32_32x32x16_bf16 v[192:207], a[20:23], v[180:183], v[192:207]
    v_subrev_f32 v80, s52, v80
    v_subrev_f32 v73, s51, v73
    v_subrev_f32 v81, s52, v81
    s_waitcnt lgkmcnt(0)
    v_mfma_f32_32x32x16_bf16 v[192:207], a[24:27], v[184:187], v[192:207]
    v_subrev_f32 v74, s51, v74
    v_subrev_f32 v82, s52, v82
    v_mfma_f32_32x32x16_bf16 v[192:207], a[28:31], v[188:191], v[192:207]
    v_subrev_f32 v75, s51, v75
    v_subrev_f32 v83, s52, v83
    v_subrev_f32 v76, s51, v76
    v_subrev_f32 v84, s52, v84
    v_subrev_f32 v77, s51, v77
    v_subrev_f32 v85, s52, v85
    v_subrev_f32 v78, s51, v78
    v_subrev_f32 v86, s52, v86
    v_subrev_f32 v79, s51, v79
    v_subrev_f32 v87, s52, v87
    v_mul_f32 v88, v72, v72
    v_mul_f32 v89, v80, v80
    v_mul_f32 v112, v12, v112
    v_mul_f32 v113, v12, v113
    v_mul_f32 v114, v12, v114
    v_mul_f32 v115, v12, v115
    v_mul_f32 v116, v12, v116
    v_mul_f32 v117, v12, v117
    v_mul_f32 v118, v12, v118
    v_mul_f32 v119, v12, v119
    v_fmac_f32 v112, v11, v192
    v_fmac_f32 v113, v11, v193
    v_fmac_f32 v114, v11, v194
    v_fmac_f32 v115, v11, v195
    v_fmac_f32 v116, v11, v196
    v_fmac_f32 v117, v11, v197
    v_fmac_f32 v118, v11, v198
    v_fmac_f32 v119, v11, v199
    v_cvt_pk_bf16_f32 v96, v112, v113
    v_cvt_pk_bf16_f32 v97, v114, v115
    v_cvt_pk_bf16_f32 v98, v116, v117
    v_cvt_pk_bf16_f32 v99, v118, v119
    buffer_store_dwordx4 v[96:99], v28, s[44:47], s67 offen sc1
    v_mul_f32 v120, v12, v120
    v_mul_f32 v121, v12, v121
    v_mul_f32 v122, v12, v122
    v_mul_f32 v123, v12, v123
    v_mul_f32 v124, v12, v124
    v_mul_f32 v125, v12, v125
    v_mul_f32 v126, v12, v126
    v_mul_f32 v127, v12, v127
    v_fmac_f32 v120, v11, v200
    v_fmac_f32 v121, v11, v201
    v_fmac_f32 v122, v11, v202
    v_fmac_f32 v123, v11, v203
    v_fmac_f32 v124, v11, v204
    v_fmac_f32 v125, v11, v205
    v_fmac_f32 v126, v11, v206
    v_fmac_f32 v127, v11, v207
    v_cvt_pk_bf16_f32 v100, v120, v121
    v_cvt_pk_bf16_f32 v101, v122, v123
    v_cvt_pk_bf16_f32 v102, v124, v125
    v_cvt_pk_bf16_f32 v103, v126, v127
    buffer_store_dwordx4 v[100:103], v28, s[44:47], s68 offen sc1
    v_fmac_f32 v88, v73, v73
    v_fmac_f32 v89, v81, v81
    v_fmac_f32 v88, v74, v74
    v_fmac_f32 v89, v82, v82
    v_fmac_f32 v88, v75, v75
    v_fmac_f32 v89, v83, v83
    v_fmac_f32 v88, v76, v76
    v_fmac_f32 v89, v84, v84
    v_fmac_f32 v88, v77, v77
    v_fmac_f32 v89, v85, v85
    v_fmac_f32 v88, v78, v78
    v_fmac_f32 v89, v86, v86
    v_fmac_f32 v88, v79, v79
    v_fmac_f32 v89, v87, v87
    s_nop 0
    v_add_f32_dpp v88, v88, v88 quad_perm:[1,0,3,2] row_mask:0xf bank_mask:0xf
    v_add_f32_dpp v89, v89, v89 quad_perm:[1,0,3,2] row_mask:0xf bank_mask:0xf
    s_nop 0
    v_add_f32_dpp v88, v88, v88 quad_perm:[2,3,0,1] row_mask:0xf bank_mask:0xf
    v_add_f32_dpp v89, v89, v89 quad_perm:[2,3,0,1] row_mask:0xf bank_mask:0xf
    s_nop 0
    v_add_f32_dpp v88, v88, v88 row_half_mirror row_mask:0xf bank_mask:0xf
    v_add_f32_dpp v89, v89, v89 row_half_mirror row_mask:0xf bank_mask:0xf
    s_nop 0
    v_add_f32_dpp v88, v88, v88 row_mirror row_mask:0xf bank_mask:0xf
    v_add_f32_dpp v89, v89, v89 row_mirror row_mask:0xf bank_mask:0xf
    s_nop 0
    v_add_f32_dpp v88, v88, v88 row_bcast:15 row_mask:0xa bank_mask:0xf
    v_add_f32_dpp v89, v89, v89 row_bcast:15 row_mask:0xa bank_mask:0xf
    s_nop 0
    v_add_f32_dpp v88, v88, v88 row_bcast:31 row_mask:0xc bank_mask:0xf
    v_add_f32_dpp v89, v89, v89 row_bcast:31 row_mask:0xc bank_mask:0xf
    v_mul_f32 v88, 0x3b000000, v88
    v_mul_f32 v89, 0x3b000000, v89
    v_cvt_pk_bf16_f32 v88, v88, v88
    v_cvt_pk_bf16_f32 v89, v89, v89
    v_lshlrev_b32 v88, 16, v88
    v_lshlrev_b32 v89, 16, v89
    v_add_f32 v88, 0x3727c5ac, v88
    v_add_f32 v89, 0x3727c5ac, v89
    v_cvt_pk_bf16_f32 v88, v88, v88
    v_cvt_pk_bf16_f32 v89, v89, v89
    v_lshlrev_b32 v88, 16, v88
    v_lshlrev_b32 v89, 16, v89
    v_sqrt_f32 v88, v88
    v_sqrt_f32 v89, v89
    v_cvt_pk_bf16_f32 v88, v88, v88
    v_cvt_pk_bf16_f32 v89, v89, v89
    v_lshlrev_b32 v88, 16, v88
    v_lshlrev_b32 v89, 16, v89
    v_rcp_f32 v88, v88
    v_rcp_f32 v89, v89
    v_mul_f32 v88, 0x3a000000, v88
    v_mul_f32 v89, 0x3a000000, v89
    s_lshr_b32 s51, s56, 8
    s_add_u32 s51, s51, 65536
    v_mov_b32 v4, 0
    s_mov_b32 exec_lo, 0
    s_brev_b32 exec_hi, 1
    buffer_store_dwordx2 v[88:89], v4, s[44:47], s51 offen sc1
    s_mov_b64 exec, -1
    buffer_load_dword v3, v4, s[40:43], 0 offen sc1
    v_lshrrev_b32 v30, 5, v1
    v_bfe_u32 v31, v1, 2, 2
    v_lshl_add_u32 v30, v30, 3, v31
    v_lshlrev_b32 v29, 6, v30
    v_and_b32 v30, 16, v1
    v_lshl_add_u32 v29, v30, 1, v29
    v_and_b32 v30, 1, v1
    v_lshl_add_u32 v29, v30, 4, v29
    v_and_b32 v30, 2, v1
    v_lshl_add_u32 v29, v30, 2, v29
    v_and_b32 v13, 15, v1
    v_lshrrev_b32 v14, 4, v1
    s_lshl_b32 s57, s3, 4
    s_waitcnt vmcnt(0)
L_flagchk:
    v_cmp_ne_u32 vcc, 1, v3
    s_cbranch_vccz L_flagok
    s_sub_u32 s48, s48, 1
    s_cbranch_scc1 L_flagtmo
    buffer_load_dword v3, v4, s[40:43], 0 offen sc1
    s_waitcnt vmcnt(0)
    s_branch L_flagchk
L_flagtmo:
    s_mov_b32 s48, 0
L_flagok:
    s_barrier
    s_cmp_lg_u32 s3, 0
    s_cbranch_scc1 L_a1_1
    s_add_u32 s51, s69, 0
    v_mov_b32 v0, 1
    v_mov_b32 v4, 0
    s_mov_b64 exec, 1
    buffer_atomic_add v0, v4, s[44:47], s51 offen sc0 sc1
    s_mov_b64 exec, -1
L_a1_1:
    s_getpc_b64 s[58:59]
L_pc2:
    s_lshl_b32 s51, s3, 13
    s_add_u32 s51, s51, L_tw - L_pc2
    s_add_u32 s58, s58, s51
    s_addc_u32 s59, s59, 0
    v_add_u32 v15, 4096, v2
    s_cmp_ge_u32 s62, 44
    s_cbranch_scc1 L_role_f
    ds_read_b64_tr_b16 a[0:1], v29 offset:32768
    ds_read_b64_tr_b16 a[2:3], v29 offset:33024
    ds_read_b64_tr_b16 a[4:5], v29 offset:33792
    ds_read_b64_tr_b16 a[6:7], v29 offset:34048
    ds_read_b64_tr_b16 a[8:9], v29 offset:34816
    ds_read_b64_tr_b16 a[10:11], v29 offset:35072
    ds_read_b64_tr_b16 a[12:13], v29 offset:35840
    ds_read_b64_tr_b16 a[14:15], v29 offset:36096
    ds_read_b64_tr_b16 a[16:17], v29 offset:36864
    ds_read_b64_tr_b16 a[18:19], v29 offset:37120
    ds_read_b64_tr_b16 a[20:21], v29 offset:37888
    ds_read_b64_tr_b16 a[22:23], v29 offset:38144
    s_lshl_b32 s51, s7, 2
    s_add_u32 s51, s51, s3
    v_lshl_add_u32 v3, s51, 1, v6
    v_cmp_eq_u32 vcc, 31, v3
    v_mov_b32 v8, 0x3d800000
    v_mov_b32 v9, 0x3d3504f3
    v_cndmask_b32 v10, v8, 0, vcc
    v_cndmask_b32 v9, v8, v9, vcc
    s_lshl_b32 s51, s51, 11
    s_lshl_b32 s52, s62, 15
    s_add_u32 s51, s51, s52
    s_add_u32 s51, s51, 7340032
    ds_read_b64_tr_b16 a[24:25], v29 offset:38912
    ds_read_b64_tr_b16 a[26:27], v29 offset:39168
    s_waitcnt lgkmcnt(10)
    v_mfma_f32_32x32x16_bf16 v[112:127], v[128:131], a[0:3], 0
    v_add_u32 v24, s57, v13
    ds_read_b64_tr_b16 a[28:29], v29 offset:39936
    ds_read_b64_tr_b16 a[30:31], v29 offset:40192
    v_mfma_f32_32x32x16_bf16 v[112:127], v[132:135], a[4:7], v[112:127]
    global_load_dwordx4 v[80:83], v2, s[58:59] offset:0
    v_cvt_f32_u32 v24, v24
    v_cvt_f32_u32 v25, v14
    ds_read_b64_tr_b16 a[0:1], v29 offset:40960
    ds_read_b64_tr_b16 a[2:3], v29 offset:41216
    s_waitcnt lgkmcnt(10)
    v_mfma_f32_32x32x16_bf16 v[112:127], v[136:139], a[8:11], v[112:127]
    v_mul_f32 v25, 4.0, v25
    ds_read_b64_tr_b16 a[4:5], v29 offset:41984
    ds_read_b64_tr_b16 a[6:7], v29 offset:42240
    v_mfma_f32_32x32x16_bf16 v[112:127], v[140:143], a[12:15], v[112:127]
    v_cvt_f32_u32 v26, v13
    v_mul_f32 v27, 0x3c800000, v24
    ds_read_b64_tr_b16 a[8:9], v29 offset:43008
    ds_read_b64_tr_b16 a[10:11], v29 offset:43264
    s_waitcnt lgkmcnt(10)
    v_mfma_f32_32x32x16_bf16 v[112:127], v[144:147], a[16:19], v[112:127]
    global_load_dwordx4 v[84:87], v2, s[58:59] offset:1024
    v_mul_f32 v28, v25, v27
    ds_read_b64_tr_b16 a[12:13], v29 offset:44032
    ds_read_b64_tr_b16 a[14:15], v29 offset:44288
    v_mfma_f32_32x32x16_bf16 v[112:127], v[148:151], a[20:23], v[112:127]
    v_add_f32 v28, v28, v28
    v_mov_b32 v16, v28
    ds_read_b64_tr_b16 a[16:17], v29 offset:45056
    ds_read_b64_tr_b16 a[18:19], v29 offset:45312
    s_waitcnt lgkmcnt(10)
    v_mfma_f32_32x32x16_bf16 v[112:127], v[152:155], a[24:27], v[112:127]
    v_fmamk_f32 v17, v27, 0x3f800000, v28
    ds_read_b64_tr_b16 a[20:21], v29 offset:46080
    ds_read_b64_tr_b16 a[22:23], v29 offset:46336
    v_mfma_f32_32x32x16_bf16 v[112:127], v[156:159], a[28:31], v[112:127]
    global_load_dwordx4 v[88:91], v2, s[58:59] offset:2048
    v_fmamk_f32 v18, v27, 0x40000000, v28
    v_fmamk_f32 v19, v27, 0x40400000, v28
    ds_read_b64_tr_b16 a[24:25], v29 offset:47104
    ds_read_b64_tr_b16 a[26:27], v29 offset:47360
    s_waitcnt lgkmcnt(10)
    v_mfma_f32_32x32x16_bf16 v[112:127], v[160:163], a[0:3], v[112:127]
    v_cos_f32 v20, v16
    ds_read_b64_tr_b16 a[28:29], v29 offset:48128
    ds_read_b64_tr_b16 a[30:31], v29 offset:48384
    v_mfma_f32_32x32x16_bf16 v[112:127], v[164:167], a[4:7], v[112:127]
    v_sin_f32 v16, v16
    v_cos_f32 v21, v17
    ds_read_b64_tr_b16 a[0:1], v29 offset:49152
    ds_read_b64_tr_b16 a[2:3], v29 offset:49408
    s_waitcnt lgkmcnt(10)
    v_mfma_f32_32x32x16_bf16 v[112:127], v[168:171], a[8:11], v[112:127]
    global_load_dwordx4 v[92:95], v2, s[58:59] offset:3072
    v_sin_f32 v17, v17
    ds_read_b64_tr_b16 a[4:5], v29 offset:50176
    ds_read_b64_tr_b16 a[6:7], v29 offset:50432
    v_mfma_f32_32x32x16_bf16 v[112:127], v[172:175], a[12:15], v[112:127]
    v_cos_f32 v22, v18
    v_sin_f32 v18, v18
    ds_read_b64_tr_b16 a[8:9], v29 offset:51200
    ds_read_b64_tr_b16 a[10:11], v29 offset:51456
    s_waitcnt lgkmcnt(10)
    v_mfma_f32_32x32x16_bf16 v[112:127], v[176:179], a[16:19], v[112:127]
    v_cos_f32 v23, v19
    ds_read_b64_tr_b16 a[12:13], v29 offset:52224
    ds_read_b64_tr_b16 a[14:15], v29 offset:52480
    v_mfma_f32_32x32x16_bf16 v[112:127], v[180:183], a[20:23], v[112:127]
    global_load_dwordx4 v[96:99], v15, s[58:59] offset:0
    v_sin_f32 v19, v19
    v_cvt_pk_bf16_f32 v32, v20, v21
    ds_read_b64_tr_b16 a[16:17], v29 offset:53248
    ds_read_b64_tr_b16 a[18:19], v29 offset:53504
    s_waitcnt lgkmcnt(10)
    v_mfma_f32_32x32x16_bf16 v[112:127], v[184:187], a[24:27], v[112:127]
    s_cmp_lg_u32 s3, 0
    s_cbranch_scc1 L_a2_2
    s_waitcnt vmcnt(5)
    v_readfirstlane_b32 s49, v0
    s_nop 0
    s_cmp_lg_u32 s49, 31
    s_cbranch_scc1 L_a2_2
    s_mov_b32 s49, 2048
    v_mov_b32 v0, 1
    v_lshlrev_b32 v4, 8, v1
    s_mov_b64 exec, 0xff
    buffer_atomic_add v0, v4, s[44:47], s49 offen sc1
    s_mov_b64 exec, -1
L_a2_2:
    v_cvt_pk_bf16_f32 v40, v16, v17
    ds_read_b64_tr_b16 a[20:21], v29 offset:54272
    ds_read_b64_tr_b16 a[22:23], v29 offset:54528
    v_mfma_f32_32x32x16_bf16 v[112:127], v[188:191], a[28:31], v[112:127]
    v_cvt_pk_bf16_f32 v33, v22, v23
    v_cvt_pk_bf16_f32 v41, v18, v19
    ds_read_b64_tr_b16 a[24:25], v29 offset:55296
    ds_read_b64_tr_b16 a[26:27], v29 offset:55552
    s_waitcnt lgkmcnt(10)
    v_mfma_f32_32x32x16_bf16 v[192:207], v[128:131], a[0:3], 0
    global_load_dwordx4 v[100:103], v15, s[58:59] offset:1024
    v_fmamk_f32 v16, v27, 0x40800000, v28
    ds_read_b64_tr_b16 a[28:29], v29 offset:56320
    ds_read_b64_tr_b16 a[30:31], v29 offset:56576
    v_mfma_f32_32x32x16_bf16 v[192:207], v[132:135], a[4:7], v[192:207]
    v_fmamk_f32 v17, v27, 0x40a00000, v28
    v_fmamk_f32 v18, v27, 0x40c00000, v28
    ds_read_b64_tr_b16 a[0:1], v29 offset:57344
    ds_read_b64_tr_b16 a[2:3], v29 offset:57600
    s_waitcnt lgkmcnt(10)
    v_mfma_f32_32x32x16_bf16 v[192:207], v[136:139], a[8:11], v[192:207]
    v_fmamk_f32 v19, v27, 0x40e00000, v28
    ds_read_b64_tr_b16 a[4:5], v29 offset:58368
    ds_read_b64_tr_b16 a[6:7], v29 offset:58624
    v_mfma_f32_32x32x16_bf16 v[192:207], v[140:143], a[12:15], v[192:207]
    global_load_dwordx4 v[104:107], v15, s[58:59] offset:2048
    v_cos_f32 v20, v16
    v_sin_f32 v16, v16
    ds_read_b64_tr_b16 a[8:9], v29 offset:59392
    ds_read_b64_tr_b16 a[10:11], v29 offset:59648
    s_waitcnt lgkmcnt(10)
    v_mfma_f32_32x32x16_bf16 v[192:207], v[144:147], a[16:19], v[192:207]
    v_cos_f32 v21, v17
    ds_read_b64_tr_b16 a[12:13], v29 offset:60416
    ds_read_b64_tr_b16 a[14:15], v29 offset:60672
    v_mfma_f32_32x32x16_bf16 v[192:207], v[148:151], a[20:23], v[192:207]
    v_sin_f32 v17, v17
    v_cos_f32 v22, v18
    ds_read_b64_tr_b16 a[16:17], v29 offset:61440
    ds_read_b64_tr_b16 a[18:19], v29 offset:61696
    s_waitcnt lgkmcnt(10)
    v_mfma_f32_32x32x16_bf16 v[192:207], v[152:155], a[24:27], v[192:207]
    global_load_dwordx4 v[108:111], v15, s[58:59] offset:3072
    v_sin_f32 v18, v18
    ds_read_b64_tr_b16 a[20:21], v29 offset:62464
    ds_read_b64_tr_b16 a[22:23], v29 offset:62720
    v_mfma_f32_32x32x16_bf16 v[192:207], v[156:159], a[28:31], v[192:207]
    v_cos_f32 v23, v19
    v_sin_f32 v19, v19
    ds_read_b64_tr_b16 a[24:25], v29 offset:63488
    ds_read_b64_tr_b16 a[26:27], v29 offset:63744
    s_waitcnt lgkmcnt(10)
    v_mfma_f32_32x32x16_bf16 v[192:207], v[160:163], a[0:3], v[192:207]
    v_cvt_pk_bf16_f32 v34, v20, v21
    ds_read_b64_tr_b16 a[28:29], v29 offset:64512
    ds_read_b64_tr_b16 a[30:31], v29 offset:64768
    v_mfma_f32_32x32x16_bf16 v[192:207], v[164:167], a[4:7], v[192:207]
    v_cvt_pk_bf16_f32 v42, v16, v17
    v_cvt_pk_bf16_f32 v35, v22, v23
    s_waitcnt lgkmcnt(8)
    v_mfma_f32_32x32x16_bf16 v[192:207], v[168:171], a[8:11], v[192:207]
    v_cvt_pk_bf16_f32 v43, v18, v19
    v_mfma_f32_32x32x16_bf16 v[192:207], v[172:175], a[12:15], v[192:207]
    v_mul_f32 v27, 0x3d000000, v26
    v_mul_f32 v28, v25, v27
    s_waitcnt lgkmcnt(4)
    v_mfma_f32_32x32x16_bf16 v[192:207], v[176:179], a[16:19], v[192:207]
    v_mov_b32 v16, v28
    v_mfma_f32_32x32x16_bf16 v[192:207], v[180:183], a[20:23], v[192:207]
    v_fmamk_f32 v17, v27, 0x3f800000, v28
    v_fmamk_f32 v18, v27, 0x40000000, v28
    s_waitcnt lgkmcnt(0)
    v_mfma_f32_32x32x16_bf16 v[192:207], v[184:187], a[24:27], v[192:207]
    v_fmamk_f32 v19, v27, 0x40400000, v28
    v_mfma_f32_32x32x16_bf16 v[192:207], v[188:191], a[28:31], v[192:207]
    v_cos_f32 v20, v16
    v_sin_f32 v16, v16
    s_nop 9
    v_sub_f32 v112, v112, v192
    v_sub_f32 v113, v113, v193
    v_add_f32 v114, v114, v194
    v_add_f32 v115, v115, v195
    v_sub_f32 v116, v116, v196
    v_sub_f32 v117, v117, v197
    v_add_f32 v118, v118, v198
    v_add_f32 v119, v119, v199
    v_mul_f32 v112, v8, v112
    v_mul_f32 v113, v8, v113
    v_mul_f32 v114, v8, v114
    v_mul_f32 v115, v8, v115
    v_mul_f32 v116, v8, v116
    v_mul_f32 v117, v8, v117
    v_mul_f32 v118, v8, v118
    v_mul_f32 v119, v8, v119
    v_cvt_pk_bf16_f32 v208, v112, v113
    v_cvt_pk_bf16_f32 v209, v114, v115
    v_cvt_pk_bf16_f32 v210, v116, v117
    v_cvt_pk_bf16_f32 v211, v118, v119
    buffer_store_dwordx4 v[208:211], v2, s[44:47], s51 offen offset:0 sc1
    v_sub_f32 v120, v120, v200
    v_sub_f32 v121, v121, v201
    v_add_f32 v122, v122, v202
    v_add_f32 v123, v123, v203
    v_sub_f32 v124, v124, v204
    v_sub_f32 v125, v125, v205
    v_add_f32 v126, v126, v206
    v_add_f32 v127, v127, v207
    v_mul_f32 v120, v8, v120
    v_mul_f32 v121, v8, v121
    v_mul_f32 v122, v8, v122
    v_mul_f32 v123, v8, v123
    v_mul_f32 v124, v8, v124
    v_mul_f32 v125, v8, v125
    v_mul_f32 v126, v9, v126
    v_mul_f32 v127, v10, v127
    v_cvt_pk_bf16_f32 v212, v120, v121
    v_cvt_pk_bf16_f32 v213, v122, v123
    v_cvt_pk_bf16_f32 v214, v124, v125
    v_cvt_pk_bf16_f32 v215, v126, v127
    buffer_store_dwordx4 v[212:215], v2, s[44:47], s51 offen offset:1024 sc1
    v_cos_f32 v21, v17
    v_sin_f32 v17, v17
    v_cos_f32 v22, v18
    v_sin_f32 v18, v18
    v_cos_f32 v23, v19
    v_sin_f32 v19, v19
    v_cvt_pk_bf16_f32 v56, v20, v21
    v_cvt_pk_bf16_f32 v64, v16, v17
    v_cvt_pk_bf16_f32 v57, v22, v23
    v_cvt_pk_bf16_f32 v65, v18, v19
    v_fmamk_f32 v16, v27, 0x41800000, v28
    v_fmamk_f32 v17, v27, 0x41880000, v28
    v_fmamk_f32 v18, v27, 0x41900000, v28
    v_fmamk_f32 v19, v27, 0x41980000, v28
    v_cos_f32 v20, v16
    v_sin_f32 v16, v16
    v_cos_f32 v21, v17
    v_sin_f32 v17, v17
    v_cos_f32 v22, v18
    v_sin_f32 v18, v18
    v_cos_f32 v23, v19
    v_sin_f32 v19, v19
    v_cvt_pk_bf16_f32 v58, v20, v21
    v_cvt_pk_bf16_f32 v66, v16, v17
    v_cvt_pk_bf16_f32 v59, v22, v23
    v_cvt_pk_bf16_f32 v67, v18, v19
    v_bfe_i32 v30, v13, 0, 1
    v_and_b32 v30, 0x80008000, v30
    v_xor_b32 v36, v30, v32
    v_xor_b32 v44, v30, v40
    v_xor_b32 v60, 0x80000000, v56
    v_xor_b32 v68, 0x80000000, v64
    v_xor_b32 v37, v30, v33
    v_xor_b32 v45, v30, v41
    v_xor_b32 v61, 0x80000000, v57
    v_xor_b32 v69, 0x80000000, v65
    v_xor_b32 v38, v30, v34
    v_xor_b32 v46, v30, v42
    v_xor_b32 v62, 0x80000000, v58
    v_xor_b32 v70, 0x80000000, v66
    v_xor_b32 v39, v30, v35
    v_xor_b32 v47, v30, v43
    v_xor_b32 v63, 0x80000000, v59
    v_xor_b32 v71, 0x80000000, v67
    v_xor_b32 v48, 0x80008000, v40
    v_xor_b32 v72, 0x80008000, v64
    v_xor_b32 v49, 0x80008000, v41
    v_xor_b32 v73, 0x80008000, v65
    v_xor_b32 v50, 0x80008000, v42
    v_xor_b32 v74, 0x80008000, v66
    v_xor_b32 v51, 0x80008000, v43
    v_xor_b32 v75, 0x80008000, v67
    v_xor_b32 v52, 0x80008000, v44
    v_xor_b32 v76, 0x80008000, v68
    v_xor_b32 v53, 0x80008000, v45
    v_xor_b32 v77, 0x80008000, v69
    v_xor_b32 v54, 0x80008000, v46
    v_xor_b32 v78, 0x80008000, v70
    v_xor_b32 v55, 0x80008000, v47
    v_xor_b32 v79, 0x80008000, v71
    s_branch L_role_done
L_role_f:
    v_lshrrev_b32 v30, 5, v1
    v_bfe_u32 v31, v1, 2, 2
    v_lshl_add_u32 v30, v30, 3, v31
    v_lshlrev_b32 v8, 7, v30
    v_and_b32 v30, 16, v1
    v_lshl_add_u32 v8, v30, 1, v8
    v_and_b32 v30, 1, v1
    v_lshl_add_u32 v8, v30, 4, v8
    v_and_b32 v30, 2, v1
    v_lshl_add_u32 v8, v30, 2, v8
    s_lshl_b32 s51, s3, 13
    v_add_u32 v8, s51, v8
    ds_read_b64_tr_b16 v[128:129], v8 offset:32768
    ds_read_b64_tr_b16 v[130:131], v8 offset:33280
    ds_read_b64_tr_b16 v[132:133], v8 offset:32832
    ds_read_b64_tr_b16 v[134:135], v8 offset:33344
    ds_read_b64_tr_b16 v[136:137], v8 offset:34816
    ds_read_b64_tr_b16 v[138:139], v8 offset:35328
    ds_read_b64_tr_b16 v[140:141], v8 offset:34880
    ds_read_b64_tr_b16 v[142:143], v8 offset:35392
    ds_read_b64_tr_b16 v[144:145], v8 offset:36864
    ds_read_b64_tr_b16 v[146:147], v8 offset:37376
    ds_read_b64_tr_b16 v[148:149], v8 offset:36928
    ds_read_b64_tr_b16 v[150:151], v8 offset:37440
    s_and_b32 s51, s66, 7
    s_mul_i32 s51, s51, 88
    s_lshr_b32 s52, s66, 3
    s_add_u32 s51, s51, s52
    s_lshl_b32 s51, s51, 11
    s_add_u32 s51, s51, 9437184
    s_cmp_lg_u32 s3, 0
    s_cbranch_scc1 L_a2_3
    s_waitcnt vmcnt(0)
    v_readfirstlane_b32 s49, v0
    s_nop 0
    s_cmp_lg_u32 s49, 31
    s_cbranch_scc1 L_a2_3
    s_mov_b32 s49, 2048
    v_mov_b32 v0, 1
    v_lshlrev_b32 v4, 8, v1
    s_mov_b64 exec, 0xff
    buffer_atomic_add v0, v4, s[44:47], s49 offen sc1
    s_mov_b64 exec, -1
L_a2_3:
    s_waitcnt lgkmcnt(0)
    buffer_store_dwordx4 v[128:131], v2, s[44:47], s51 offen offset:0 sc1
    buffer_store_dwordx4 v[132:135], v2, s[44:47], s51 offen offset:1024 sc1
    s_add_u32 s51, s51, 81920
    buffer_store_dwordx4 v[136:139], v2, s[44:47], s51 offen offset:0 sc1
    buffer_store_dwordx4 v[140:143], v2, s[44:47], s51 offen offset:1024 sc1
    s_add_u32 s51, s51, 81920
    s_cmp_ge_u32 s66, 64
    s_cbranch_scc1 L_w2f_done
    buffer_store_dwordx4 v[144:147], v2, s[44:47], s51 offen offset:0 sc1
    buffer_store_dwordx4 v[148:151], v2, s[44:47], s51 offen offset:1024 sc1
L_w2f_done:
    s_cmp_lt_u32 s66, 64
    s_cbranch_scc1 L_f_done
    s_sub_u32 s53, s66, 64
    s_lshr_b32 s51, s53, 4
    s_lshl_b32 s52, s51, 5
    v_add_u32 v3, s52, v5
    v_cvt_f32_u32 v8, v3
    v_mul_f32 v8, 0x3b000000, v8
    s_and_b32 s52, s53, 15
    s_lshl_b32 s53, s52, 4
    s_add_u32 s53, s53, 1
    v_lshl_add_u32 v4, v6, 2, s53
    v_cvt_f32_u32 v4, v4
    v_mul_f32 v9, v8, v4
    v_mov_b32 v160, v9
    v_fmamk_f32 v161, v8, 0x3f800000, v9
    v_fmamk_f32 v162, v8, 0x40000000, v9
    v_fmamk_f32 v163, v8, 0x40400000, v9
    v_fmamk_f32 v164, v8, 0x41000000, v9
    v_fmamk_f32 v165, v8, 0x41100000, v9
    v_fmamk_f32 v166, v8, 0x41200000, v9
    v_fmamk_f32 v167, v8, 0x41300000, v9
    v_cos_f32 v168, v160
    v_sin_f32 v160, v160
    v_cos_f32 v169, v161
    v_sin_f32 v161, v161
    v_cos_f32 v170, v162
    v_sin_f32 v162, v162
    v_cos_f32 v171, v163
    v_sin_f32 v163, v163
    v_cos_f32 v172, v164
    v_sin_f32 v164, v164
    v_cos_f32 v173, v165
    v_sin_f32 v165, v165
    v_cos_f32 v174, v166
    v_sin_f32 v166, v166
    v_cos_f32 v175, v167
    v_sin_f32 v167, v167
    v_cvt_pk_bf16_f32 v176, v168, -v160
    v_cvt_pk_bf16_f32 v177, v169, -v161
    v_cvt_pk_bf16_f32 v178, v170, -v162
    v_cvt_pk_bf16_f32 v179, v171, -v163
    v_cvt_pk_bf16_f32 v180, v172, -v164
    v_cvt_pk_bf16_f32 v181, v173, -v165
    v_cvt_pk_bf16_f32 v182, v174, -v166
    v_cvt_pk_bf16_f32 v183, v175, -v167
    v_and_b32 v3, 1, v3
    v_lshlrev_b32 v3, 15, v3
    v_or_b32 v3, 0x3f353f35, v3
    v_lshl_add_u32 v4, s52, 1, v6
    v_cmp_eq_u32 vcc, 31, v4
    s_add_u32 s51, s51, 44
    s_lshl_b32 s51, s51, 15
    v_cndmask_b32 v183, v183, v3, vcc
    s_lshl_b32 s52, s52, 11
    s_add_u32 s51, s51, s52
    s_add_u32 s51, s51, 7340032
    buffer_store_dwordx4 v[176:179], v2, s[44:47], s51 offen sc1
    buffer_store_dwordx4 v[180:183], v2, s[44:47], s51 offen offset:1024 sc1
L_f_done:
    global_load_dwordx4 v[80:83], v2, s[58:59] offset:0
    global_load_dwordx4 v[84:87], v2, s[58:59] offset:1024
    global_load_dwordx4 v[88:91], v2, s[58:59] offset:2048
    global_load_dwordx4 v[92:95], v2, s[58:59] offset:3072
    global_load_dwordx4 v[96:99], v15, s[58:59] offset:0
    global_load_dwordx4 v[100:103], v15, s[58:59] offset:1024
    global_load_dwordx4 v[104:107], v15, s[58:59] offset:2048
    global_load_dwordx4 v[108:111], v15, s[58:59] offset:3072
    v_add_u32 v24, s57, v13
    v_cvt_f32_u32 v24, v24
    v_cvt_f32_u32 v25, v14
    v_mul_f32 v25, 4.0, v25
    v_cvt_f32_u32 v26, v13
    v_mul_f32 v27, 0x3c800000, v24
    v_mul_f32 v28, v25, v27
    v_add_f32 v28, v28, v28
    v_mov_b32 v16, v28
    v_fmamk_f32 v17, v27, 0x3f800000, v28
    v_fmamk_f32 v18, v27, 0x40000000, v28
    v_fmamk_f32 v19, v27, 0x40400000, v28
    v_cos_f32 v20, v16
    v_sin_f32 v16, v16
    v_cos_f32 v21, v17
    v_sin_f32 v17, v17
    v_cos_f32 v22, v18
    v_sin_f32 v18, v18
    v_cos_f32 v23, v19
    v_sin_f32 v19, v19
    v_cvt_pk_bf16_f32 v32, v20, v21
    v_cvt_pk_bf16_f32 v40, v16, v17
    v_cvt_pk_bf16_f32 v33, v22, v23
    v_cvt_pk_bf16_f32 v41, v18, v19
    v_fmamk_f32 v16, v27, 0x40800000, v28
    v_fmamk_f32 v17, v27, 0x40a00000, v28
    v_fmamk_f32 v18, v27, 0x40c00000, v28
    v_fmamk_f32 v19, v27, 0x40e00000, v28
    v_cos_f32 v20, v16
    v_sin_f32 v16, v16
    v_cos_f32 v21, v17
    v_sin_f32 v17, v17
    v_cos_f32 v22, v18
    v_sin_f32 v18, v18
    v_cos_f32 v23, v19
    v_sin_f32 v19, v19
    v_cvt_pk_bf16_f32 v34, v20, v21
    v_cvt_pk_bf16_f32 v42, v16, v17
    v_cvt_pk_bf16_f32 v35, v22, v23
    v_cvt_pk_bf16_f32 v43, v18, v19
    v_mul_f32 v27, 0x3d000000, v26
    v_mul_f32 v28, v25, v27
    v_mov_b32 v16, v28
    v_fmamk_f32 v17, v27, 0x3f800000, v28
    v_fmamk_f32 v18, v27, 0x40000000, v28
    v_fmamk_f32 v19, v27, 0x40400000, v28
    v_cos_f32 v20, v16
    v_sin_f32 v16, v16
    v_cos_f32 v21, v17
    v_sin_f32 v17, v17
    v_cos_f32 v22, v18
    v_sin_f32 v18, v18
    v_cos_f32 v23, v19
    v_sin_f32 v19, v19
    v_cvt_pk_bf16_f32 v56, v20, v21
    v_cvt_pk_bf16_f32 v64, v16, v17
    v_cvt_pk_bf16_f32 v57, v22, v23
    v_cvt_pk_bf16_f32 v65, v18, v19
    v_fmamk_f32 v16, v27, 0x41800000, v28
    v_fmamk_f32 v17, v27, 0x41880000, v28
    v_fmamk_f32 v18, v27, 0x41900000, v28
    v_fmamk_f32 v19, v27, 0x41980000, v28
    v_cos_f32 v20, v16
    v_sin_f32 v16, v16
    v_cos_f32 v21, v17
    v_sin_f32 v17, v17
    v_cos_f32 v22, v18
    v_sin_f32 v18, v18
    v_cos_f32 v23, v19
    v_sin_f32 v19, v19
    v_cvt_pk_bf16_f32 v58, v20, v21
    v_cvt_pk_bf16_f32 v66, v16, v17
    v_cvt_pk_bf16_f32 v59, v22, v23
    v_cvt_pk_bf16_f32 v67, v18, v19
    v_bfe_i32 v30, v13, 0, 1
    v_and_b32 v30, 0x80008000, v30
    v_xor_b32 v36, v30, v32
    v_xor_b32 v44, v30, v40
    v_xor_b32 v60, 0x80000000, v56
    v_xor_b32 v68, 0x80000000, v64
    v_xor_b32 v37, v30, v33
    v_xor_b32 v45, v30, v41
    v_xor_b32 v61, 0x80000000, v57
    v_xor_b32 v69, 0x80000000, v65
    v_xor_b32 v38, v30, v34
    v_xor_b32 v46, v30, v42
    v_xor_b32 v62, 0x80000000, v58
    v_xor_b32 v70, 0x80000000, v66
    v_xor_b32 v39, v30, v35
    v_xor_b32 v47, v30, v43
    v_xor_b32 v63, 0x80000000, v59
    v_xor_b32 v71, 0x80000000, v67
    v_xor_b32 v48, 0x80008000, v40
    v_xor_b32 v72, 0x80008000, v64
    v_xor_b32 v49, 0x80008000, v41
    v_xor_b32 v73, 0x80008000, v65
    v_xor_b32 v50, 0x80008000, v42
    v_xor_b32 v74, 0x80008000, v66
    v_xor_b32 v51, 0x80008000, v43
    v_xor_b32 v75, 0x80008000, v67
    v_xor_b32 v52, 0x80008000, v44
    v_xor_b32 v76, 0x80008000, v68
    v_xor_b32 v53, 0x80008000, v45
    v_xor_b32 v77, 0x80008000, v69
    v_xor_b32 v54, 0x80008000, v46
    v_xor_b32 v78, 0x80008000, v70
    v_xor_b32 v55, 0x80008000, v47
    v_xor_b32 v79, 0x80008000, v71
L_role_done:
    s_nop 1
    s_lshl_b32 s50, s4, 5
    s_add_u32 s50, s50, s5
    s_cmp_eq_u32 s50, 255
    s_cselect_b32 s54, 0, -1
    s_cselect_b32 s55, 0, 1.0
    s_lshl_b32 s56, s50, 6
    s_add_u32 s56, s56, 1048576
    s_lshl_b32 s58, s50, 7
    s_add_u32 s58, s58, 5242880
    s_lshl_b32 s60, s50, 13
    s_lshl_b32 s61, s3, 11
    s_add_u32 s60, s60, s61
    s_add_u32 s60, s60, 3145728
    s_mov_b32 s61, 65536
    v_add_u32 v3, s57, v13
    v_lshlrev_b32 v17, 15, v3
    v_lshrrev_b32 v4, 1, v14
    v_lshl_add_u32 v15, v4, 14, v17
    v_and_b32 v4, 1, v14
    v_lshl_add_u32 v15, v4, 4, v15
    v_lshl_add_u32 v17, v14, 4, v17
    v_lshlrev_b32 v16, 7, v3
    v_lshl_add_u32 v16, v14, 5, v16
    v_lshlrev_b32 v18, 6, v3
    v_lshl_add_u32 v18, v14, 4, v18
    v_bfe_u32 v4, v1, 2, 2
    v_lshl_add_u32 v4, v14, 3, v4
    v_lshlrev_b32 v19, 6, v4
    v_and_b32 v4, 3, v1
    v_lshl_add_u32 v19, v4, 3, v19
    v_mul_u32_u24 v20, 144, v13
    v_lshl_add_u32 v20, v14, 3, v20
    s_lshl_b32 s51, s3, 5
    v_add_u32 v20, s51, v20
    v_and_b32 v3, 12, v13
    v_lshl_add_u32 v3, v3, 1, v4
    v_mul_u32_u24 v21, 144, v3
    v_lshl_add_u32 v21, v14, 4, v21
    v_mov_b32 v23, 0
    s_lshr_b32 s62, s4, 1
    s_lshl_b32 s62, s62, 2
    s_lshr_b32 s51, s5, 3
    s_add_u32 s62, s62, s51
    s_and_b32 s63, s4, 1
    s_lshl_b32 s63, s63, 3
    s_and_b32 s65, s5, 7
    s_add_u32 s63, s63, s65
    s_lshr_b32 s51, s5, 4
    s_lshl_b32 s66, s4, 1
    s_add_u32 s66, s66, s51
    s_lshl_b32 s64, s66, 2
    s_bfe_u32 s51, s5, 0x10003
    s_add_u32 s64, s64, s51
    s_min_u32 s68, s63, 14
    s_lshl_b32 s68, s68, 2
    s_add_u32 s68, s68, s3
    s_lshl_b32 s68, s68, 15
    s_add_u32 s68, s68, 7340032
    s_mul_i32 s67, s65, 88
    s_mul_i32 s51, s3, 22
    s_add_u32 s67, s67, s51
    s_lshl_b32 s67, s67, 11
    s_add_u32 s67, s67, 9437184
    s_add_u32 s51, s69, 2048
    s_cmp_lg_u32 s3, 0
    s_cbranch_scc1 L_pw_4
    v_and_b32 v4, 0, v1
    v_lshlrev_b32 v4, 8, v4
L_pl_5:
    buffer_load_dword v3, v4, s[44:47], s51 offen sc1
    s_waitcnt vmcnt(0)
    v_cmp_ne_u32 vcc, 8, v3
    s_cbranch_vccz L_pw_4
    s_sub_u32 s48, s48, 1
    s_cbranch_scc1 L_pw_4_t
    s_sleep 1
    s_branch L_pl_5
L_pw_4_t:
    s_mov_b32 s48, 0
L_pw_4:
    s_barrier
    buffer_load_dwordx4 v[112:115], v15, s[44:47], s56 offen sc1
    buffer_load_dwordx4 v[116:119], v15, s[44:47], s56 offen offset:32 sc1
    buffer_load_dwordx4 v[120:123], v16, s[44:47], s61 offen sc1
    buffer_load_dwordx4 v[124:127], v16, s[44:47], s61 offen offset:16 sc1
    s_sleep 6
    buffer_load_dwordx4 v[128:131], v2, s[44:47], s60 offen sc1
    buffer_load_dwordx4 v[132:135], v2, s[44:47], s60 offen offset:1024 sc1
    s_waitcnt vmcnt(2)
    v_lshlrev_b32 v136, 16, v112
    v_and_b32 v137, 0xffff0000, v112
    v_lshlrev_b32 v138, 16, v113
    v_and_b32 v139, 0xffff0000, v113
    v_lshlrev_b32 v140, 16, v114
    v_and_b32 v141, 0xffff0000, v114
    v_lshlrev_b32 v142, 16, v115
    v_and_b32 v143, 0xffff0000, v115
    v_pk_mul_f32 v[152:153], v[136:137], v[120:121]
    v_pk_mul_f32 v[154:155], v[138:139], v[122:123]
    v_pk_mul_f32 v[156:157], v[140:141], v[124:125]
    v_pk_mul_f32 v[158:159], v[142:143], v[126:127]
    v_cvt_pk_bf16_f32 v112, v152, v153
    v_cvt_pk_bf16_f32 v113, v154, v155
    v_cvt_pk_bf16_f32 v114, v156, v157
    v_cvt_pk_bf16_f32 v115, v158, v159
    ds_write_b128 v18, v[112:115] offset:0
    v_lshlrev_b32 v144, 16, v116
    v_and_b32 v145, 0xffff0000, v116
    v_lshlrev_b32 v146, 16, v117
    v_and_b32 v147, 0xffff0000, v117
    v_lshlrev_b32 v148, 16, v118
    v_and_b32 v149, 0xffff0000, v118
    v_lshlrev_b32 v150, 16, v119
    v_and_b32 v151, 0xffff0000, v119
    v_pk_mul_f32 v[152:153], v[144:145], v[120:121]
    v_pk_mul_f32 v[154:155], v[146:147], v[122:123]
    v_pk_mul_f32 v[156:157], v[148:149], v[124:125]
    v_pk_mul_f32 v[158:159], v[150:151], v[126:127]
    v_cvt_pk_bf16_f32 v116, v152, v153
    v_cvt_pk_bf16_f32 v117, v154, v155
    v_cvt_pk_bf16_f32 v118, v156, v157
    v_cvt_pk_bf16_f32 v119, v158, v159
    v_and_b32 v116, s54, v116
    v_and_b32 v117, s54, v117
    v_and_b32 v118, s54, v118
    v_and_b32 v119, s54, v119
    ds_write_b128 v18, v[116:119] offset:4096
    s_waitcnt lgkmcnt(0)
    s_barrier
    s_cmp_lg_u32 s3, 0
    s_cbranch_scc1 L_a1_6
    s_add_u32 s51, s69, 4096
    v_mov_b32 v0, 1
    v_mov_b32 v4, 0
    s_mov_b64 exec, 1
    buffer_atomic_add v0, v4, s[44:47], s51 offen sc0 sc1
    s_mov_b64 exec, -1
L_a1_6:
    ds_read_b64_tr_b16 v[168:169], v19 offset:0
    ds_read_b64_tr_b16 v[170:171], v19 offset:256
    ds_read_b64_tr_b16 v[172:173], v19 offset:4096
    ds_read_b64_tr_b16 v[174:175], v19 offset:4352
    ds_read_b64_tr_b16 v[176:177], v19 offset:2048
    ds_read_b64_tr_b16 v[178:179], v19 offset:2304
    ds_read_b64_tr_b16 v[180:181], v19 offset:6144
    ds_read_b64_tr_b16 v[182:183], v19 offset:6400
    ds_read_b64_tr_b16 v[184:185], v19 offset:32
    ds_read_b64_tr_b16 v[186:187], v19 offset:288
    ds_read_b64_tr_b16 v[188:189], v19 offset:4128
    ds_read_b64_tr_b16 v[190:191], v19 offset:4384
    ds_read_b64_tr_b16 v[192:193], v19 offset:2080
    ds_read_b64_tr_b16 v[194:195], v19 offset:2336
    ds_read_b64_tr_b16 v[196:197], v19 offset:6176
    ds_read_b64_tr_b16 v[198:199], v19 offset:6432
    s_waitcnt lgkmcnt(14)
    v_mfma_f32_16x16x32_bf16 v[216:219], v[168:171], v[32:35], 0
    v_mfma_f32_16x16x32_bf16 v[224:227], v[168:171], v[48:51], 0
    s_waitcnt lgkmcnt(12)
    v_mfma_f32_16x16x32_bf16 v[216:219], v[172:175], v[40:43], v[216:219]
    v_mfma_f32_16x16x32_bf16 v[224:227], v[172:175], v[32:35], v[224:227]
    s_waitcnt lgkmcnt(10)
    v_mfma_f32_16x16x32_bf16 v[216:219], v[176:179], v[36:39], v[216:219]
    v_mfma_f32_16x16x32_bf16 v[224:227], v[176:179], v[52:55], v[224:227]
    s_waitcnt lgkmcnt(8)
    v_mfma_f32_16x16x32_bf16 v[216:219], v[180:183], v[44:47], v[216:219]
    v_mfma_f32_16x16x32_bf16 v[224:227], v[180:183], v[36:39], v[224:227]
    s_waitcnt lgkmcnt(6)
    v_mfma_f32_16x16x32_bf16 v[220:223], v[184:187], v[32:35], 0
    v_mfma_f32_16x16x32_bf16 v[228:231], v[184:187], v[48:51], 0
    s_waitcnt lgkmcnt(4)
    v_mfma_f32_16x16x32_bf16 v[220:223], v[188:191], v[40:43], v[220:223]
    s_nop 3
    v_mfma_f32_16x16x32_bf16 v[228:231], v[188:191], v[32:35], v[228:231]
    v_mul_f32 v152, v216, v80
    v_mul_f32 v156, v224, v80
    s_waitcnt lgkmcnt(2)
    v_mfma_f32_16x16x32_bf16 v[220:223], v[192:195], v[36:39], v[220:223]
    v_mul_f32 v153, v217, v81
    v_mul_f32 v157, v225, v81
    v_mfma_f32_16x16x32_bf16 v[228:231], v[192:195], v[52:55], v[228:231]
    v_mul_f32 v154, v218, v82
    v_mul_f32 v158, v226, v82
    v_mul_f32 v155, v219, v83
    s_waitcnt lgkmcnt(0)
    v_mfma_f32_16x16x32_bf16 v[220:223], v[196:199], v[44:47], v[220:223]
    v_mul_f32 v159, v227, v83
    v_fma_f32 v152, v224, v88, v152
    v_mfma_f32_16x16x32_bf16 v[228:231], v[196:199], v[36:39], v[228:231]
    v_fma_f32 v156, -v216, v88, v156
    v_fma_f32 v153, v225, v89, v153
    v_fma_f32 v157, -v217, v89, v157
    v_fma_f32 v154, v226, v90, v154
    v_fma_f32 v158, -v218, v90, v158
    v_fma_f32 v155, v227, v91, v155
    v_fma_f32 v159, -v219, v91, v159
    v_cvt_pk_bf16_f32 v232, v152, v153
    v_cvt_pk_bf16_f32 v236, v156, v157
    v_cvt_pk_bf16_f32 v233, v154, v155
    v_cvt_pk_bf16_f32 v237, v158, v159
    v_pk_mul_f32 v[160:161], v[220:221], v[84:85]
    v_pk_mul_f32 v[164:165], v[228:229], v[84:85]
    v_pk_mul_f32 v[162:163], v[222:223], v[86:87]
    v_pk_mul_f32 v[166:167], v[230:231], v[86:87]
    v_pk_fma_f32 v[160:161], v[228:229], v[92:93], v[160:161]
    v_pk_fma_f32 v[164:165], v[220:221], v[92:93], v[164:165] neg_lo:[1,0,0] neg_hi:[1,0,0]
    v_pk_fma_f32 v[162:163], v[230:231], v[94:95], v[162:163]
    v_pk_fma_f32 v[166:167], v[222:223], v[94:95], v[166:167] neg_lo:[1,0,0] neg_hi:[1,0,0]
    v_cvt_pk_bf16_f32 v234, v160, v161
    v_cvt_pk_bf16_f32 v238, v164, v165
    v_cvt_pk_bf16_f32 v235, v162, v163
    v_cvt_pk_bf16_f32 v239, v166, v167
    s_cmp_lg_u32 s3, 0
    s_cbranch_scc1 L_a2_7
    s_waitcnt vmcnt(0)
    v_readfirstlane_b32 s49, v0
    s_nop 0
    s_cmp_lg_u32 s49, 31
    s_cbranch_scc1 L_a2_7
    s_mov_b32 s49, 6144
    v_mov_b32 v0, 1
    v_lshlrev_b32 v4, 8, v1
    s_mov_b64 exec, 0xff
    buffer_atomic_add v0, v4, s[44:47], s49 offen sc1
    s_mov_b64 exec, -1
L_a2_7:
    s_waitcnt vmcnt(0)
    v_mfma_f32_16x16x32_bf16 v[216:219], v[56:59], v[232:235], 0
    v_lshlrev_b32 v200, 16, v128
    v_and_b32 v201, 0xffff0000, v128
    v_mfma_f32_16x16x32_bf16 v[224:227], v[56:59], v[236:239], 0
    v_lshlrev_b32 v202, 16, v129
    v_and_b32 v203, 0xffff0000, v129
    v_mfma_f32_16x16x32_bf16 v[216:219], v[64:67], v[236:239], v[216:219]
    v_lshlrev_b32 v208, 16, v130
    v_and_b32 v209, 0xffff0000, v130
    v_mfma_f32_16x16x32_bf16 v[224:227], v[72:75], v[232:235], v[224:227]
    v_lshlrev_b32 v210, 16, v131
    v_and_b32 v211, 0xffff0000, v131
    v_mfma_f32_16x16x32_bf16 v[220:223], v[60:63], v[232:235], 0
    v_lshlrev_b32 v204, 16, v132
    v_and_b32 v205, 0xffff0000, v132
    v_mfma_f32_16x16x32_bf16 v[228:231], v[60:63], v[236:239], 0
    v_lshlrev_b32 v206, 16, v133
    v_and_b32 v207, 0xffff0000, v133
    v_mfma_f32_16x16x32_bf16 v[220:223], v[68:71], v[236:239], v[220:223]
    v_lshlrev_b32 v212, 16, v134
    v_and_b32 v213, 0xffff0000, v134
    v_mfma_f32_16x16x32_bf16 v[228:231], v[76:79], v[232:235], v[228:231]
    v_lshlrev_b32 v214, 16, v135
    v_and_b32 v215, 0xffff0000, v135
    v_pk_mul_f32 v[152:153], v[216:217], v[200:201]
    v_pk_mul_f32 v[156:157], v[224:225], v[200:201]
    v_pk_mul_f32 v[154:155], v[218:219], v[202:203]
    v_pk_mul_f32 v[158:159], v[226:227], v[202:203]
    v_pk_fma_f32 v[152:153], v[224:225], v[208:209], v[152:153] neg_lo:[1,0,0] neg_hi:[1,0,0]
    v_pk_fma_f32 v[156:157], v[216:217], v[208:209], v[156:157]
    v_pk_fma_f32 v[154:155], v[226:227], v[210:211], v[154:155] neg_lo:[1,0,0] neg_hi:[1,0,0]
    v_pk_fma_f32 v[158:159], v[218:219], v[210:211], v[158:159]
    v_cvt_pk_bf16_f32 v240, v152, v153
    v_cvt_pk_bf16_f32 v244, v156, v157
    v_cvt_pk_bf16_f32 v241, v154, v155
    v_cvt_pk_bf16_f32 v245, v158, v159
    v_pk_mul_f32 v[160:161], v[220:221], v[204:205]
    v_pk_mul_f32 v[164:165], v[228:229], v[204:205]
    v_pk_mul_f32 v[162:163], v[222:223], v[206:207]
    v_pk_mul_f32 v[166:167], v[230:231], v[206:207]
    v_pk_fma_f32 v[160:161], v[228:229], v[212:213], v[160:161] neg_lo:[1,0,0] neg_hi:[1,0,0]
    v_pk_fma_f32 v[164:165], v[220:221], v[212:213], v[164:165]
    v_pk_fma_f32 v[162:163], v[230:231], v[214:215], v[162:163] neg_lo:[1,0,0] neg_hi:[1,0,0]
    v_pk_fma_f32 v[166:167], v[222:223], v[214:215], v[166:167]
    v_cvt_pk_bf16_f32 v242, v160, v161
    v_cvt_pk_bf16_f32 v246, v164, v165
    v_cvt_pk_bf16_f32 v243, v162, v163
    v_cvt_pk_bf16_f32 v247, v166, v167
    s_nop 0
    v_mfma_f32_16x16x32_bf16 v[216:219], v[240:243], v[56:59], 0
    v_mfma_f32_16x16x32_bf16 v[224:227], v[244:247], v[56:59], 0
    v_mfma_f32_16x16x32_bf16 v[216:219], v[244:247], v[72:75], v[216:219]
    v_mfma_f32_16x16x32_bf16 v[224:227], v[240:243], v[64:67], v[224:227]
    v_mfma_f32_16x16x32_bf16 v[220:223], v[240:243], v[60:63], 0
    v_mfma_f32_16x16x32_bf16 v[228:231], v[244:247], v[60:63], 0
    v_mfma_f32_16x16x32_bf16 v[220:223], v[244:247], v[76:79], v[220:223]
    v_mfma_f32_16x16x32_bf16 v[228:231], v[240:243], v[68:71], v[228:231]
    s_nop 2
    v_pk_mul_f32 v[152:153], v[216:217], v[96:97]
    v_pk_mul_f32 v[156:157], v[224:225], v[96:97]
    v_pk_mul_f32 v[154:155], v[218:219], v[98:99]
    v_pk_mul_f32 v[158:159], v[226:227], v[98:99]
    v_pk_fma_f32 v[152:153], v[224:225], v[104:105], v[152:153] neg_lo:[1,0,0] neg_hi:[1,0,0]
    v_pk_fma_f32 v[156:157], v[216:217], v[104:105], v[156:157]
    v_pk_fma_f32 v[154:155], v[226:227], v[106:107], v[154:155] neg_lo:[1,0,0] neg_hi:[1,0,0]
    v_pk_fma_f32 v[158:159], v[218:219], v[106:107], v[158:159]
    v_cvt_pk_bf16_f32 v232, v152, v153
    v_cvt_pk_bf16_f32 v236, v156, v157
    v_cvt_pk_bf16_f32 v233, v154, v155
    v_cvt_pk_bf16_f32 v237, v158, v159
    ds_write_b64 v20, v[232:233] offset:8192
    ds_write_b64 v20, v[236:237] offset:12800
    v_pk_mul_f32 v[160:161], v[220:221], v[100:101]
    v_pk_mul_f32 v[164:165], v[228:229], v[100:101]
    v_pk_mul_f32 v[162:163], v[222:223], v[102:103]
    v_pk_mul_f32 v[166:167], v[230:231], v[102:103]
    v_pk_fma_f32 v[160:161], v[228:229], v[108:109], v[160:161] neg_lo:[1,0,0] neg_hi:[1,0,0]
    v_pk_fma_f32 v[164:165], v[220:221], v[108:109], v[164:165]
    v_pk_fma_f32 v[162:163], v[230:231], v[110:111], v[162:163] neg_lo:[1,0,0] neg_hi:[1,0,0]
    v_pk_fma_f32 v[166:167], v[222:223], v[110:111], v[166:167]
    v_cvt_pk_bf16_f32 v234, v160, v161
    v_cvt_pk_bf16_f32 v238, v164, v165
    v_cvt_pk_bf16_f32 v235, v162, v163
    v_cvt_pk_bf16_f32 v239, v166, v167
    ds_write_b64 v20, v[234:235] offset:10496
    ds_write_b64 v20, v[238:239] offset:15104
    s_waitcnt lgkmcnt(0)
    s_barrier
    ds_read_b128 v[168:171], v21 offset:8192
    ds_read_b128 v[172:175], v21 offset:12800
    ds_read_b128 v[176:179], v21 offset:8256
    ds_read_b128 v[180:183], v21 offset:12864
    ds_read_b128 v[184:187], v21 offset:8768
    ds_read_b128 v[188:191], v21 offset:13376
    ds_read_b128 v[192:195], v21 offset:8832
    ds_read_b128 v[196:199], v21 offset:13440
    s_nop 0
    s_waitcnt lgkmcnt(7)
    v_mfma_f32_16x16x32_bf16 v[216:219], v[168:171], v[32:35], 0
    v_mfma_f32_16x16x32_bf16 v[224:227], v[168:171], v[40:43], 0
    s_waitcnt lgkmcnt(6)
    v_mfma_f32_16x16x32_bf16 v[216:219], v[172:175], v[48:51], v[216:219]
    v_mfma_f32_16x16x32_bf16 v[224:227], v[172:175], v[32:35], v[224:227]
    s_waitcnt lgkmcnt(5)
    v_mfma_f32_16x16x32_bf16 v[216:219], v[176:179], v[36:39], v[216:219]
    v_mfma_f32_16x16x32_bf16 v[224:227], v[176:179], v[44:47], v[224:227]
    s_waitcnt lgkmcnt(4)
    v_mfma_f32_16x16x32_bf16 v[216:219], v[180:183], v[52:55], v[216:219]
    v_mfma_f32_16x16x32_bf16 v[224:227], v[180:183], v[36:39], v[224:227]
    s_waitcnt lgkmcnt(3)
    v_mfma_f32_16x16x32_bf16 v[220:223], v[184:187], v[32:35], 0
    v_mfma_f32_16x16x32_bf16 v[228:231], v[184:187], v[40:43], 0
    s_waitcnt lgkmcnt(2)
    v_mfma_f32_16x16x32_bf16 v[220:223], v[188:191], v[48:51], v[220:223]
    s_nop 3
    v_mfma_f32_16x16x32_bf16 v[228:231], v[188:191], v[32:35], v[228:231]
    v_add_f32 v136, v136, v216
    v_fma_f32 v144, v224, s55, v144
    s_waitcnt lgkmcnt(1)
    v_mfma_f32_16x16x32_bf16 v[220:223], v[192:195], v[36:39], v[220:223]
    v_add_f32 v137, v137, v217
    v_fma_f32 v145, v225, s55, v145
    v_mfma_f32_16x16x32_bf16 v[228:231], v[192:195], v[44:47], v[228:231]
    v_add_f32 v138, v138, v218
    v_fma_f32 v146, v226, s55, v146
    v_add_f32 v139, v139, v219
    s_waitcnt lgkmcnt(0)
    v_mfma_f32_16x16x32_bf16 v[220:223], v[196:199], v[52:55], v[220:223]
    v_fma_f32 v147, v227, s55, v147
    v_cvt_pk_bf16_f32 v112, v136, v137
    v_mfma_f32_16x16x32_bf16 v[228:231], v[196:199], v[36:39], v[228:231]
    v_cvt_pk_bf16_f32 v116, v144, v145
    v_cvt_pk_bf16_f32 v113, v138, v139
    v_cvt_pk_bf16_f32 v117, v146, v147
    s_nop 1
    v_add_f32 v140, v140, v220
    s_nop 1
    v_fma_f32 v148, v228, s55, v148
    v_add_f32 v141, v141, v221
    v_fma_f32 v149, v229, s55, v149
    v_add_f32 v142, v142, v222
    v_fma_f32 v150, v230, s55, v150
    v_add_f32 v143, v143, v223
    v_fma_f32 v151, v231, s55, v151
    v_cvt_pk_bf16_f32 v114, v140, v141
    v_cvt_pk_bf16_f32 v118, v148, v149
    v_cvt_pk_bf16_f32 v115, v142, v143
    v_cvt_pk_bf16_f32 v119, v150, v151
    buffer_store_dwordx4 v[112:115], v17, s[44:47], s58 offen sc1
    buffer_store_dwordx4 v[116:119], v17, s[44:47], s58 offen offset:64 sc1
    s_add_u32 s51, s69, 6144
    buffer_load_dword v22, v23, s[44:47], s51 offen sc1
    s_waitcnt vmcnt(1)
    s_barrier
    s_cmp_lg_u32 s3, 0
    s_cbranch_scc1 L_a1_8
    s_add_u32 s51, s69, 8192
    v_mov_b32 v0, 1
    v_mov_b32 v4, 0
    s_mov_b64 exec, 1
    buffer_atomic_add v0, v4, s[44:47], s51 offen sc0 sc1
    s_mov_b64 exec, -1
L_a1_8:
    s_waitcnt vmcnt(0)
    v_cmp_ne_u32 vcc, 8, v22
    s_cbranch_vccz L_b1b_ok
    s_add_u32 s51, s69, 6144
    v_and_b32 v4, 0, v1
    v_lshlrev_b32 v4, 8, v4
L_pl_10:
    buffer_load_dword v3, v4, s[44:47], s51 offen sc1
    s_waitcnt vmcnt(0)
    v_cmp_ne_u32 vcc, 8, v3
    s_cbranch_vccz L_pw_9
    s_sub_u32 s48, s48, 1
    s_cbranch_scc1 L_pw_9_t
    s_sleep 1
    s_branch L_pl_10
L_pw_9_t:
    s_mov_b32 s48, 0
L_pw_9:
L_b1b_ok:
    s_lshl_b32 s51, s63, 8
    s_lshl_b32 s52, s3, 6
    s_add_u32 s51, s51, s52
    v_lshlrev_b32 v3, 1, v5
    buffer_load_ushort v76, v3, s[24:27], s51 offen
    s_add_u32 s59, s3, 0
    s_and_b32 s59, s59, 3
    s_lshl_b32 s59, s59, 13
    s_add_u32 s59, s59, s68
    buffer_load_dwordx4 a[0:3], v2, s[44:47], s59 offen offset:0 sc1
    buffer_load_dwordx4 a[4:7], v2, s[44:47], s59 offen offset:1024 sc1
    buffer_load_dwordx4 a[8:11], v2, s[44:47], s59 offen offset:2048 sc1
    buffer_load_dwordx4 a[12:15], v2, s[44:47], s59 offen offset:3072 sc1
    s_cmp_lg_u32 s3, 0
    s_cbranch_scc1 L_a2_11
    s_waitcnt vmcnt(5)
    v_readfirstlane_b32 s49, v0
    s_nop 0
    s_cmp_lg_u32 s49, 31
    s_cbranch_scc1 L_a2_11
    s_mov_b32 s49, 10240
    v_mov_b32 v0, 1
    v_lshlrev_b32 v4, 8, v1
    s_mov_b64 exec, 0xff
    buffer_atomic_add v0, v4, s[44:47], s49 offen sc1
    s_mov_b64 exec, -1
L_a2_11:
    s_add_u32 s59, s59, 4096
    buffer_load_dwordx4 a[16:19], v2, s[44:47], s59 offen offset:0 sc1
    buffer_load_dwordx4 a[20:23], v2, s[44:47], s59 offen offset:1024 sc1
    buffer_load_dwordx4 a[24:27], v2, s[44:47], s59 offen offset:2048 sc1
    buffer_load_dwordx4 a[28:31], v2, s[44:47], s59 offen offset:3072 sc1
    s_add_u32 s59, s3, 1
    s_and_b32 s59, s59, 3
    s_lshl_b32 s59, s59, 13
    s_add_u32 s59, s59, s68
    buffer_load_dwordx4 a[32:35], v2, s[44:47], s59 offen offset:0 sc1
    buffer_load_dwordx4 a[36:39], v2, s[44:47], s59 offen offset:1024 sc1
    buffer_load_dwordx4 a[40:43], v2, s[44:47], s59 offen offset:2048 sc1
    buffer_load_dwordx4 a[44:47], v2, s[44:47], s59 offen offset:3072 sc1
    s_add_u32 s59, s59, 4096
    buffer_load_dwordx4 a[48:51], v2, s[44:47], s59 offen offset:0 sc1
    buffer_load_dwordx4 a[52:55], v2, s[44:47], s59 offen offset:1024 sc1
    buffer_load_dwordx4 a[56:59], v2, s[44:47], s59 offen offset:2048 sc1
    buffer_load_dwordx4 a[60:63], v2, s[44:47], s59 offen offset:3072 sc1
    s_add_u32 s59, s3, 2
    s_and_b32 s59, s59, 3
    s_lshl_b32 s59, s59, 13
    s_add_u32 s59, s59, s68
    buffer_load_dwordx4 a[64:67], v2, s[44:47], s59 offen offset:0 sc1
    buffer_load_dwordx4 a[68:71], v2, s[44:47], s59 offen offset:1024 sc1
    buffer_load_dwordx4 a[72:75], v2, s[44:47], s59 offen offset:2048 sc1
    buffer_load_dwordx4 a[76:79], v2, s[44:47], s59 offen offset:3072 sc1
    s_add_u32 s59, s59, 4096
    buffer_load_dwordx4 a[80:83], v2, s[44:47], s59 offen offset:0 sc1
    buffer_load_dwordx4 a[84:87], v2, s[44:47], s59 offen offset:1024 sc1
    buffer_load_dwordx4 a[88:91], v2, s[44:47], s59 offen offset:2048 sc1
    buffer_load_dwordx4 a[92:95], v2, s[44:47], s59 offen offset:3072 sc1
    s_add_u32 s59, s3, 3
    s_and_b32 s59, s59, 3
    s_lshl_b32 s59, s59, 13
    s_add_u32 s59, s59, s68
    buffer_load_dwordx4 a[96:99], v2, s[44:47], s59 offen offset:0 sc1
    buffer_load_dwordx4 a[100:103], v2, s[44:47], s59 offen offset:1024 sc1
    buffer_load_dwordx4 a[104:107], v2, s[44:47], s59 offen offset:2048 sc1
    buffer_load_dwordx4 a[108:111], v2, s[44:47], s59 offen offset:3072 sc1
    s_add_u32 s59, s59, 4096
    buffer_load_dwordx4 a[112:115], v2, s[44:47], s59 offen offset:0 sc1
    buffer_load_dwordx4 a[116:119], v2, s[44:47], s59 offen offset:1024 sc1
    buffer_load_dwordx4 a[120:123], v2, s[44:47], s59 offen offset:2048 sc1
    buffer_load_dwordx4 a[124:127], v2, s[44:47], s59 offen offset:3072 sc1
    v_lshrrev_b32 v30, 5, v1
    v_bfe_u32 v31, v1, 2, 2
    v_lshl_add_u32 v30, v30, 3, v31
    v_lshlrev_b32 v100, 6, v30
    v_and_b32 v30, 16, v1
    v_lshl_add_u32 v100, v30, 1, v100
    v_and_b32 v30, 3, v1
    v_lshl_add_u32 v100, v30, 3, v100
    v_mov_b32 v4, v100
    s_add_u32 s52, s3, 0
    s_and_b32 s52, s52, 3
    s_lshl_b32 s52, s52, 13
    v_add_u32 v100, s52, v4
    s_add_u32 s52, s3, 1
    s_and_b32 s52, s52, 3
    s_lshl_b32 s52, s52, 13
    v_add_u32 v101, s52, v4
    s_add_u32 s52, s3, 2
    s_and_b32 s52, s52, 3
    s_lshl_b32 s52, s52, 13
    v_add_u32 v102, s52, v4
    s_add_u32 s52, s3, 3
    s_and_b32 s52, s52, 3
    s_lshl_b32 s52, s52, 13
    v_add_u32 v103, s52, v4
    v_lshl_add_u32 v3, s3, 1, v6
    v_cmp_eq_u32 vcc, 7, v3
    v_mov_b32 v4, 0xffff
    v_mov_b32 v77, 0
    v_cndmask_b32 v7, -1, v4, vcc
    s_lshl_b32 s51, s3, 8
    s_add_u32 s51, s51, 131072
    v_lshl_add_u32 v10, v1, 2, s51
    v_and_b32 v3, 31, v1
    v_lshlrev_b32 v13, 2, v3
    v_add_u32 v11, 131072, v13
    v_add_u32 v12, 132096, v13
    v_and_b32 v3, 1, v1
    v_cmp_ne_u32 s[56:57], 0, v3
    v_and_b32 v3, 2, v1
    v_cmp_ne_u32 s[58:59], 0, v3
    v_mov_b32 v78, 0
    v_mov_b32 v79, 0
    v_mov_b32 v81, 0
    v_mov_b32 v82, 0
    v_mov_b32 v83, 0
    s_cmp_ge_u32 s63, 11
    s_cselect_b32 s51, 0x80008000, 0
    s_cselect_b32 s52, 0, 0xffff
    s_mov_b32 s55, 90112
    s_cmov_b32 s55, 32768
    s_mov_b32 s54, 13631488
    s_cmov_b32 s54, 11444224
    v_mov_b32 v8, s51
    v_cmp_eq_u32 vcc, 0, v6
    v_mov_b32 v4, s52
    s_lshl_b32 s52, s62, 2
    v_cndmask_b32 v9, 0, v4, vcc
    s_mul_i32 s52, s52, s55
    s_add_u32 s54, s54, s52
    s_lshl_b32 s52, s63, 13
    s_add_u32 s54, s54, s52
    s_lshl_b32 s52, s3, 11
    s_add_u32 s54, s54, s52
    s_lshl_b32 s60, s63, 2
    s_add_u32 s60, s60, s3
    s_lshl_b32 s60, s60, 13
    s_lshl_b32 s52, s62, 9
    s_add_u32 s60, s60, s52
    s_add_u32 s60, s60, 131072
    s_lshl_b32 s53, s62, 8
    s_add_u32 s53, s53, 16384
    s_lshl_b32 s61, s66, 8
    s_add_u32 s61, s61, 16384
    s_lshl_b32 s50, s62, 17
    s_lshl_b32 s52, s3, 13
    s_add_u32 s50, s50, s52
    s_add_u32 s50, s50, 5242880
    s_mov_b32 m0, s52
    s_add_u32 s51, s69, 10240
    s_cmp_lg_u32 s3, 0
    s_cbranch_scc1 L_pw_12
    v_and_b32 v4, 0, v1
    v_lshlrev_b32 v4, 8, v4
L_pl_13:
    buffer_load_dword v3, v4, s[44:47], s51 offen sc1
    s_waitcnt vmcnt(0)
    v_cmp_ne_u32 vcc, 8, v3
    s_cbranch_vccz L_pw_12
    s_sub_u32 s48, s48, 1
    s_cbranch_scc1 L_pw_12_t
    s_sleep 1
    s_branch L_pl_13
L_pw_12_t:
    s_mov_b32 s48, 0
L_pw_12:
    s_barrier
    s_cmp_eq_u32 s63, 15
    s_cbranch_scc1 L_p3_skip
    buffer_load_dwordx4 v2, s[44:47], s50 offen offset:0 sc1 lds
    buffer_load_dwordx4 v2, s[44:47], s50 offen offset:1024 sc1 lds
    buffer_load_dwordx4 v2, s[44:47], s50 offen offset:2048 sc1 lds
    buffer_load_dwordx4 v2, s[44:47], s50 offen offset:3072 sc1 lds
    s_add_u32 m0, m0, 4096
    s_add_u32 s50, s50, 4096
    buffer_load_dwordx4 v2, s[44:47], s50 offen offset:0 sc1 lds
    buffer_load_dwordx4 v2, s[44:47], s50 offen offset:1024 sc1 lds
    buffer_load_dwordx4 v2, s[44:47], s50 offen offset:2048 sc1 lds
    buffer_load_dwordx4 v2, s[44:47], s50 offen offset:3072 sc1 lds
    s_add_u32 m0, m0, 28672
    s_add_u32 s50, s50, 28672
    s_waitcnt vmcnt(6)
    ds_read_b64_tr_b16 v[112:113], v100 offset:0
    ds_read_b64_tr_b16 v[114:115], v100 offset:256
    ds_read_b64_tr_b16 v[116:117], v100 offset:1024
    ds_read_b64_tr_b16 v[118:119], v100 offset:1280
    s_waitcnt vmcnt(4)
    ds_read_b64_tr_b16 v[120:121], v100 offset:2048
    ds_read_b64_tr_b16 v[122:123], v100 offset:2304
    ds_read_b64_tr_b16 v[124:125], v100 offset:3072
    ds_read_b64_tr_b16 v[126:127], v100 offset:3328
    s_waitcnt vmcnt(2)
    ds_read_b64_tr_b16 v[128:129], v100 offset:4096
    ds_read_b64_tr_b16 v[130:131], v100 offset:4352
    ds_read_b64_tr_b16 v[132:133], v100 offset:5120
    ds_read_b64_tr_b16 v[134:135], v100 offset:5376
    s_waitcnt vmcnt(0)
    s_waitcnt lgkmcnt(8)
    v_mfma_f32_32x32x16_bf16 v[16:31], a[0:3], v[112:115], 0
    v_mfma_f32_4x4x4_16b_bf16 v[72:75], v[112:113], v[112:113], 0
    ds_read_b64_tr_b16 v[136:137], v100 offset:6144
    ds_read_b64_tr_b16 v[138:139], v100 offset:6400
    v_mfma_f32_4x4x4_16b_bf16 v[72:75], v[114:115], v[114:115], v[72:75]
    buffer_load_dwordx4 v2, s[44:47], s50 offen offset:0 sc1 lds
    v_mfma_f32_32x32x16_bf16 v[16:31], a[4:7], v[116:119], v[16:31]
    v_mfma_f32_4x4x4_16b_bf16 v[72:75], v[116:117], v[116:117], v[72:75]
    ds_read_b64_tr_b16 v[140:141], v100 offset:7168
    ds_read_b64_tr_b16 v[142:143], v100 offset:7424
    v_mfma_f32_4x4x4_16b_bf16 v[72:75], v[118:119], v[118:119], v[72:75]
    buffer_load_dwordx4 v2, s[44:47], s50 offen offset:1024 sc1 lds
    s_barrier
    s_waitcnt lgkmcnt(8)
    v_mfma_f32_32x32x16_bf16 v[16:31], a[8:11], v[120:123], v[16:31]
    v_mfma_f32_4x4x4_16b_bf16 v[72:75], v[120:121], v[120:121], v[72:75]
    ds_read_b64_tr_b16 v[112:113], v101 offset:0
    ds_read_b64_tr_b16 v[114:115], v101 offset:256
    v_mfma_f32_4x4x4_16b_bf16 v[72:75], v[122:123], v[122:123], v[72:75]
    buffer_load_dwordx4 v2, s[44:47], s50 offen offset:2048 sc1 lds
    v_mfma_f32_32x32x16_bf16 v[16:31], a[12:15], v[124:127], v[16:31]
    v_mfma_f32_4x4x4_16b_bf16 v[72:75], v[124:125], v[124:125], v[72:75]
    ds_read_b64_tr_b16 v[116:117], v101 offset:1024
    ds_read_b64_tr_b16 v[118:119], v101 offset:1280
    v_mfma_f32_4x4x4_16b_bf16 v[72:75], v[126:127], v[126:127], v[72:75]
    buffer_load_dwordx4 v2, s[44:47], s50 offen offset:3072 sc1 lds
    s_add_u32 m0, m0, 4096
    s_add_u32 s50, s50, 4096
    s_waitcnt lgkmcnt(8)
    v_mfma_f32_32x32x16_bf16 v[16:31], a[16:19], v[128:131], v[16:31]
    v_mfma_f32_4x4x4_16b_bf16 v[72:75], v[128:129], v[128:129], v[72:75]
    ds_read_b64_tr_b16 v[120:121], v101 offset:2048
    ds_read_b64_tr_b16 v[122:123], v101 offset:2304
    v_mfma_f32_4x4x4_16b_bf16 v[72:75], v[130:131], v[130:131], v[72:75]
    buffer_load_dwordx4 v2, s[44:47], s50 offen offset:0 sc1 lds
    v_mfma_f32_32x32x16_bf16 v[16:31], a[20:23], v[132:135], v[16:31]
    v_mfma_f32_4x4x4_16b_bf16 v[72:75], v[132:133], v[132:133], v[72:75]
    ds_read_b64_tr_b16 v[124:125], v101 offset:3072
    ds_read_b64_tr_b16 v[126:127], v101 offset:3328
    v_mfma_f32_4x4x4_16b_bf16 v[72:75], v[134:135], v[134:135], v[72:75]
    buffer_load_dwordx4 v2, s[44:47], s50 offen offset:1024 sc1 lds
    s_waitcnt lgkmcnt(8)
    v_mfma_f32_32x32x16_bf16 v[16:31], a[24:27], v[136:139], v[16:31]
    v_mfma_f32_4x4x4_16b_bf16 v[72:75], v[136:137], v[136:137], v[72:75]
    ds_read_b64_tr_b16 v[128:129], v101 offset:4096
    ds_read_b64_tr_b16 v[130:131], v101 offset:4352
    v_mfma_f32_4x4x4_16b_bf16 v[72:75], v[138:139], v[138:139], v[72:75]
    buffer_load_dwordx4 v2, s[44:47], s50 offen offset:2048 sc1 lds
    v_mfma_f32_32x32x16_bf16 v[16:31], a[28:31], v[140:143], v[16:31]
    v_mov_b32 v56, v142
    v_and_b32 v57, v7, v143
    v_mfma_f32_4x4x4_16b_bf16 v[72:75], v[140:141], v[140:141], v[72:75]
    ds_read_b64_tr_b16 v[132:133], v101 offset:5120
    ds_read_b64_tr_b16 v[134:135], v101 offset:5376
    v_mfma_f32_4x4x4_16b_bf16 v[72:75], v[56:57], v[56:57], v[72:75]
    buffer_load_dwordx4 v2, s[44:47], s50 offen offset:3072 sc1 lds
    s_add_u32 m0, m0, 28672
    s_add_u32 s50, s50, 28672
    s_waitcnt lgkmcnt(8)
    v_mfma_f32_32x32x16_bf16 v[16:31], a[32:35], v[112:115], v[16:31]
    ds_read_b64_tr_b16 v[136:137], v101 offset:6144
    ds_read_b64_tr_b16 v[138:139], v101 offset:6400
    v_mfma_f32_32x32x16_bf16 v[16:31], a[36:39], v[116:119], v[16:31]
    ds_read_b64_tr_b16 v[140:141], v101 offset:7168
    ds_read_b64_tr_b16 v[142:143], v101 offset:7424
    v_cndmask_b32 v56, v72, v73, s[56:57]
    v_cndmask_b32 v57, v74, v75, s[56:57]
    v_cndmask_b32 v56, v56, v57, s[58:59]
    ds_write_b32 v10, v56 offset:0
    s_waitcnt lgkmcnt(9)
    v_mfma_f32_32x32x16_bf16 v[16:31], a[40:43], v[120:123], v[16:31]
    ds_read_b64_tr_b16 v[112:113], v102 offset:0
    ds_read_b64_tr_b16 v[114:115], v102 offset:256
    v_mfma_f32_32x32x16_bf16 v[16:31], a[44:47], v[124:127], v[16:31]
    ds_read_b64_tr_b16 v[116:117], v102 offset:1024
    ds_read_b64_tr_b16 v[118:119], v102 offset:1280
    s_waitcnt lgkmcnt(9)
    v_mfma_f32_32x32x16_bf16 v[16:31], a[48:51], v[128:131], v[16:31]
    ds_read_b64_tr_b16 v[120:121], v102 offset:2048
    ds_read_b64_tr_b16 v[122:123], v102 offset:2304
    v_mfma_f32_32x32x16_bf16 v[16:31], a[52:55], v[132:135], v[16:31]
    ds_read_b64_tr_b16 v[124:125], v102 offset:3072
    ds_read_b64_tr_b16 v[126:127], v102 offset:3328
    s_waitcnt lgkmcnt(8)
    s_waitcnt vmcnt(0)
    s_barrier
    ds_read2_b32 v[48:49], v11 offset0:0 offset1:32
    ds_read2_b32 v[50:51], v11 offset0:64 offset1:96
    ds_read2_b32 v[52:53], v11 offset0:128 offset1:160
    ds_read2_b32 v[54:55], v11 offset0:192 offset1:224
    v_mfma_f32_32x32x16_bf16 v[16:31], a[56:59], v[136:139], v[16:31]
    ds_read_b64_tr_b16 v[128:129], v102 offset:4096
    ds_read_b64_tr_b16 v[130:131], v102 offset:4352
    buffer_load_dwordx4 v2, s[44:47], s50 offen offset:0 sc1 lds
    v_mfma_f32_32x32x16_bf16 v[16:31], a[60:63], v[140:143], v[16:31]
    ds_read_b64_tr_b16 v[132:133], v102 offset:5120
    ds_read_b64_tr_b16 v[134:135], v102 offset:5376
    s_waitcnt lgkmcnt(12)
    v_mfma_f32_32x32x16_bf16 v[16:31], a[64:67], v[112:115], v[16:31]
    ds_read_b64_tr_b16 v[136:137], v102 offset:6144
    ds_read_b64_tr_b16 v[138:139], v102 offset:6400
    buffer_load_dwordx4 v2, s[44:47], s50 offen offset:1024 sc1 lds
    v_mfma_f32_32x32x16_bf16 v[16:31], a[68:71], v[116:119], v[16:31]
    ds_read_b64_tr_b16 v[140:141], v102 offset:7168
    ds_read_b64_tr_b16 v[142:143], v102 offset:7424
    s_waitcnt lgkmcnt(12)
    v_mfma_f32_32x32x16_bf16 v[16:31], a[72:75], v[120:123], v[16:31]
    ds_read_b64_tr_b16 v[112:113], v103 offset:0
    ds_read_b64_tr_b16 v[114:115], v103 offset:256
    s_waitcnt lgkmcnt(10)
    buffer_load_dwordx4 v2, s[44:47], s50 offen offset:2048 sc1 lds
    v_add_f32 v48, v48, v49
    v_mfma_f32_32x32x16_bf16 v[16:31], a[76:79], v[124:127], v[16:31]
    ds_read_b64_tr_b16 v[116:117], v103 offset:1024
    ds_read_b64_tr_b16 v[118:119], v103 offset:1280
    v_add_f32 v50, v50, v51
    v_add_f32 v52, v52, v53
    s_waitcnt lgkmcnt(8)
    v_mfma_f32_32x32x16_bf16 v[16:31], a[80:83], v[128:131], v[16:31]
    ds_read_b64_tr_b16 v[120:121], v103 offset:2048
    ds_read_b64_tr_b16 v[122:123], v103 offset:2304
    buffer_load_dwordx4 v2, s[44:47], s50 offen offset:3072 sc1 lds
    s_add_u32 m0, m0, 4096
    s_add_u32 s50, s50, 4096
    v_add_f32 v54, v54, v55
    v_mfma_f32_32x32x16_bf16 v[16:31], a[84:87], v[132:135], v[16:31]
    ds_read_b64_tr_b16 v[124:125], v103 offset:3072
    ds_read_b64_tr_b16 v[126:127], v103 offset:3328
    v_add_f32 v48, v48, v50
    v_add_f32 v52, v52, v54
    s_waitcnt lgkmcnt(8)
    v_mfma_f32_32x32x16_bf16 v[16:31], a[88:91], v[136:139], v[16:31]
    ds_read_b64_tr_b16 v[128:129], v103 offset:4096
    ds_read_b64_tr_b16 v[130:131], v103 offset:4352
    buffer_load_dwordx4 v2, s[44:47], s50 offen offset:0 sc1 lds
    v_add_f32 v14, v48, v52
    v_mfma_f32_32x32x16_bf16 v[16:31], a[92:95], v[140:143], v[16:31]
    ds_read_b64_tr_b16 v[132:133], v103 offset:5120
    ds_read_b64_tr_b16 v[134:135], v103 offset:5376
    v_mul_f32 v14, 0x3b000000, v14
    v_cvt_pk_bf16_f32 v14, v14, v14
    s_waitcnt lgkmcnt(8)
    v_mfma_f32_32x32x16_bf16 v[16:31], a[96:99], v[112:115], v[16:31]
    ds_read_b64_tr_b16 v[136:137], v103 offset:6144
    ds_read_b64_tr_b16 v[138:139], v103 offset:6400
    buffer_load_dwordx4 v2, s[44:47], s50 offen offset:1024 sc1 lds
    v_lshlrev_b32 v14, 16, v14
    v_mfma_f32_32x32x16_bf16 v[16:31], a[100:103], v[116:119], v[16:31]
    ds_read_b64_tr_b16 v[140:141], v103 offset:7168
    ds_read_b64_tr_b16 v[142:143], v103 offset:7424
    v_add_f32 v14, 0x3727c5ac, v14
    v_cvt_pk_bf16_f32 v14, v14, v14
    s_waitcnt lgkmcnt(8)
    v_mfma_f32_32x32x16_bf16 v[16:31], a[104:107], v[120:123], v[16:31]
    ds_read_b64_tr_b16 v[112:113], v100 offset:32768
    ds_read_b64_tr_b16 v[114:115], v100 offset:33024
    buffer_load_dwordx4 v2, s[44:47], s50 offen offset:2048 sc1 lds
    v_lshlrev_b32 v14, 16, v14
    v_mfma_f32_32x32x16_bf16 v[16:31], a[108:111], v[124:127], v[16:31]
    ds_read_b64_tr_b16 v[116:117], v100 offset:33792
    ds_read_b64_tr_b16 v[118:119], v100 offset:34048
    v_sqrt_f32 v14, v14
    s_nop 0
    v_cvt_pk_bf16_f32 v14, v14, v14
    s_waitcnt lgkmcnt(8)
    v_mfma_f32_32x32x16_bf16 v[16:31], a[112:115], v[128:131], v[16:31]
    ds_read_b64_tr_b16 v[120:121], v100 offset:34816
    ds_read_b64_tr_b16 v[122:123], v100 offset:35072
    buffer_load_dwordx4 v2, s[44:47], s50 offen offset:3072 sc1 lds
    s_add_u32 m0, m0, 28672
    s_add_u32 s50, s50, 28672
    v_and_b32 v80, v9, v14
    v_mfma_f32_32x32x16_bf16 v[16:31], a[116:119], v[132:135], v[16:31]
    ds_read_b64_tr_b16 v[124:125], v100 offset:35840
    ds_read_b64_tr_b16 v[126:127], v100 offset:36096
    buffer_load_dwordx4 a[128:131], v2, s[44:47], s67 offen offset:0 sc1
    buffer_store_dword v14, v13, s[44:47], s60 offen offset:0 sc1
    s_waitcnt lgkmcnt(8)
    v_mfma_f32_32x32x16_bf16 v[16:31], a[120:123], v[136:139], v[16:31]
    ds_read_b64_tr_b16 v[128:129], v100 offset:36864
    ds_read_b64_tr_b16 v[130:131], v100 offset:37120
    buffer_load_dwordx4 a[132:135], v2, s[44:47], s67 offen offset:1024 sc1
    v_mfma_f32_32x32x16_bf16 v[16:31], a[124:127], v[140:143], v[16:31]
    ds_read_b64_tr_b16 v[132:133], v100 offset:37888
    ds_read_b64_tr_b16 v[134:135], v100 offset:38144
    buffer_load_dwordx4 a[136:139], v2, s[44:47], s67 offen offset:2048 sc1
    v_mfma_f32_32x32x16_bf16 v[16:31], v[76:79], v[80:83], v[16:31]
    s_waitcnt lgkmcnt(8)
    v_mfma_f32_32x32x16_bf16 v[32:47], a[0:3], v[112:115], 0
    v_mfma_f32_4x4x4_16b_bf16 v[72:75], v[112:113], v[112:113], 0
    ds_read_b64_tr_b16 v[136:137], v100 offset:38912
    ds_read_b64_tr_b16 v[138:139], v100 offset:39168
    v_mfma_f32_4x4x4_16b_bf16 v[72:75], v[114:115], v[114:115], v[72:75]
    buffer_load_dwordx4 a[140:143], v2, s[44:47], s67 offen offset:3072 sc1
    s_add_u32 s67, s67, 4096
    v_mfma_f32_32x32x16_bf16 v[32:47], a[4:7], v[116:119], v[32:47]
    v_mfma_f32_4x4x4_16b_bf16 v[72:75], v[116:117], v[116:117], v[72:75]
    ds_read_b64_tr_b16 v[140:141], v100 offset:39936
    ds_read_b64_tr_b16 v[142:143], v100 offset:40192
    v_mfma_f32_4x4x4_16b_bf16 v[72:75], v[118:119], v[118:119], v[72:75]
    buffer_load_dwordx4 a[144:147], v2, s[44:47], s67 offen offset:0 sc1
    s_waitcnt lgkmcnt(8)
    v_mfma_f32_32x32x16_bf16 v[32:47], a[8:11], v[120:123], v[32:47]
    v_mfma_f32_4x4x4_16b_bf16 v[72:75], v[120:121], v[120:121], v[72:75]
    ds_read_b64_tr_b16 v[112:113], v101 offset:32768
    ds_read_b64_tr_b16 v[114:115], v101 offset:33024
    v_mfma_f32_4x4x4_16b_bf16 v[72:75], v[122:123], v[122:123], v[72:75]
    buffer_load_dwordx4 a[148:151], v2, s[44:47], s67 offen offset:1024 sc1
    v_mul_f32 v16, v16, |v16|
    v_mul_f32 v17, v17, |v17|
    v_mfma_f32_32x32x16_bf16 v[32:47], a[12:15], v[124:127], v[32:47]
    v_mfma_f32_4x4x4_16b_bf16 v[72:75], v[124:125], v[124:125], v[72:75]
    ds_read_b64_tr_b16 v[116:117], v101 offset:33792
    ds_read_b64_tr_b16 v[118:119], v101 offset:34048
    v_mfma_f32_4x4x4_16b_bf16 v[72:75], v[126:127], v[126:127], v[72:75]
    buffer_load_dwordx4 a[152:155], v2, s[44:47], s67 offen offset:2048 sc1
    v_mul_f32 v18, v18, |v18|
    v_mul_f32 v19, v19, |v19|
    s_waitcnt lgkmcnt(8)
    v_mfma_f32_32x32x16_bf16 v[32:47], a[16:19], v[128:131], v[32:47]
    v_mfma_f32_4x4x4_16b_bf16 v[72:75], v[128:129], v[128:129], v[72:75]
    ds_read_b64_tr_b16 v[120:121], v101 offset:34816
    ds_read_b64_tr_b16 v[122:123], v101 offset:35072
    v_mfma_f32_4x4x4_16b_bf16 v[72:75], v[130:131], v[130:131], v[72:75]
    buffer_load_dwordx4 a[156:159], v2, s[44:47], s67 offen offset:3072 sc1
    s_add_u32 s67, s67, 4096
    v_mul_f32 v20, v20, |v20|
    v_mul_f32 v21, v21, |v21|
    v_mfma_f32_32x32x16_bf16 v[32:47], a[20:23], v[132:135], v[32:47]
    v_mfma_f32_4x4x4_16b_bf16 v[72:75], v[132:133], v[132:133], v[72:75]
    ds_read_b64_tr_b16 v[124:125], v101 offset:35840
    ds_read_b64_tr_b16 v[126:127], v101 offset:36096
    v_mfma_f32_4x4x4_16b_bf16 v[72:75], v[134:135], v[134:135], v[72:75]
    buffer_load_dwordx4 a[160:163], v2, s[44:47], s67 offen offset:0 sc1
    v_mul_f32 v22, v22, |v22|
    v_mul_f32 v23, v23, |v23|
    s_waitcnt lgkmcnt(8)
    v_mfma_f32_32x32x16_bf16 v[32:47], a[24:27], v[136:139], v[32:47]
    v_mfma_f32_4x4x4_16b_bf16 v[72:75], v[136:137], v[136:137], v[72:75]
    ds_read_b64_tr_b16 v[128:129], v101 offset:36864
    ds_read_b64_tr_b16 v[130:131], v101 offset:37120
    v_mfma_f32_4x4x4_16b_bf16 v[72:75], v[138:139], v[138:139], v[72:75]
    buffer_load_dwordx4 a[164:167], v2, s[44:47], s67 offen offset:1024 sc1
    v_cvt_pk_bf16_f32 v92, v16, v17
    v_cvt_pk_bf16_f32 v93, v18, v19
    v_mfma_f32_32x32x16_bf16 v[32:47], a[28:31], v[140:143], v[32:47]
    v_mov_b32 v56, v142
    v_and_b32 v57, v7, v143
    v_mfma_f32_4x4x4_16b_bf16 v[72:75], v[140:141], v[140:141], v[72:75]
    ds_read_b64_tr_b16 v[132:133], v101 offset:37888
    ds_read_b64_tr_b16 v[134:135], v101 offset:38144
    v_mfma_f32_4x4x4_16b_bf16 v[72:75], v[56:57], v[56:57], v[72:75]
    buffer_load_dwordx4 a[168:171], v2, s[44:47], s67 offen offset:2048 sc1
    v_cvt_pk_bf16_f32 v94, v20, v21
    v_cvt_pk_bf16_f32 v95, v22, v23
    s_waitcnt lgkmcnt(8)
    v_mfma_f32_32x32x16_bf16 v[32:47], a[32:35], v[112:115], v[32:47]
    ds_read_b64_tr_b16 v[136:137], v101 offset:38912
    ds_read_b64_tr_b16 v[138:139], v101 offset:39168
    v_pk_max_i16 v92, v92, v8
    v_pk_max_i16 v93, v93, v8
    v_pk_max_i16 v94, v94, v8
    v_pk_max_i16 v95, v95, v8
    v_mfma_f32_32x32x16_bf16 v[32:47], a[36:39], v[116:119], v[32:47]
    ds_read_b64_tr_b16 v[140:141], v101 offset:39936
    ds_read_b64_tr_b16 v[142:143], v101 offset:40192
    v_cndmask_b32 v56, v72, v73, s[56:57]
    v_cndmask_b32 v57, v74, v75, s[56:57]
    v_cndmask_b32 v56, v56, v57, s[58:59]
    ds_write_b32 v10, v56 offset:1024
    s_waitcnt lgkmcnt(9)
    v_mfma_f32_32x32x16_bf16 v[32:47], a[40:43], v[120:123], v[32:47]
    ds_read_b64_tr_b16 v[112:113], v102 offset:32768
    ds_read_b64_tr_b16 v[114:115], v102 offset:33024
    buffer_load_dwordx4 a[172:175], v2, s[44:47], s67 offen offset:3072 sc1
    s_add_u32 s67, s67, 4096
    buffer_store_dwordx4 v[92:95], v2, s[44:47], s54 offen offset:0 sc1
    v_mul_f32 v24, v24, |v24|
    v_mul_f32 v25, v25, |v25|
    v_mfma_f32_32x32x16_bf16 v[32:47], a[44:47], v[124:127], v[32:47]
    ds_read_b64_tr_b16 v[116:117], v102 offset:33792
    ds_read_b64_tr_b16 v[118:119], v102 offset:34048
    v_mul_f32 v26, v26, |v26|
    v_mul_f32 v27, v27, |v27|
    v_mul_f32 v28, v28, |v28|
    v_mul_f32 v29, v29, |v29|
    s_waitcnt lgkmcnt(9)
    v_mfma_f32_32x32x16_bf16 v[32:47], a[48:51], v[128:131], v[32:47]
    ds_read_b64_tr_b16 v[120:121], v102 offset:34816
    ds_read_b64_tr_b16 v[122:123], v102 offset:35072
    buffer_load_dwordx4 a[176:179], v2, s[44:47], s67 offen offset:0 sc1
    v_mul_f32 v30, v30, |v30|
    v_mul_f32 v31, v31, |v31|
    v_cvt_pk_bf16_f32 v96, v24, v25
    v_mfma_f32_32x32x16_bf16 v[32:47], a[52:55], v[132:135], v[32:47]
    ds_read_b64_tr_b16 v[124:125], v102 offset:35840
    ds_read_b64_tr_b16 v[126:127], v102 offset:36096
    s_waitcnt lgkmcnt(8)
    s_waitcnt vmcnt(15)
    s_barrier
    ds_read2_b32 v[48:49], v12 offset0:0 offset1:32
    ds_read2_b32 v[50:51], v12 offset0:64 offset1:96
    ds_read2_b32 v[52:53], v12 offset0:128 offset1:160
    ds_read2_b32 v[54:55], v12 offset0:192 offset1:224
    v_mfma_f32_32x32x16_bf16 v[32:47], a[56:59], v[136:139], v[32:47]
    ds_read_b64_tr_b16 v[128:129], v102 offset:36864
    ds_read_b64_tr_b16 v[130:131], v102 offset:37120
    buffer_load_dwordx4 v2, s[44:47], s50 offen offset:0 sc1 lds
    v_cvt_pk_bf16_f32 v97, v26, v27
    v_cvt_pk_bf16_f32 v98, v28, v29
    v_cvt_pk_bf16_f32 v99, v30, v31
    v_mfma_f32_32x32x16_bf16 v[32:47], a[60:63], v[140:143], v[32:47]
    ds_read_b64_tr_b16 v[132:133], v102 offset:37888
    ds_read_b64_tr_b16 v[134:135], v102 offset:38144
    v_pk_max_i16 v96, v96, v8
    v_pk_max_i16 v97, v97, v8
    v_pk_max_i16 v98, v98, v8
    v_pk_max_i16 v99, v99, v8
    s_waitcnt lgkmcnt(12)
    v_mfma_f32_32x32x16_bf16 v[32:47], a[64:67], v[112:115], v[32:47]
    ds_read_b64_tr_b16 v[136:137], v102 offset:38912
    ds_read_b64_tr_b16 v[138:139], v102 offset:39168
    buffer_load_dwordx4 v2, s[44:47], s50 offen offset:1024 sc1 lds
    buffer_store_dwordx4 v[96:99], v2, s[44:47], s54 offen offset:1024 sc1
    s_add_u32 s54, s54, s55
    v_mfma_f32_32x32x16_bf16 v[32:47], a[68:71], v[116:119], v[32:47]
    ds_read_b64_tr_b16 v[140:141], v102 offset:39936
    ds_read_b64_tr_b16 v[142:143], v102 offset:40192
    s_waitcnt lgkmcnt(12)
    v_mfma_f32_32x32x16_bf16 v[32:47], a[72:75], v[120:123], v[32:47]
    ds_read_b64_tr_b16 v[112:113], v103 offset:32768
    ds_read_b64_tr_b16 v[114:115], v103 offset:33024
    s_waitcnt lgkmcnt(10)
    buffer_load_dwordx4 v2, s[44:47], s50 offen offset:2048 sc1 lds
    v_add_f32 v48, v48, v49
    v_mfma_f32_32x32x16_bf16 v[32:47], a[76:79], v[124:127], v[32:47]
    ds_read_b64_tr_b16 v[116:117], v103 offset:33792
    ds_read_b64_tr_b16 v[118:119], v103 offset:34048
    v_add_f32 v50, v50, v51
    v_add_f32 v52, v52, v53
    s_waitcnt lgkmcnt(8)
    v_mfma_f32_32x32x16_bf16 v[32:47], a[80:83], v[128:131], v[32:47]
    ds_read_b64_tr_b16 v[120:121], v103 offset:34816
    ds_read_b64_tr_b16 v[122:123], v103 offset:35072
    buffer_load_dwordx4 v2, s[44:47], s50 offen offset:3072 sc1 lds
    s_add_u32 m0, m0, 4096
    s_add_u32 s50, s50, 4096
    v_add_f32 v54, v54, v55
    v_mfma_f32_32x32x16_bf16 v[32:47], a[84:87], v[132:135], v[32:47]
    ds_read_b64_tr_b16 v[124:125], v103 offset:35840
    ds_read_b64_tr_b16 v[126:127], v103 offset:36096
    v_add_f32 v48, v48, v50
    v_add_f32 v52, v52, v54
    s_waitcnt lgkmcnt(8)
    v_mfma_f32_32x32x16_bf16 v[32:47], a[88:91], v[136:139], v[32:47]
    ds_read_b64_tr_b16 v[128:129], v103 offset:36864
    ds_read_b64_tr_b16 v[130:131], v103 offset:37120
    buffer_load_dwordx4 v2, s[44:47], s50 offen offset:0 sc1 lds
    v_add_f32 v14, v48, v52
    v_mfma_f32_32x32x16_bf16 v[32:47], a[92:95], v[140:143], v[32:47]
    ds_read_b64_tr_b16 v[132:133], v103 offset:37888
    ds_read_b64_tr_b16 v[134:135], v103 offset:38144
    v_mul_f32 v14, 0x3b000000, v14
    v_cvt_pk_bf16_f32 v14, v14, v14
    s_waitcnt lgkmcnt(8)
    v_mfma_f32_32x32x16_bf16 v[32:47], a[96:99], v[112:115], v[32:47]
    ds_read_b64_tr_b16 v[136:137], v103 offset:38912
    ds_read_b64_tr_b16 v[138:139], v103 offset:39168
    buffer_load_dwordx4 v2, s[44:47], s50 offen offset:1024 sc1 lds
    v_lshlrev_b32 v14, 16, v14
    v_mfma_f32_32x32x16_bf16 v[32:47], a[100:103], v[116:119], v[32:47]
    ds_read_b64_tr_b16 v[140:141], v103 offset:39936
    ds_read_b64_tr_b16 v[142:143], v103 offset:40192
    v_add_f32 v14, 0x3727c5ac, v14
    v_cvt_pk_bf16_f32 v14, v14, v14
    s_waitcnt lgkmcnt(8)
    v_mfma_f32_32x32x16_bf16 v[32:47], a[104:107], v[120:123], v[32:47]
    v_add_u32 v100, 0x10000, v100
    ds_read_b64_tr_b16 v[112:113], v100 offset:0
    ds_read_b64_tr_b16 v[114:115], v100 offset:256
    buffer_load_dwordx4 v2, s[44:47], s50 offen offset:2048 sc1 lds
    v_lshlrev_b32 v14, 16, v14
    v_mfma_f32_32x32x16_bf16 v[32:47], a[108:111], v[124:127], v[32:47]
    ds_read_b64_tr_b16 v[116:117], v100 offset:1024
    ds_read_b64_tr_b16 v[118:119], v100 offset:1280
    v_sqrt_f32 v14, v14
    s_nop 0
    v_cvt_pk_bf16_f32 v14, v14, v14
    s_waitcnt lgkmcnt(8)
    v_mfma_f32_32x32x16_bf16 v[32:47], a[112:115], v[128:131], v[32:47]
    ds_read_b64_tr_b16 v[120:121], v100 offset:2048
    ds_read_b64_tr_b16 v[122:123], v100 offset:2304
    buffer_load_dwordx4 v2, s[44:47], s50 offen offset:3072 sc1 lds
    v_and_b32 v80, v9, v14
    v_mfma_f32_32x32x16_bf16 v[32:47], a[116:119], v[132:135], v[32:47]
    ds_read_b64_tr_b16 v[124:125], v100 offset:3072
    ds_read_b64_tr_b16 v[126:127], v100 offset:3328
    buffer_load_dwordx4 a[180:183], v2, s[44:47], s67 offen offset:1024 sc1
    buffer_store_dword v14, v13, s[44:47], s60 offen offset:128 sc1
    s_waitcnt lgkmcnt(8)
    v_mfma_f32_32x32x16_bf16 v[32:47], a[120:123], v[136:139], v[32:47]
    ds_read_b64_tr_b16 v[128:129], v100 offset:4096
    ds_read_b64_tr_b16 v[130:131], v100 offset:4352
    buffer_load_dwordx4 a[184:187], v2, s[44:47], s67 offen offset:2048 sc1
    v_mfma_f32_32x32x16_bf16 v[32:47], a[124:127], v[140:143], v[32:47]
    ds_read_b64_tr_b16 v[132:133], v100 offset:5120
    ds_read_b64_tr_b16 v[134:135], v100 offset:5376
    buffer_load_dwordx4 a[188:191], v2, s[44:47], s67 offen offset:3072 sc1
    s_add_u32 s67, s67, 4096
    v_mfma_f32_32x32x16_bf16 v[32:47], v[76:79], v[80:83], v[32:47]
    s_waitcnt lgkmcnt(8)
    v_mfma_f32_32x32x16_bf16 v[16:31], a[0:3], v[112:115], 0
    v_mfma_f32_4x4x4_16b_bf16 v[72:75], v[112:113], v[112:113], 0
    ds_read_b64_tr_b16 v[136:137], v100 offset:6144
    ds_read_b64_tr_b16 v[138:139], v100 offset:6400
    v_mfma_f32_4x4x4_16b_bf16 v[72:75], v[114:115], v[114:115], v[72:75]
    buffer_load_dwordx4 a[192:195], v2, s[44:47], s67 offen offset:0 sc1
    v_mfma_f32_32x32x16_bf16 v[16:31], a[4:7], v[116:119], v[16:31]
    v_mfma_f32_4x4x4_16b_bf16 v[72:75], v[116:117], v[116:117], v[72:75]
    ds_read_b64_tr_b16 v[140:141], v100 offset:7168
    ds_read_b64_tr_b16 v[142:143], v100 offset:7424
    v_mfma_f32_4x4x4_16b_bf16 v[72:75], v[118:119], v[118:119], v[72:75]
    buffer_load_dwordx4 a[196:199], v2, s[44:47], s67 offen offset:1024 sc1
    s_waitcnt lgkmcnt(8)
    v_mfma_f32_32x32x16_bf16 v[16:31], a[8:11], v[120:123], v[16:31]
    v_mfma_f32_4x4x4_16b_bf16 v[72:75], v[120:121], v[120:121], v[72:75]
    v_add_u32 v101, 0x10000, v101
    ds_read_b64_tr_b16 v[112:113], v101 offset:0
    ds_read_b64_tr_b16 v[114:115], v101 offset:256
    v_mfma_f32_4x4x4_16b_bf16 v[72:75], v[122:123], v[122:123], v[72:75]
    buffer_load_dwordx4 a[200:203], v2, s[44:47], s67 offen offset:2048 sc1
    v_mul_f32 v32, v32, |v32|
    v_mul_f32 v33, v33, |v33|
    v_mfma_f32_32x32x16_bf16 v[16:31], a[12:15], v[124:127], v[16:31]
    v_mfma_f32_4x4x4_16b_bf16 v[72:75], v[124:125], v[124:125], v[72:75]
    ds_read_b64_tr_b16 v[116:117], v101 offset:1024
    ds_read_b64_tr_b16 v[118:119], v101 offset:1280
    v_mfma_f32_4x4x4_16b_bf16 v[72:75], v[126:127], v[126:127], v[72:75]
    buffer_load_dwordx4 a[204:207], v2, s[44:47], s67 offen offset:3072 sc1
    s_add_u32 s67, s67, 4096
    v_mul_f32 v34, v34, |v34|
    v_mul_f32 v35, v35, |v35|
    s_waitcnt lgkmcnt(8)
    v_mfma_f32_32x32x16_bf16 v[16:31], a[16:19], v[128:131], v[16:31]
    v_mfma_f32_4x4x4_16b_bf16 v[72:75], v[128:129], v[128:129], v[72:75]
    ds_read_b64_tr_b16 v[120:121], v101 offset:2048
    ds_read_b64_tr_b16 v[122:123], v101 offset:2304
    v_mfma_f32_4x4x4_16b_bf16 v[72:75], v[130:131], v[130:131], v[72:75]
    buffer_load_dwordx4 a[208:211], v2, s[44:47], s67 offen offset:0 sc1
    v_mul_f32 v36, v36, |v36|
    v_mul_f32 v37, v37, |v37|
    v_mfma_f32_32x32x16_bf16 v[16:31], a[20:23], v[132:135], v[16:31]
    v_mfma_f32_4x4x4_16b_bf16 v[72:75], v[132:133], v[132:133], v[72:75]
    ds_read_b64_tr_b16 v[124:125], v101 offset:3072
    ds_read_b64_tr_b16 v[126:127], v101 offset:3328
    v_mfma_f32_4x4x4_16b_bf16 v[72:75], v[134:135], v[134:135], v[72:75]
    buffer_load_dwordx4 a[212:215], v2, s[44:47], s67 offen offset:1024 sc1
    v_mul_f32 v38, v38, |v38|
    v_mul_f32 v39, v39, |v39|
    s_waitcnt lgkmcnt(8)
    v_mfma_f32_32x32x16_bf16 v[16:31], a[24:27], v[136:139], v[16:31]
    v_mfma_f32_4x4x4_16b_bf16 v[72:75], v[136:137], v[136:137], v[72:75]
    ds_read_b64_tr_b16 v[128:129], v101 offset:4096
    ds_read_b64_tr_b16 v[130:131], v101 offset:4352
    v_mfma_f32_4x4x4_16b_bf16 v[72:75], v[138:139], v[138:139], v[72:75]
    buffer_load_dwordx4 a[216:219], v2, s[44:47], s67 offen offset:2048 sc1
    v_cvt_pk_bf16_f32 v92, v32, v33
    v_cvt_pk_bf16_f32 v93, v34, v35
    v_mfma_f32_32x32x16_bf16 v[16:31], a[28:31], v[140:143], v[16:31]
    v_mov_b32 v56, v142
    v_and_b32 v57, v7, v143
    v_mfma_f32_4x4x4_16b_bf16 v[72:75], v[140:141], v[140:141], v[72:75]
    ds_read_b64_tr_b16 v[132:133], v101 offset:5120
    ds_read_b64_tr_b16 v[134:135], v101 offset:5376
    v_mfma_f32_4x4x4_16b_bf16 v[72:75], v[56:57], v[56:57], v[72:75]
    buffer_load_dwordx4 a[220:223], v2, s[44:47], s67 offen offset:3072 sc1
    s_add_u32 s67, s67, 4096
    v_cvt_pk_bf16_f32 v94, v36, v37
    v_cvt_pk_bf16_f32 v95, v38, v39
    s_waitcnt lgkmcnt(8)
    v_mfma_f32_32x32x16_bf16 v[16:31], a[32:35], v[112:115], v[16:31]
    ds_read_b64_tr_b16 v[136:137], v101 offset:6144
    ds_read_b64_tr_b16 v[138:139], v101 offset:6400
    v_pk_max_i16 v92, v92, v8
    v_pk_max_i16 v93, v93, v8
    v_pk_max_i16 v94, v94, v8
    v_pk_max_i16 v95, v95, v8
    v_mfma_f32_32x32x16_bf16 v[16:31], a[36:39], v[116:119], v[16:31]
    ds_read_b64_tr_b16 v[140:141], v101 offset:7168
    ds_read_b64_tr_b16 v[142:143], v101 offset:7424
    v_cndmask_b32 v56, v72, v73, s[56:57]
    v_cndmask_b32 v57, v74, v75, s[56:57]
    v_cndmask_b32 v56, v56, v57, s[58:59]
    ds_write_b32 v10, v56 offset:0
    s_waitcnt lgkmcnt(9)
    v_mfma_f32_32x32x16_bf16 v[16:31], a[40:43], v[120:123], v[16:31]
    v_add_u32 v102, 0x10000, v102
    ds_read_b64_tr_b16 v[112:113], v102 offset:0
    ds_read_b64_tr_b16 v[114:115], v102 offset:256
    buffer_load_dwordx4 a[224:227], v2, s[44:47], s67 offen offset:0 sc1
    buffer_store_dwordx4 v[92:95], v2, s[44:47], s54 offen offset:0 sc1
    v_mul_f32 v40, v40, |v40|
    v_mul_f32 v41, v41, |v41|
    v_mfma_f32_32x32x16_bf16 v[16:31], a[44:47], v[124:127], v[16:31]
    ds_read_b64_tr_b16 v[116:117], v102 offset:1024
    ds_read_b64_tr_b16 v[118:119], v102 offset:1280
    v_mul_f32 v42, v42, |v42|
    v_mul_f32 v43, v43, |v43|
    v_mul_f32 v44, v44, |v44|
    v_mul_f32 v45, v45, |v45|
    s_waitcnt lgkmcnt(9)
    v_mfma_f32_32x32x16_bf16 v[16:31], a[48:51], v[128:131], v[16:31]
    ds_read_b64_tr_b16 v[120:121], v102 offset:2048
    ds_read_b64_tr_b16 v[122:123], v102 offset:2304
    buffer_load_dwordx4 a[228:231], v2, s[44:47], s67 offen offset:1024 sc1
    v_mul_f32 v46, v46, |v46|
    v_mul_f32 v47, v47, |v47|
    v_cvt_pk_bf16_f32 v96, v40, v41
    v_mfma_f32_32x32x16_bf16 v[16:31], a[52:55], v[132:135], v[16:31]
    ds_read_b64_tr_b16 v[124:125], v102 offset:3072
    ds_read_b64_tr_b16 v[126:127], v102 offset:3328
    s_waitcnt lgkmcnt(8)
    s_waitcnt vmcnt(15)
    s_barrier
    ds_read2_b32 v[48:49], v11 offset0:0 offset1:32
    ds_read2_b32 v[50:51], v11 offset0:64 offset1:96
    ds_read2_b32 v[52:53], v11 offset0:128 offset1:160
    ds_read2_b32 v[54:55], v11 offset0:192 offset1:224
    v_mfma_f32_32x32x16_bf16 v[16:31], a[56:59], v[136:139], v[16:31]
    ds_read_b64_tr_b16 v[128:129], v102 offset:4096
    ds_read_b64_tr_b16 v[130:131], v102 offset:4352
    v_cvt_pk_bf16_f32 v97, v42, v43
    v_cvt_pk_bf16_f32 v98, v44, v45
    v_cvt_pk_bf16_f32 v99, v46, v47
    v_pk_max_i16 v96, v96, v8
    v_mfma_f32_32x32x16_bf16 v[16:31], a[60:63], v[140:143], v[16:31]
    ds_read_b64_tr_b16 v[132:133], v102 offset:5120
    ds_read_b64_tr_b16 v[134:135], v102 offset:5376
    buffer_load_dwordx4 a[232:235], v2, s[44:47], s67 offen offset:2048 sc1
    v_pk_max_i16 v97, v97, v8
    v_pk_max_i16 v98, v98, v8
    v_pk_max_i16 v99, v99, v8
    s_waitcnt lgkmcnt(12)
    v_mfma_f32_32x32x16_bf16 v[16:31], a[64:67], v[112:115], v[16:31]
    ds_read_b64_tr_b16 v[136:137], v102 offset:6144
    ds_read_b64_tr_b16 v[138:139], v102 offset:6400
    buffer_store_dwordx4 v[96:99], v2, s[44:47], s54 offen offset:1024 sc1
    s_add_u32 s54, s54, s55
    v_mfma_f32_32x32x16_bf16 v[16:31], a[68:71], v[116:119], v[16:31]
    ds_read_b64_tr_b16 v[140:141], v102 offset:7168
    ds_read_b64_tr_b16 v[142:143], v102 offset:7424
    buffer_load_dwordx4 a[236:239], v2, s[44:47], s67 offen offset:3072 sc1
    s_add_u32 s67, s67, 4096
    s_waitcnt lgkmcnt(12)
    v_mfma_f32_32x32x16_bf16 v[16:31], a[72:75], v[120:123], v[16:31]
    v_add_u32 v103, 0x10000, v103
    ds_read_b64_tr_b16 v[112:113], v103 offset:0
    ds_read_b64_tr_b16 v[114:115], v103 offset:256
    s_waitcnt lgkmcnt(10)
    v_add_f32 v48, v48, v49
    v_add_f32 v50, v50, v51
    v_mfma_f32_32x32x16_bf16 v[16:31], a[76:79], v[124:127], v[16:31]
    ds_read_b64_tr_b16 v[116:117], v103 offset:1024
    ds_read_b64_tr_b16 v[118:119], v103 offset:1280
    v_add_f32 v52, v52, v53
    v_add_f32 v54, v54, v55
    s_waitcnt lgkmcnt(8)
    v_mfma_f32_32x32x16_bf16 v[16:31], a[80:83], v[128:131], v[16:31]
    ds_read_b64_tr_b16 v[120:121], v103 offset:2048
    ds_read_b64_tr_b16 v[122:123], v103 offset:2304
    buffer_load_dwordx4 a[240:243], v2, s[44:47], s67 offen offset:0 sc1
    v_add_f32 v48, v48, v50
    v_mfma_f32_32x32x16_bf16 v[16:31], a[84:87], v[132:135], v[16:31]
    ds_read_b64_tr_b16 v[124:125], v103 offset:3072
    ds_read_b64_tr_b16 v[126:127], v103 offset:3328
    v_add_f32 v52, v52, v54
    v_add_f32 v14, v48, v52
    s_waitcnt lgkmcnt(8)
    v_mfma_f32_32x32x16_bf16 v[16:31], a[88:91], v[136:139], v[16:31]
    ds_read_b64_tr_b16 v[128:129], v103 offset:4096
    ds_read_b64_tr_b16 v[130:131], v103 offset:4352
    buffer_load_dwordx4 a[244:247], v2, s[44:47], s67 offen offset:1024 sc1
    v_mul_f32 v14, 0x3b000000, v14
    v_mfma_f32_32x32x16_bf16 v[16:31], a[92:95], v[140:143], v[16:31]
    ds_read_b64_tr_b16 v[132:133], v103 offset:5120
    ds_read_b64_tr_b16 v[134:135], v103 offset:5376
    v_cvt_pk_bf16_f32 v14, v14, v14
    v_lshlrev_b32 v14, 16, v14
    s_waitcnt lgkmcnt(8)
    v_mfma_f32_32x32x16_bf16 v[16:31], a[96:99], v[112:115], v[16:31]
    ds_read_b64_tr_b16 v[136:137], v103 offset:6144
    ds_read_b64_tr_b16 v[138:139], v103 offset:6400
    v_add_f32 v14, 0x3727c5ac, v14
    v_cvt_pk_bf16_f32 v14, v14, v14
    v_mfma_f32_32x32x16_bf16 v[16:31], a[100:103], v[116:119], v[16:31]
    ds_read_b64_tr_b16 v[140:141], v103 offset:7168
    ds_read_b64_tr_b16 v[142:143], v103 offset:7424
    buffer_load_dwordx4 a[248:251], v2, s[44:47], s67 offen offset:2048 sc1
    v_lshlrev_b32 v14, 16, v14
    s_waitcnt lgkmcnt(8)
    v_mfma_f32_32x32x16_bf16 v[16:31], a[104:107], v[120:123], v[16:31]
    ds_read_b64_tr_b16 v[112:113], v100 offset:32768
    ds_read_b64_tr_b16 v[114:115], v100 offset:33024
    v_sqrt_f32 v14, v14
    s_nop 0
    v_cvt_pk_bf16_f32 v14, v14, v14
    v_mfma_f32_32x32x16_bf16 v[16:31], a[108:111], v[124:127], v[16:31]
    ds_read_b64_tr_b16 v[116:117], v100 offset:33792
    ds_read_b64_tr_b16 v[118:119], v100 offset:34048
    buffer_load_dwordx4 a[252:255], v2, s[44:47], s67 offen offset:3072 sc1
    s_add_u32 s67, s67, 4096
    v_and_b32 v80, v9, v14
    s_waitcnt lgkmcnt(8)
    v_mfma_f32_32x32x16_bf16 v[16:31], a[112:115], v[128:131], v[16:31]
    ds_read_b64_tr_b16 v[120:121], v100 offset:34816
    ds_read_b64_tr_b16 v[122:123], v100 offset:35072
    buffer_store_dword v14, v13, s[44:47], s60 offen offset:256 sc1
    v_mfma_f32_32x32x16_bf16 v[16:31], a[116:119], v[132:135], v[16:31]
    ds_read_b64_tr_b16 v[124:125], v100 offset:35840
    ds_read_b64_tr_b16 v[126:127], v100 offset:36096
    s_waitcnt lgkmcnt(8)
    v_mfma_f32_32x32x16_bf16 v[16:31], a[120:123], v[136:139], v[16:31]
    ds_read_b64_tr_b16 v[128:129], v100 offset:36864
    ds_read_b64_tr_b16 v[130:131], v100 offset:37120
    buffer_load_dwordx4 v[208:211], v2, s[44:47], s67 offen offset:0 sc1
    v_mfma_f32_32x32x16_bf16 v[16:31], a[124:127], v[140:143], v[16:31]
    ds_read_b64_tr_b16 v[132:133], v100 offset:37888
    ds_read_b64_tr_b16 v[134:135], v100 offset:38144
    v_mfma_f32_32x32x16_bf16 v[16:31], v[76:79], v[80:83], v[16:31]
    s_waitcnt lgkmcnt(8)
    v_mfma_f32_32x32x16_bf16 v[32:47], a[0:3], v[112:115], 0
    v_mfma_f32_4x4x4_16b_bf16 v[72:75], v[112:113], v[112:113], 0
    ds_read_b64_tr_b16 v[136:137], v100 offset:38912
    ds_read_b64_tr_b16 v[138:139], v100 offset:39168
    v_mfma_f32_4x4x4_16b_bf16 v[72:75], v[114:115], v[114:115], v[72:75]
    buffer_load_dwordx4 v[212:215], v2, s[44:47], s67 offen offset:1024 sc1
    v_mfma_f32_32x32x16_bf16 v[32:47], a[4:7], v[116:119], v[32:47]
    v_mfma_f32_4x4x4_16b_bf16 v[72:75], v[116:117], v[116:117], v[72:75]
    ds_read_b64_tr_b16 v[140:141], v100 offset:39936
    ds_read_b64_tr_b16 v[142:143], v100 offset:40192
    v_mfma_f32_4x4x4_16b_bf16 v[72:75], v[118:119], v[118:119], v[72:75]
    s_waitcnt lgkmcnt(8)
    v_mfma_f32_32x32x16_bf16 v[32:47], a[8:11], v[120:123], v[32:47]
    v_mfma_f32_4x4x4_16b_bf16 v[72:75], v[120:121], v[120:121], v[72:75]
    ds_read_b64_tr_b16 v[112:113], v101 offset:32768
    ds_read_b64_tr_b16 v[114:115], v101 offset:33024
    v_mfma_f32_4x4x4_16b_bf16 v[72:75], v[122:123], v[122:123], v[72:75]
    v_mul_f32 v16, v16, |v16|
    v_mul_f32 v17, v17, |v17|
    v_mul_f32 v18, v18, |v18|
    v_mfma_f32_32x32x16_bf16 v[32:47], a[12:15], v[124:127], v[32:47]
    v_mfma_f32_4x4x4_16b_bf16 v[72:75], v[124:125], v[124:125], v[72:75]
    ds_read_b64_tr_b16 v[116:117], v101 offset:33792
    ds_read_b64_tr_b16 v[118:119], v101 offset:34048
    v_mfma_f32_4x4x4_16b_bf16 v[72:75], v[126:127], v[126:127], v[72:75]
    buffer_load_dwordx4 v[216:219], v2, s[44:47], s67 offen offset:2048 sc1
    v_mul_f32 v19, v19, |v19|
    v_mul_f32 v20, v20, |v20|
    s_waitcnt vmcnt(9)
    s_barrier
    s_cmp_lg_u32 s3, 0
    s_cbranch_scc1 L_arr_14
    v_mov_b32 v58, 1
    v_mov_b32 v59, 0
    s_mov_b64 exec, 1
    buffer_atomic_add v58, v59, s[44:47], s53 offen sc1
    s_mov_b64 exec, -1
L_arr_14:
    s_waitcnt lgkmcnt(8)
    v_mfma_f32_32x32x16_bf16 v[32:47], a[16:19], v[128:131], v[32:47]
    v_mfma_f32_4x4x4_16b_bf16 v[72:75], v[128:129], v[128:129], v[72:75]
    ds_read_b64_tr_b16 v[120:121], v101 offset:34816
    ds_read_b64_tr_b16 v[122:123], v101 offset:35072
    v_mfma_f32_4x4x4_16b_bf16 v[72:75], v[130:131], v[130:131], v[72:75]
    v_mul_f32 v21, v21, |v21|
    v_mul_f32 v22, v22, |v22|
    v_mul_f32 v23, v23, |v23|
    v_mfma_f32_32x32x16_bf16 v[32:47], a[20:23], v[132:135], v[32:47]
    v_mfma_f32_4x4x4_16b_bf16 v[72:75], v[132:133], v[132:133], v[72:75]
    ds_read_b64_tr_b16 v[124:125], v101 offset:35840
    ds_read_b64_tr_b16 v[126:127], v101 offset:36096
    v_mfma_f32_4x4x4_16b_bf16 v[72:75], v[134:135], v[134:135], v[72:75]
    buffer_load_dwordx4 v[220:223], v2, s[44:47], s67 offen offset:3072 sc1
    s_add_u32 s67, s67, 4096
    v_cvt_pk_bf16_f32 v92, v16, v17
    v_cvt_pk_bf16_f32 v93, v18, v19
    s_waitcnt lgkmcnt(8)
    v_mfma_f32_32x32x16_bf16 v[32:47], a[24:27], v[136:139], v[32:47]
    v_mfma_f32_4x4x4_16b_bf16 v[72:75], v[136:137], v[136:137], v[72:75]
    ds_read_b64_tr_b16 v[128:129], v101 offset:36864
    ds_read_b64_tr_b16 v[130:131], v101 offset:37120
    v_mfma_f32_4x4x4_16b_bf16 v[72:75], v[138:139], v[138:139], v[72:75]
    v_cvt_pk_bf16_f32 v94, v20, v21
    v_cvt_pk_bf16_f32 v95, v22, v23
    v_pk_max_i16 v92, v92, v8
    v_mfma_f32_32x32x16_bf16 v[32:47], a[28:31], v[140:143], v[32:47]
    v_mov_b32 v56, v142
    v_and_b32 v57, v7, v143
    v_mfma_f32_4x4x4_16b_bf16 v[72:75], v[140:141], v[140:141], v[72:75]
    ds_read_b64_tr_b16 v[132:133], v101 offset:37888
    ds_read_b64_tr_b16 v[134:135], v101 offset:38144
    v_mfma_f32_4x4x4_16b_bf16 v[72:75], v[56:57], v[56:57], v[72:75]
    v_pk_max_i16 v93, v93, v8
    v_pk_max_i16 v94, v94, v8
    v_pk_max_i16 v95, v95, v8
    s_waitcnt lgkmcnt(8)
    v_mfma_f32_32x32x16_bf16 v[32:47], a[32:35], v[112:115], v[32:47]
    ds_read_b64_tr_b16 v[136:137], v101 offset:38912
    ds_read_b64_tr_b16 v[138:139], v101 offset:39168
    buffer_load_dwordx4 v[224:227], v2, s[44:47], s67 offen offset:0 sc1
    buffer_store_dwordx4 v[92:95], v2, s[44:47], s54 offen offset:0 sc1
    v_mul_f32 v24, v24, |v24|
    v_mul_f32 v25, v25, |v25|
    v_mfma_f32_32x32x16_bf16 v[32:47], a[36:39], v[116:119], v[32:47]
    ds_read_b64_tr_b16 v[140:141], v101 offset:39936
    ds_read_b64_tr_b16 v[142:143], v101 offset:40192
    v_cndmask_b32 v56, v72, v73, s[56:57]
    v_cndmask_b32 v57, v74, v75, s[56:57]
    v_cndmask_b32 v56, v56, v57, s[58:59]
    ds_write_b32 v10, v56 offset:1024
    s_waitcnt lgkmcnt(9)
    v_mfma_f32_32x32x16_bf16 v[32:47], a[40:43], v[120:123], v[32:47]
    ds_read_b64_tr_b16 v[112:113], v102 offset:32768
    ds_read_b64_tr_b16 v[114:115], v102 offset:33024
    buffer_load_dwordx4 v[228:231], v2, s[44:47], s67 offen offset:1024 sc1
    v_mul_f32 v26, v26, |v26|
    v_mul_f32 v27, v27, |v27|
    v_mul_f32 v28, v28, |v28|
    v_mfma_f32_32x32x16_bf16 v[32:47], a[44:47], v[124:127], v[32:47]
    ds_read_b64_tr_b16 v[116:117], v102 offset:33792
    ds_read_b64_tr_b16 v[118:119], v102 offset:34048
    v_mul_f32 v29, v29, |v29|
    v_mul_f32 v30, v30, |v30|
    v_mul_f32 v31, v31, |v31|
    v_cvt_pk_bf16_f32 v96, v24, v25
    s_waitcnt lgkmcnt(9)
    v_mfma_f32_32x32x16_bf16 v[32:47], a[48:51], v[128:131], v[32:47]
    ds_read_b64_tr_b16 v[120:121], v102 offset:34816
    ds_read_b64_tr_b16 v[122:123], v102 offset:35072
    v_cvt_pk_bf16_f32 v97, v26, v27
    v_cvt_pk_bf16_f32 v98, v28, v29
    v_cvt_pk_bf16_f32 v99, v30, v31
    v_pk_max_i16 v96, v96, v8
    v_mfma_f32_32x32x16_bf16 v[32:47], a[52:55], v[132:135], v[32:47]
    ds_read_b64_tr_b16 v[124:125], v102 offset:35840
    ds_read_b64_tr_b16 v[126:127], v102 offset:36096
    s_waitcnt lgkmcnt(8)
    s_barrier
    ds_read2_b32 v[48:49], v12 offset0:0 offset1:32
    ds_read2_b32 v[50:51], v12 offset0:64 offset1:96
    ds_read2_b32 v[52:53], v12 offset0:128 offset1:160
    ds_read2_b32 v[54:55], v12 offset0:192 offset1:224
    v_mfma_f32_32x32x16_bf16 v[32:47], a[56:59], v[136:139], v[32:47]
    ds_read_b64_tr_b16 v[128:129], v102 offset:36864
    ds_read_b64_tr_b16 v[130:131], v102 offset:37120
    buffer_load_dwordx4 v[232:235], v2, s[44:47], s67 offen offset:2048 sc1
    v_pk_max_i16 v97, v97, v8
    v_pk_max_i16 v98, v98, v8
    v_pk_max_i16 v99, v99, v8
    v_mfma_f32_32x32x16_bf16 v[32:47], a[60:63], v[140:143], v[32:47]
    ds_read_b64_tr_b16 v[132:133], v102 offset:37888
    ds_read_b64_tr_b16 v[134:135], v102 offset:38144
    buffer_load_dwordx4 v[236:239], v2, s[44:47], s67 offen offset:3072 sc1
    s_add_u32 s67, s67, 4096
    buffer_store_dwordx4 v[96:99], v2, s[44:47], s54 offen offset:1024 sc1
    s_add_u32 s54, s54, s55
    s_waitcnt lgkmcnt(12)
    v_mfma_f32_32x32x16_bf16 v[32:47], a[64:67], v[112:115], v[32:47]
    ds_read_b64_tr_b16 v[136:137], v102 offset:38912
    ds_read_b64_tr_b16 v[138:139], v102 offset:39168
    v_mfma_f32_32x32x16_bf16 v[32:47], a[68:71], v[116:119], v[32:47]
    ds_read_b64_tr_b16 v[140:141], v102 offset:39936
    ds_read_b64_tr_b16 v[142:143], v102 offset:40192
    s_waitcnt lgkmcnt(12)
    v_mfma_f32_32x32x16_bf16 v[32:47], a[72:75], v[120:123], v[32:47]
    ds_read_b64_tr_b16 v[112:113], v103 offset:32768
    ds_read_b64_tr_b16 v[114:115], v103 offset:33024
    s_waitcnt lgkmcnt(10)
    buffer_load_dwordx4 v[240:243], v2, s[44:47], s67 offen offset:0 sc1
    v_add_f32 v48, v48, v49
    v_mfma_f32_32x32x16_bf16 v[32:47], a[76:79], v[124:127], v[32:47]
    ds_read_b64_tr_b16 v[116:117], v103 offset:33792
    ds_read_b64_tr_b16 v[118:119], v103 offset:34048
    v_add_f32 v50, v50, v51
    v_add_f32 v52, v52, v53
    s_waitcnt lgkmcnt(8)
    v_mfma_f32_32x32x16_bf16 v[32:47], a[80:83], v[128:131], v[32:47]
    ds_read_b64_tr_b16 v[120:121], v103 offset:34816
    ds_read_b64_tr_b16 v[122:123], v103 offset:35072
    buffer_load_dwordx4 v[244:247], v2, s[44:47], s67 offen offset:1024 sc1
    v_add_f32 v54, v54, v55
    v_mfma_f32_32x32x16_bf16 v[32:47], a[84:87], v[132:135], v[32:47]
    ds_read_b64_tr_b16 v[124:125], v103 offset:35840
    ds_read_b64_tr_b16 v[126:127], v103 offset:36096
    v_add_f32 v48, v48, v50
    v_add_f32 v52, v52, v54
    s_waitcnt lgkmcnt(8)
    v_mfma_f32_32x32x16_bf16 v[32:47], a[88:91], v[136:139], v[32:47]
    ds_read_b64_tr_b16 v[128:129], v103 offset:36864
    ds_read_b64_tr_b16 v[130:131], v103 offset:37120
    v_add_f32 v14, v48, v52
    v_mul_f32 v14, 0x3b000000, v14
    v_mfma_f32_32x32x16_bf16 v[32:47], a[92:95], v[140:143], v[32:47]
    ds_read_b64_tr_b16 v[132:133], v103 offset:37888
    ds_read_b64_tr_b16 v[134:135], v103 offset:38144
    buffer_load_dwordx4 v[248:251], v2, s[44:47], s67 offen offset:2048 sc1
    v_cvt_pk_bf16_f32 v14, v14, v14
    s_waitcnt lgkmcnt(8)
    v_mfma_f32_32x32x16_bf16 v[32:47], a[96:99], v[112:115], v[32:47]
    ds_read_b64_tr_b16 v[136:137], v103 offset:38912
    ds_read_b64_tr_b16 v[138:139], v103 offset:39168
    v_lshlrev_b32 v14, 16, v14
    v_add_f32 v14, 0x3727c5ac, v14
    v_mfma_f32_32x32x16_bf16 v[32:47], a[100:103], v[116:119], v[32:47]
    ds_read_b64_tr_b16 v[140:141], v103 offset:39936
    ds_read_b64_tr_b16 v[142:143], v103 offset:40192
    buffer_load_dwordx4 v[252:255], v2, s[44:47], s67 offen offset:3072 sc1
    s_add_u32 s67, s67, 4096
    v_cvt_pk_bf16_f32 v14, v14, v14
    s_waitcnt lgkmcnt(8)
    v_mfma_f32_32x32x16_bf16 v[32:47], a[104:107], v[120:123], v[32:47]
    v_mov_b32 v59, 0
    s_mul_i32 s68, s64, 88
    s_mul_i32 s51, s3, 22
    s_add_u32 s68, s68, s51
    s_lshl_b32 s68, s68, 10
    s_add_u32 s68, s68, 13631488
    v_lshlrev_b32 v14, 16, v14
    v_sqrt_f32 v14, v14
    v_mfma_f32_32x32x16_bf16 v[32:47], a[108:111], v[124:127], v[32:47]
    v_cvt_pk_bf16_f32 v14, v14, v14
    v_and_b32 v80, v9, v14
    s_waitcnt lgkmcnt(4)
    v_mfma_f32_32x32x16_bf16 v[32:47], a[112:115], v[128:131], v[32:47]
    buffer_store_dword v14, v13, s[44:47], s60 offen offset:384 sc1
    v_mfma_f32_32x32x16_bf16 v[32:47], a[116:119], v[132:135], v[32:47]
    s_waitcnt lgkmcnt(0)
    v_mfma_f32_32x32x16_bf16 v[32:47], a[120:123], v[136:139], v[32:47]
    buffer_load_dword v58, v59, s[44:47], s61 offen sc1
    v_mfma_f32_32x32x16_bf16 v[32:47], a[124:127], v[140:143], v[32:47]
    v_mfma_f32_32x32x16_bf16 v[32:47], v[76:79], v[80:83], v[32:47]
    s_nop 11
    v_mul_f32 v32, v32, |v32|
    v_mul_f32 v33, v33, |v33|
    v_mul_f32 v34, v34, |v34|
    v_mul_f32 v35, v35, |v35|
    v_mul_f32 v36, v36, |v36|
    v_mul_f32 v37, v37, |v37|
    v_mul_f32 v38, v38, |v38|
    v_mul_f32 v39, v39, |v39|
    v_cvt_pk_bf16_f32 v92, v32, v33
    v_cvt_pk_bf16_f32 v93, v34, v35
    v_cvt_pk_bf16_f32 v94, v36, v37
    v_cvt_pk_bf16_f32 v95, v38, v39
    v_pk_max_i16 v92, v92, v8
    v_pk_max_i16 v93, v93, v8
    v_pk_max_i16 v94, v94, v8
    v_pk_max_i16 v95, v95, v8
    buffer_store_dwordx4 v[92:95], v2, s[44:47], s54 offen offset:0 sc1
    v_mul_f32 v40, v40, |v40|
    v_mul_f32 v41, v41, |v41|
    v_mul_f32 v42, v42, |v42|
    v_mul_f32 v43, v43, |v43|
    v_mul_f32 v44, v44, |v44|
    v_mul_f32 v45, v45, |v45|
    v_mul_f32 v46, v46, |v46|
    v_mul_f32 v47, v47, |v47|
    v_cvt_pk_bf16_f32 v96, v40, v41
    v_cvt_pk_bf16_f32 v97, v42, v43
    v_cvt_pk_bf16_f32 v98, v44, v45
    v_cvt_pk_bf16_f32 v99, v46, v47
    v_pk_max_i16 v96, v96, v8
    v_pk_max_i16 v97, v97, v8
    v_pk_max_i16 v98, v98, v8
    v_pk_max_i16 v99, v99, v8
    buffer_store_dwordx4 v[96:99], v2, s[44:47], s54 offen offset:1024 sc1
    s_add_u32 s54, s54, s55
    s_waitcnt vmcnt(2)
    v_cmp_ne_u32 vcc, 15, v58
    s_cbranch_vccnz L_p4_slow
    buffer_load_dwordx4 a[0:3], v2, s[44:47], s68 offen offset:0 sc1
    buffer_load_dwordx4 a[4:7], v2, s[44:47], s68 offen offset:1024 sc1
    buffer_load_dwordx4 a[8:11], v2, s[44:47], s68 offen offset:2048 sc1
    buffer_load_dwordx4 a[12:15], v2, s[44:47], s68 offen offset:3072 sc1
    s_add_u32 s68, s68, 4096
    buffer_load_dwordx4 a[16:19], v2, s[44:47], s68 offen offset:0 sc1
    buffer_load_dwordx4 a[20:23], v2, s[44:47], s68 offen offset:1024 sc1
    buffer_load_dwordx4 a[24:27], v2, s[44:47], s68 offen offset:2048 sc1
    buffer_load_dwordx4 a[28:31], v2, s[44:47], s68 offen offset:3072 sc1
    s_add_u32 s68, s68, 4096
    buffer_load_dwordx4 a[32:35], v2, s[44:47], s68 offen offset:0 sc1
    buffer_load_dwordx4 a[36:39], v2, s[44:47], s68 offen offset:1024 sc1
    buffer_load_dwordx4 a[40:43], v2, s[44:47], s68 offen offset:2048 sc1
    buffer_load_dwordx4 a[44:47], v2, s[44:47], s68 offen offset:3072 sc1
    s_add_u32 s68, s68, 4096
    buffer_load_dwordx4 a[48:51], v2, s[44:47], s68 offen offset:0 sc1
    buffer_load_dwordx4 a[52:55], v2, s[44:47], s68 offen offset:1024 sc1
    s_waitcnt vmcnt(14)
    s_barrier
    s_add_u32 s53, s53, 4096
    s_cmp_lg_u32 s3, 0
    s_cbranch_scc1 L_arr_15
    v_mov_b32 v3, 1
    v_mov_b32 v4, 0
    s_mov_b64 exec, 1
    buffer_atomic_add v3, v4, s[44:47], s53 offen sc1
    s_mov_b64 exec, -1
L_arr_15:
    s_branch L_p4_go
L_p4_slow:
    s_waitcnt vmcnt(0)
    s_barrier
    s_add_u32 s53, s53, 4096
    s_cmp_lg_u32 s3, 0
    s_cbranch_scc1 L_arr_16
    v_mov_b32 v3, 1
    v_mov_b32 v4, 0
    s_mov_b64 exec, 1
    buffer_atomic_add v3, v4, s[44:47], s53 offen sc1
    s_mov_b64 exec, -1
L_arr_16:
    s_branch L_p4_poll
L_p3_skip:
    buffer_load_dwordx4 a[128:131], v2, s[44:47], s67 offen offset:0 sc1
    buffer_load_dwordx4 a[132:135], v2, s[44:47], s67 offen offset:1024 sc1
    buffer_load_dwordx4 a[136:139], v2, s[44:47], s67 offen offset:2048 sc1
    buffer_load_dwordx4 a[140:143], v2, s[44:47], s67 offen offset:3072 sc1
    s_add_u32 s67, s67, 4096
    buffer_load_dwordx4 a[144:147], v2, s[44:47], s67 offen offset:0 sc1
    buffer_load_dwordx4 a[148:151], v2, s[44:47], s67 offen offset:1024 sc1
    buffer_load_dwordx4 a[152:155], v2, s[44:47], s67 offen offset:2048 sc1
    buffer_load_dwordx4 a[156:159], v2, s[44:47], s67 offen offset:3072 sc1
    s_add_u32 s67, s67, 4096
    buffer_load_dwordx4 a[160:163], v2, s[44:47], s67 offen offset:0 sc1
    buffer_load_dwordx4 a[164:167], v2, s[44:47], s67 offen offset:1024 sc1
    buffer_load_dwordx4 a[168:171], v2, s[44:47], s67 offen offset:2048 sc1
    buffer_load_dwordx4 a[172:175], v2, s[44:47], s67 offen offset:3072 sc1
    s_add_u32 s67, s67, 4096
    buffer_load_dwordx4 a[176:179], v2, s[44:47], s67 offen offset:0 sc1
    buffer_load_dwordx4 a[180:183], v2, s[44:47], s67 offen offset:1024 sc1
    buffer_load_dwordx4 a[184:187], v2, s[44:47], s67 offen offset:2048 sc1
    buffer_load_dwordx4 a[188:191], v2, s[44:47], s67 offen offset:3072 sc1
    s_add_u32 s67, s67, 4096
    buffer_load_dwordx4 a[192:195], v2, s[44:47], s67 offen offset:0 sc1
    buffer_load_dwordx4 a[196:199], v2, s[44:47], s67 offen offset:1024 sc1
    buffer_load_dwordx4 a[200:203], v2, s[44:47], s67 offen offset:2048 sc1
    buffer_load_dwordx4 a[204:207], v2, s[44:47], s67 offen offset:3072 sc1
    s_add_u32 s67, s67, 4096
    buffer_load_dwordx4 a[208:211], v2, s[44:47], s67 offen offset:0 sc1
    buffer_load_dwordx4 a[212:215], v2, s[44:47], s67 offen offset:1024 sc1
    buffer_load_dwordx4 a[216:219], v2, s[44:47], s67 offen offset:2048 sc1
    buffer_load_dwordx4 a[220:223], v2, s[44:47], s67 offen offset:3072 sc1
    s_add_u32 s67, s67, 4096
    buffer_load_dwordx4 a[224:227], v2, s[44:47], s67 offen offset:0 sc1
    buffer_load_dwordx4 a[228:231], v2, s[44:47], s67 offen offset:1024 sc1
    buffer_load_dwordx4 a[232:235], v2, s[44:47], s67 offen offset:2048 sc1
    buffer_load_dwordx4 a[236:239], v2, s[44:47], s67 offen offset:3072 sc1
    s_add_u32 s67, s67, 4096
    buffer_load_dwordx4 a[240:243], v2, s[44:47], s67 offen offset:0 sc1
    buffer_load_dwordx4 a[244:247], v2, s[44:47], s67 offen offset:1024 sc1
    buffer_load_dwordx4 a[248:251], v2, s[44:47], s67 offen offset:2048 sc1
    buffer_load_dwordx4 a[252:255], v2, s[44:47], s67 offen offset:3072 sc1
    s_add_u32 s67, s67, 4096
    buffer_load_dwordx4 v[208:211], v2, s[44:47], s67 offen offset:0 sc1
    buffer_load_dwordx4 v[212:215], v2, s[44:47], s67 offen offset:1024 sc1
    buffer_load_dwordx4 v[216:219], v2, s[44:47], s67 offen offset:2048 sc1
    buffer_load_dwordx4 v[220:223], v2, s[44:47], s67 offen offset:3072 sc1
    s_add_u32 s67, s67, 4096
    buffer_load_dwordx4 v[224:227], v2, s[44:47], s67 offen offset:0 sc1
    buffer_load_dwordx4 v[228:231], v2, s[44:47], s67 offen offset:1024 sc1
    buffer_load_dwordx4 v[232:235], v2, s[44:47], s67 offen offset:2048 sc1
    buffer_load_dwordx4 v[236:239], v2, s[44:47], s67 offen offset:3072 sc1
    s_add_u32 s67, s67, 4096
    buffer_load_dwordx4 v[240:243], v2, s[44:47], s67 offen offset:0 sc1
    buffer_load_dwordx4 v[244:247], v2, s[44:47], s67 offen offset:1024 sc1
    buffer_load_dwordx4 v[248:251], v2, s[44:47], s67 offen offset:2048 sc1
    buffer_load_dwordx4 v[252:255], v2, s[44:47], s67 offen offset:3072 sc1
    s_add_u32 s67, s67, 4096
    s_mul_i32 s68, s64, 88
    s_mul_i32 s51, s3, 22
    s_add_u32 s68, s68, s51
    s_lshl_b32 s68, s68, 10
    s_add_u32 s68, s68, 13631488
L_p4_poll:
    v_and_b32 v4, 0, v1
    v_lshlrev_b32 v4, 8, v4
L_pl_18:
    buffer_load_dword v3, v4, s[44:47], s61 offen sc1
    s_waitcnt vmcnt(0)
    v_cmp_ne_u32 vcc, 15, v3
    s_cbranch_vccz L_pw_17
    s_sub_u32 s48, s48, 1
    s_cbranch_scc1 L_pw_17_t
    s_sleep 1
    s_branch L_pl_18
L_pw_17_t:
    s_mov_b32 s48, 0
L_pw_17:
    buffer_load_dwordx4 a[0:3], v2, s[44:47], s68 offen offset:0 sc1
    buffer_load_dwordx4 a[4:7], v2, s[44:47], s68 offen offset:1024 sc1
    buffer_load_dwordx4 a[8:11], v2, s[44:47], s68 offen offset:2048 sc1
    buffer_load_dwordx4 a[12:15], v2, s[44:47], s68 offen offset:3072 sc1
    s_add_u32 s68, s68, 4096
    buffer_load_dwordx4 a[16:19], v2, s[44:47], s68 offen offset:0 sc1
    buffer_load_dwordx4 a[20:23], v2, s[44:47], s68 offen offset:1024 sc1
    buffer_load_dwordx4 a[24:27], v2, s[44:47], s68 offen offset:2048 sc1
    buffer_load_dwordx4 a[28:31], v2, s[44:47], s68 offen offset:3072 sc1
    s_add_u32 s68, s68, 4096
    buffer_load_dwordx4 a[32:35], v2, s[44:47], s68 offen offset:0 sc1
    buffer_load_dwordx4 a[36:39], v2, s[44:47], s68 offen offset:1024 sc1
    buffer_load_dwordx4 a[40:43], v2, s[44:47], s68 offen offset:2048 sc1
    buffer_load_dwordx4 a[44:47], v2, s[44:47], s68 offen offset:3072 sc1
    s_add_u32 s68, s68, 4096
    buffer_load_dwordx4 a[48:51], v2, s[44:47], s68 offen offset:0 sc1
    buffer_load_dwordx4 a[52:55], v2, s[44:47], s68 offen offset:1024 sc1
L_p4_go:
    s_nop 7
    buffer_load_dwordx4 a[56:59], v2, s[44:47], s68 offen offset:2048 sc1
    buffer_load_dwordx4 a[60:63], v2, s[44:47], s68 offen offset:3072 sc1
    s_add_u32 s68, s68, 4096
    buffer_load_dwordx4 a[64:67], v2, s[44:47], s68 offen offset:0 sc1
    buffer_load_dwordx4 a[68:71], v2, s[44:47], s68 offen offset:1024 sc1
    buffer_load_dwordx4 a[72:75], v2, s[44:47], s68 offen offset:2048 sc1
    buffer_load_dwordx4 a[76:79], v2, s[44:47], s68 offen offset:3072 sc1
    s_add_u32 s68, s68, 4096
    v_lshrrev_b32 v3, 3, v1
    v_and_b32 v4, 7, v1
    s_lshl_b32 s51, s3, 3
    v_add_u32 v7, s51, v3
    v_lshrrev_b32 v8, 1, v4
    v_lshlrev_b32 v5, 10, v8
    v_and_b32 v8, 1, v4
    v_lshl_add_u32 v5, v8, 9, v5
    v_lshl_add_u32 v5, v7, 4, v5
    v_lshlrev_b32 v6, 10, v7
    v_lshl_add_u32 v6, v4, 4, v6
    v_lshlrev_b32 v9, 2, v7
    v_lshlrev_b32 v10, 4, v4
    s_lshl_b32 s52, s65, 7
    buffer_load_dwordx4 v[88:91], v10, s[32:35], s52 offen
    v_and_b32 v8, 7, v7
    v_lshlrev_b32 v10, 1, v4
    v_xor_b32 v8, v8, v10
    v_lshlrev_b32 v8, 4, v8
    v_lshl_add_u32 v104, v7, 8, v8
    v_xor_b32 v105, 16, v104
    v_and_b32 v3, 31, v1
    v_lshrrev_b32 v4, 5, v1
    v_lshlrev_b32 v4, 1, v4
    v_and_b32 v8, 7, v3
    v_xor_b32 v4, v4, v8
    v_lshlrev_b32 v4, 4, v4
    v_lshl_add_u32 v4, v3, 8, v4
    s_lshl_b32 s51, s3, 13
    v_add_u32 v100, s51, v4
    v_xor_b32 v101, 16, v100
    v_xor_b32 v102, 64, v100
    v_xor_b32 v103, 80, v100
    v_mov_b32 v11, 0
    s_lshl_b32 s55, s64, 15
    s_lshl_b32 s51, s65, 12
    s_add_u32 s55, s55, s51
    s_add_u32 s55, s55, 11534336
    s_lshl_b32 s56, s64, 15
    s_add_u32 s56, s56, s52
    s_lshl_b32 s58, s64, 7
    s_add_u32 s58, s58, 131072
    s_add_u32 s61, s61, 4096
    v_mov_b32 v12, 0x7fffffff
    v_mov_b32 v13, 0x3d800000
    s_waitcnt vmcnt(20)
    v_mfma_f32_32x32x16_bf16 v[16:31], a[128:131], a[0:3], 0
    buffer_load_dwordx4 a[80:83], v2, s[44:47], s68 offen offset:0 sc1
    v_mfma_f32_32x32x16_bf16 v[32:47], a[132:135], a[0:3], 0
    s_waitcnt vmcnt(20)
    v_mfma_f32_32x32x16_bf16 v[16:31], a[136:139], a[4:7], v[16:31]
    buffer_load_dwordx4 a[84:87], v2, s[44:47], s68 offen offset:1024 sc1
    v_mfma_f32_32x32x16_bf16 v[32:47], a[140:143], a[4:7], v[32:47]
    s_waitcnt vmcnt(20)
    v_mfma_f32_32x32x16_bf16 v[16:31], a[144:147], a[8:11], v[16:31]
    s_add_u32 s51, s55, 0
    buffer_load_dwordx4 v[80:83], v5, s[44:47], s51 offen sc1
    buffer_load_dword v106, v9, s[44:47], s58 offen offset:0 sc1
    v_mfma_f32_32x32x16_bf16 v[32:47], a[148:151], a[8:11], v[32:47]
    s_waitcnt vmcnt(21)
    v_mfma_f32_32x32x16_bf16 v[16:31], a[152:155], a[12:15], v[16:31]
    v_mfma_f32_32x32x16_bf16 v[32:47], a[156:159], a[12:15], v[32:47]
    s_waitcnt vmcnt(20)
    v_mfma_f32_32x32x16_bf16 v[16:31], a[160:163], a[16:19], v[16:31]
    v_mfma_f32_32x32x16_bf16 v[32:47], a[164:167], a[16:19], v[32:47]
    s_waitcnt vmcnt(19)
    v_mfma_f32_32x32x16_bf16 v[16:31], a[168:171], a[20:23], v[16:31]
    v_mfma_f32_32x32x16_bf16 v[32:47], a[172:175], a[20:23], v[32:47]
    s_waitcnt vmcnt(18)
    v_mfma_f32_32x32x16_bf16 v[16:31], a[176:179], a[24:27], v[16:31]
    v_mfma_f32_32x32x16_bf16 v[32:47], a[180:183], a[24:27], v[32:47]
    s_waitcnt vmcnt(17)
    v_mfma_f32_32x32x16_bf16 v[16:31], a[184:187], a[28:31], v[16:31]
    v_mfma_f32_32x32x16_bf16 v[32:47], a[188:191], a[28:31], v[32:47]
    s_waitcnt vmcnt(16)
    v_mfma_f32_32x32x16_bf16 v[16:31], a[192:195], a[32:35], v[16:31]
    v_mfma_f32_32x32x16_bf16 v[32:47], a[196:199], a[32:35], v[32:47]
    s_waitcnt vmcnt(15)
    v_mfma_f32_32x32x16_bf16 v[16:31], a[200:203], a[36:39], v[16:31]
    v_mfma_f32_32x32x16_bf16 v[32:47], a[204:207], a[36:39], v[32:47]
    s_waitcnt vmcnt(14)
    v_mfma_f32_32x32x16_bf16 v[16:31], a[208:211], a[40:43], v[16:31]
    v_mfma_f32_32x32x16_bf16 v[32:47], a[212:215], a[40:43], v[32:47]
    s_waitcnt vmcnt(13)
    v_mfma_f32_32x32x16_bf16 v[16:31], a[216:219], a[44:47], v[16:31]
    v_mfma_f32_32x32x16_bf16 v[32:47], a[220:223], a[44:47], v[32:47]
    s_waitcnt vmcnt(12)
    v_mfma_f32_32x32x16_bf16 v[16:31], a[224:227], a[48:51], v[16:31]
    v_mfma_f32_32x32x16_bf16 v[32:47], a[228:231], a[48:51], v[32:47]
    s_waitcnt vmcnt(4)
    v_lshlrev_b32 v92, 16, v88
    v_and_b32 v93, 0xffff0000, v88
    v_lshlrev_b32 v94, 16, v89
    v_and_b32 v95, 0xffff0000, v89
    v_lshlrev_b32 v96, 16, v90
    v_and_b32 v97, 0xffff0000, v90
    v_lshlrev_b32 v98, 16, v91
    v_and_b32 v99, 0xffff0000, v91
    v_mfma_f32_32x32x16_bf16 v[16:31], a[232:235], a[52:55], v[16:31]
    v_mfma_f32_32x32x16_bf16 v[32:47], a[236:239], a[52:55], v[32:47]
    v_mfma_f32_32x32x16_bf16 v[16:31], a[240:243], a[56:59], v[16:31]
    v_mfma_f32_32x32x16_bf16 v[32:47], a[244:247], a[56:59], v[32:47]
    v_mfma_f32_32x32x16_bf16 v[16:31], a[248:251], a[60:63], v[16:31]
    v_mfma_f32_32x32x16_bf16 v[32:47], a[252:255], a[60:63], v[32:47]
    v_mfma_f32_32x32x16_bf16 v[16:31], v[208:211], a[64:67], v[16:31]
    v_mfma_f32_32x32x16_bf16 v[32:47], v[212:215], a[64:67], v[32:47]
    s_waitcnt vmcnt(0)
    v_lshlrev_b32 v192, 16, v80
    v_and_b32 v193, 0xffff0000, v80
    v_lshlrev_b32 v194, 16, v81
    v_and_b32 v195, 0xffff0000, v81
    v_lshlrev_b32 v196, 16, v82
    v_and_b32 v197, 0xffff0000, v82
    v_mfma_f32_32x32x16_bf16 v[16:31], v[216:219], a[68:71], v[16:31]
    v_mfma_f32_32x32x16_bf16 v[32:47], v[220:223], a[68:71], v[32:47]
    buffer_load_dword v14, v11, s[44:47], s61 offen sc1
    v_lshlrev_b32 v198, 16, v83
    v_and_b32 v199, 0xffff0000, v83
    v_and_b32 v106, 0xffff0000, v106
    v_rcp_f32 v106, v106
    v_sqrt_f32 v160, |v192|
    v_sqrt_f32 v161, |v193|
    v_mfma_f32_32x32x16_bf16 v[16:31], v[224:227], a[72:75], v[16:31]
    v_mfma_f32_32x32x16_bf16 v[32:47], v[228:231], a[72:75], v[32:47]
    v_sqrt_f32 v162, |v194|
    v_sqrt_f32 v163, |v195|
    v_sqrt_f32 v164, |v196|
    v_sqrt_f32 v165, |v197|
    v_sqrt_f32 v166, |v198|
    v_sqrt_f32 v167, |v199|
    v_mfma_f32_32x32x16_bf16 v[16:31], v[232:235], a[76:79], v[16:31]
    v_mfma_f32_32x32x16_bf16 v[32:47], v[236:239], a[76:79], v[32:47]
    v_mul_f32 v106, v106, v106
    v_bfi_b32 v192, v12, v160, v192
    v_bfi_b32 v193, v12, v161, v193
    v_bfi_b32 v194, v12, v162, v194
    v_bfi_b32 v195, v12, v163, v195
    v_bfi_b32 v196, v12, v164, v196
    v_mfma_f32_32x32x16_bf16 v[16:31], v[240:243], a[80:83], v[16:31]
    v_mfma_f32_32x32x16_bf16 v[32:47], v[244:247], a[80:83], v[32:47]
    v_bfi_b32 v197, v12, v165, v197
    v_bfi_b32 v198, v12, v166, v198
    v_bfi_b32 v199, v12, v167, v199
    v_fma_f32 v192, v192, v13, v92
    v_fma_f32 v193, v193, v13, v93
    v_fma_f32 v194, v194, v13, v94
    v_mfma_f32_32x32x16_bf16 v[16:31], v[248:251], a[84:87], v[16:31]
    v_mfma_f32_32x32x16_bf16 v[32:47], v[252:255], a[84:87], v[32:47]
    v_fma_f32 v195, v195, v13, v95
    v_fma_f32 v196, v196, v13, v96
    v_fma_f32 v197, v197, v13, v97
    v_fma_f32 v198, v198, v13, v98
    v_fma_f32 v199, v199, v13, v99
    s_add_u32 s68, s68, 159744
    s_waitcnt vmcnt(0)
    v_cmp_ne_u32 vcc, 15, v14
    s_cbranch_vccz L_b3b_ok
    v_and_b32 v4, 0, v1
    v_lshlrev_b32 v4, 8, v4
L_pl_20:
    buffer_load_dword v3, v4, s[44:47], s61 offen sc1
    s_waitcnt vmcnt(0)
    v_cmp_ne_u32 vcc, 15, v3
    s_cbranch_vccz L_pw_19
    s_sub_u32 s48, s48, 1
    s_cbranch_scc1 L_pw_19_t
    s_sleep 1
    s_branch L_pl_20
L_pw_19_t:
    s_mov_b32 s48, 0
L_pw_19:
L_b3b_ok:
    buffer_load_dwordx4 a[88:91], v2, s[44:47], s68 offen offset:0 sc1
    buffer_load_dwordx4 a[92:95], v2, s[44:47], s68 offen offset:1024 sc1
    buffer_load_dwordx4 a[96:99], v2, s[44:47], s68 offen offset:2048 sc1
    buffer_load_dwordx4 a[100:103], v2, s[44:47], s68 offen offset:3072 sc1
    s_add_u32 s68, s68, 4096
    buffer_load_dwordx4 a[104:107], v2, s[44:47], s68 offen offset:0 sc1
    buffer_load_dwordx4 a[108:111], v2, s[44:47], s68 offen offset:1024 sc1
    buffer_load_dwordx4 a[112:115], v2, s[44:47], s68 offen offset:2048 sc1
    buffer_load_dwordx4 a[116:119], v2, s[44:47], s68 offen offset:3072 sc1
    s_add_u32 s68, s68, 4096
    buffer_load_dwordx4 a[120:123], v2, s[44:47], s68 offen offset:0 sc1
    buffer_load_dwordx4 a[124:127], v2, s[44:47], s68 offen offset:1024 sc1
    ds_write_b128 v100, v[16:19] offset:0
    ds_write_b128 v101, v[20:23] offset:0
    ds_write_b128 v102, v[24:27] offset:0
    ds_write_b128 v103, v[28:31] offset:0
    ds_write_b128 v100, v[32:35] offset:128
    ds_write_b128 v101, v[36:39] offset:128
    ds_write_b128 v102, v[40:43] offset:128
    ds_write_b128 v103, v[44:47] offset:128
    s_waitcnt lgkmcnt(0)
    s_barrier
    ds_read_b128 v[160:163], v104 offset:0
    ds_read_b128 v[164:167], v105 offset:0
    ds_read_b128 v[168:171], v104 offset:8192
    ds_read_b128 v[172:175], v105 offset:8192
    ds_read_b128 v[176:179], v104 offset:16384
    ds_read_b128 v[180:183], v105 offset:16384
    ds_read_b128 v[184:187], v104 offset:24576
    ds_read_b128 v[188:191], v105 offset:24576
    buffer_load_dwordx4 v[112:115], v2, s[44:47], s68 offen offset:2048 sc1
    buffer_load_dwordx4 v[116:119], v2, s[44:47], s68 offen offset:3072 sc1
    s_add_u32 s68, s68, 4096
    s_waitcnt lgkmcnt(4)
    v_pk_add_f32 v[160:161], v[160:161], v[168:169]
    v_pk_add_f32 v[162:163], v[162:163], v[170:171]
    v_pk_add_f32 v[164:165], v[164:165], v[172:173]
    v_pk_add_f32 v[166:167], v[166:167], v[174:175]
    s_waitcnt lgkmcnt(0)
    v_pk_add_f32 v[176:177], v[176:177], v[184:185]
    v_pk_add_f32 v[178:179], v[178:179], v[186:187]
    v_pk_add_f32 v[180:181], v[180:181], v[188:189]
    v_pk_add_f32 v[182:183], v[182:183], v[190:191]
    v_pk_add_f32 v[160:161], v[160:161], v[176:177]
    v_pk_add_f32 v[162:163], v[162:163], v[178:179]
    v_pk_add_f32 v[164:165], v[164:165], v[180:181]
    v_pk_add_f32 v[166:167], v[166:167], v[182:183]
    buffer_load_dwordx4 v[120:123], v2, s[44:47], s68 offen offset:0 sc1
    buffer_load_dwordx4 v[124:127], v2, s[44:47], s68 offen offset:1024 sc1
    v_fma_f32 v160, v160, v106, v192
    v_fma_f32 v161, v161, v106, v193
    v_fma_f32 v162, v162, v106, v194
    v_fma_f32 v163, v163, v106, v195
    v_fma_f32 v164, v164, v106, v196
    v_fma_f32 v165, v165, v106, v197
    v_fma_f32 v166, v166, v106, v198
    v_fma_f32 v167, v167, v106, v199
    buffer_load_dwordx4 v[128:131], v2, s[44:47], s68 offen offset:2048 sc1
    buffer_load_dwordx4 v[132:135], v2, s[44:47], s68 offen offset:3072 sc1
    s_add_u32 s68, s68, 4096
    v_cvt_pk_bf16_f32 v200, v160, v161
    v_cvt_pk_bf16_f32 v201, v162, v163
    v_cvt_pk_bf16_f32 v202, v164, v165
    v_cvt_pk_bf16_f32 v203, v166, v167
    s_add_u32 s51, s56, 0
    buffer_store_dwordx4 v[200:203], v6, s[36:39], s51 offen sc1
    s_waitcnt vmcnt(16)
    v_mfma_f32_32x32x16_bf16 v[48:63], a[128:131], a[88:91], 0
    buffer_load_dwordx4 v[136:139], v2, s[44:47], s68 offen offset:0 sc1
    v_mfma_f32_32x32x16_bf16 v[64:79], a[132:135], a[88:91], 0
    s_waitcnt vmcnt(16)
    v_mfma_f32_32x32x16_bf16 v[48:63], a[136:139], a[92:95], v[48:63]
    buffer_load_dwordx4 v[140:143], v2, s[44:47], s68 offen offset:1024 sc1
    v_mfma_f32_32x32x16_bf16 v[64:79], a[140:143], a[92:95], v[64:79]
    s_waitcnt vmcnt(16)
    v_mfma_f32_32x32x16_bf16 v[48:63], a[144:147], a[96:99], v[48:63]
    buffer_load_dwordx4 v[144:147], v2, s[44:47], s68 offen offset:2048 sc1
    v_mfma_f32_32x32x16_bf16 v[64:79], a[148:151], a[96:99], v[64:79]
    s_waitcnt vmcnt(16)
    v_mfma_f32_32x32x16_bf16 v[48:63], a[152:155], a[100:103], v[48:63]
    buffer_load_dwordx4 v[148:151], v2, s[44:47], s68 offen offset:3072 sc1
    s_add_u32 s68, s68, 4096
    v_mfma_f32_32x32x16_bf16 v[64:79], a[156:159], a[100:103], v[64:79]
    s_waitcnt vmcnt(16)
    v_mfma_f32_32x32x16_bf16 v[48:63], a[160:163], a[104:107], v[48:63]
    buffer_load_dwordx4 v[152:155], v2, s[44:47], s68 offen offset:0 sc1
    v_mfma_f32_32x32x16_bf16 v[64:79], a[164:167], a[104:107], v[64:79]
    s_waitcnt vmcnt(16)
    v_mfma_f32_32x32x16_bf16 v[48:63], a[168:171], a[108:111], v[48:63]
    buffer_load_dwordx4 v[156:159], v2, s[44:47], s68 offen offset:1024 sc1
    v_mfma_f32_32x32x16_bf16 v[64:79], a[172:175], a[108:111], v[64:79]
    s_waitcnt vmcnt(16)
    v_mfma_f32_32x32x16_bf16 v[48:63], a[176:179], a[112:115], v[48:63]
    s_add_u32 s51, s55, 65536
    buffer_load_dwordx4 v[84:87], v5, s[44:47], s51 offen sc1
    buffer_load_dword v107, v9, s[44:47], s58 offen offset:256 sc1
    v_mfma_f32_32x32x16_bf16 v[64:79], a[180:183], a[112:115], v[64:79]
    s_waitcnt vmcnt(17)
    v_mfma_f32_32x32x16_bf16 v[48:63], a[184:187], a[116:119], v[48:63]
    v_mfma_f32_32x32x16_bf16 v[64:79], a[188:191], a[116:119], v[64:79]
    s_waitcnt vmcnt(16)
    v_mfma_f32_32x32x16_bf16 v[48:63], a[192:195], a[120:123], v[48:63]
    v_mfma_f32_32x32x16_bf16 v[64:79], a[196:199], a[120:123], v[64:79]
    s_waitcnt vmcnt(15)
    v_mfma_f32_32x32x16_bf16 v[48:63], a[200:203], a[124:127], v[48:63]
    v_mfma_f32_32x32x16_bf16 v[64:79], a[204:207], a[124:127], v[64:79]
    s_waitcnt vmcnt(14)
    v_mfma_f32_32x32x16_bf16 v[48:63], a[208:211], v[112:115], v[48:63]
    v_mfma_f32_32x32x16_bf16 v[64:79], a[212:215], v[112:115], v[64:79]
    s_waitcnt vmcnt(13)
    v_mfma_f32_32x32x16_bf16 v[48:63], a[216:219], v[116:119], v[48:63]
    v_mfma_f32_32x32x16_bf16 v[64:79], a[220:223], v[116:119], v[64:79]
    s_waitcnt vmcnt(12)
    v_mfma_f32_32x32x16_bf16 v[48:63], a[224:227], v[120:123], v[48:63]
    v_mfma_f32_32x32x16_bf16 v[64:79], a[228:231], v[120:123], v[64:79]
    s_waitcnt vmcnt(11)
    v_mfma_f32_32x32x16_bf16 v[48:63], a[232:235], v[124:127], v[48:63]
    v_mfma_f32_32x32x16_bf16 v[64:79], a[236:239], v[124:127], v[64:79]
    s_waitcnt vmcnt(10)
    v_mfma_f32_32x32x16_bf16 v[48:63], a[240:243], v[128:131], v[48:63]
    v_mfma_f32_32x32x16_bf16 v[64:79], a[244:247], v[128:131], v[64:79]
    s_waitcnt vmcnt(0)
    v_lshlrev_b32 v192, 16, v84
    v_and_b32 v193, 0xffff0000, v84
    v_lshlrev_b32 v194, 16, v85
    v_and_b32 v195, 0xffff0000, v85
    v_lshlrev_b32 v196, 16, v86
    v_and_b32 v197, 0xffff0000, v86
    v_mfma_f32_32x32x16_bf16 v[48:63], a[248:251], v[132:135], v[48:63]
    v_mfma_f32_32x32x16_bf16 v[64:79], a[252:255], v[132:135], v[64:79]
    v_lshlrev_b32 v198, 16, v87
    v_and_b32 v199, 0xffff0000, v87
    v_and_b32 v107, 0xffff0000, v107
    v_rcp_f32 v107, v107
    v_sqrt_f32 v160, |v192|
    v_sqrt_f32 v161, |v193|
    v_mfma_f32_32x32x16_bf16 v[48:63], v[208:211], v[136:139], v[48:63]
    v_mfma_f32_32x32x16_bf16 v[64:79], v[212:215], v[136:139], v[64:79]
    v_sqrt_f32 v162, |v194|
    v_sqrt_f32 v163, |v195|
    v_sqrt_f32 v164, |v196|
    v_sqrt_f32 v165, |v197|
    v_sqrt_f32 v166, |v198|
    v_sqrt_f32 v167, |v199|
    v_mfma_f32_32x32x16_bf16 v[48:63], v[216:219], v[140:143], v[48:63]
    v_mfma_f32_32x32x16_bf16 v[64:79], v[220:223], v[140:143], v[64:79]
    v_mul_f32 v107, v107, v107
    v_bfi_b32 v192, v12, v160, v192
    v_bfi_b32 v193, v12, v161, v193
    v_bfi_b32 v194, v12, v162, v194
    v_bfi_b32 v195, v12, v163, v195
    v_bfi_b32 v196, v12, v164, v196
    v_mfma_f32_32x32x16_bf16 v[48:63], v[224:227], v[144:147], v[48:63]
    v_mfma_f32_32x32x16_bf16 v[64:79], v[228:231], v[144:147], v[64:79]
    v_bfi_b32 v197, v12, v165, v197
    v_bfi_b32 v198, v12, v166, v198
    v_bfi_b32 v199, v12, v167, v199
    v_fma_f32 v192, v192, v13, v92
    v_fma_f32 v193, v193, v13, v93
    v_fma_f32 v194, v194, v13, v94
    v_mfma_f32_32x32x16_bf16 v[48:63], v[232:235], v[148:151], v[48:63]
    v_mfma_f32_32x32x16_bf16 v[64:79], v[236:239], v[148:151], v[64:79]
    v_fma_f32 v195, v195, v13, v95
    v_fma_f32 v196, v196, v13, v96
    v_fma_f32 v197, v197, v13, v97
    v_fma_f32 v198, v198, v13, v98
    v_fma_f32 v199, v199, v13, v99
    v_mfma_f32_32x32x16_bf16 v[48:63], v[240:243], v[152:155], v[48:63]
    v_mfma_f32_32x32x16_bf16 v[64:79], v[244:247], v[152:155], v[64:79]
    v_mfma_f32_32x32x16_bf16 v[48:63], v[248:251], v[156:159], v[48:63]
    v_mfma_f32_32x32x16_bf16 v[64:79], v[252:255], v[156:159], v[64:79]
    s_nop 10
    ds_write_b128 v100, v[48:51] offset:32768
    ds_write_b128 v101, v[52:55] offset:32768
    ds_write_b128 v102, v[56:59] offset:32768
    ds_write_b128 v103, v[60:63] offset:32768
    ds_write_b128 v100, v[64:67] offset:32896
    ds_write_b128 v101, v[68:71] offset:32896
    ds_write_b128 v102, v[72:75] offset:32896
    ds_write_b128 v103, v[76:79] offset:32896
    s_waitcnt lgkmcnt(0)
    s_barrier
    ds_read_b128 v[160:163], v104 offset:32768
    ds_read_b128 v[164:167], v105 offset:32768
    ds_read_b128 v[168:171], v104 offset:40960
    ds_read_b128 v[172:175], v105 offset:40960
    ds_read_b128 v[176:179], v104 offset:49152
    ds_read_b128 v[180:183], v105 offset:49152
    ds_read_b128 v[184:187], v104 offset:57344
    ds_read_b128 v[188:191], v105 offset:57344
    s_waitcnt lgkmcnt(4)
    v_pk_add_f32 v[160:161], v[160:161], v[168:169]
    v_pk_add_f32 v[162:163], v[162:163], v[170:171]
    v_pk_add_f32 v[164:165], v[164:165], v[172:173]
    v_pk_add_f32 v[166:167], v[166:167], v[174:175]
    s_waitcnt lgkmcnt(0)
    v_pk_add_f32 v[176:177], v[176:177], v[184:185]
    v_pk_add_f32 v[178:179], v[178:179], v[186:187]
    v_pk_add_f32 v[180:181], v[180:181], v[188:189]
    v_pk_add_f32 v[182:183], v[182:183], v[190:191]
    v_pk_add_f32 v[160:161], v[160:161], v[176:177]
    v_pk_add_f32 v[162:163], v[162:163], v[178:179]
    v_pk_add_f32 v[164:165], v[164:165], v[180:181]
    v_pk_add_f32 v[166:167], v[166:167], v[182:183]
    v_fma_f32 v160, v160, v107, v192
    v_fma_f32 v161, v161, v107, v193
    v_fma_f32 v162, v162, v107, v194
    v_fma_f32 v163, v163, v107, v195
    v_fma_f32 v164, v164, v107, v196
    v_fma_f32 v165, v165, v107, v197
    v_fma_f32 v166, v166, v107, v198
    v_fma_f32 v167, v167, v107, v199
    v_cvt_pk_bf16_f32 v200, v160, v161
    v_cvt_pk_bf16_f32 v201, v162, v163
    v_cvt_pk_bf16_f32 v202, v164, v165
    v_cvt_pk_bf16_f32 v203, v166, v167
    s_add_u32 s51, s56, 65536
    buffer_store_dwordx4 v[200:203], v6, s[36:39], s51 offen sc1
L_end:
    s_endpgm
.p2align 8
L_tw:
.long 0x3f800000,0x3f800000,0x3f800000,0x3f800000,0x3f800000,0x3f7fffb1,0x3f7ffec4,0x3f7ffd39
.long 0x3f800000,0x3f7ffec4,0x3f7ffb11,0x3f7ff4e6,0x3f800000,0x3f7ffd39,0x3f7ff4e6,0x3f7fe705
.long 0x3f800000,0x3f7ffb11,0x3f7fec43,0x3f7fd397,0x3f800000,0x3f7ff84a,0x3f7fe129,0x3f7fba9e
.long 0x3f800000,0x3f7ff4e6,0x3f7fd397,0x3f7f9c18,0x3f800000,0x3f7ff0e3,0x3f7fc38f,0x3f7f7808
.long 0x3f800000,0x3f7fec43,0x3f7fb10f,0x3f7f4e6d,0x3f800000,0x3f7fe705,0x3f7f9c18,0x3f7f1f49
.long 0x3f800000,0x3f7fe129,0x3f7f84ab,0x3f7eea9d,0x3f800000,0x3f7fdaaf,0x3f7f6ac7,0x3f7eb069
.long 0x3f800000,0x3f7fd397,0x3f7f4e6d,0x3f7e70b0,0x3f800000,0x3f7fcbe2,0x3f7f2f9d,0x3f7e2b72
.long 0x3f800000,0x3f7fc38f,0x3f7f0e58,0x3f7de0b1,0x3f800000,0x3f7fba9e,0x3f7eea9d,0x3f7d906e
.long 0x3f800000,0x3f800000,0x3f800000,0x3f800000,0x3f7ffb11,0x3f7ff84a,0x3f7ff4e6,0x3f7ff0e3
.long 0x3f7fec43,0x3f7fe129,0x3f7fd397,0x3f7fc38f,0x3f7fd397,0x3f7fba9e,0x3f7f9c18,0x3f7f7808
.long 0x3f7fb10f,0x3f7f84ab,0x3f7f4e6d,0x3f7f0e58,0x3f7f84ab,0x3f7f3f54,0x3f7eea9d,0x3f7e868b
.long 0x3f7f4e6d,0x3f7eea9d,0x3f7e70b0,0x3f7de0b1,0x3f7f0e58,0x3f7e868b,0x3f7de0b1,0x3f7d1cdd
.long 0x3f7ec46d,0x3f7e1324,0x3f7d3aac,0x3f7c3b28,0x3f7e70b0,0x3f7d906e,0x3f7c7eb0,0x3f7b3bab
.long 0x3f7e1324,0x3f7cfe73,0x3f7baccd,0x3f7a1e84,0x3f7dabcc,0x3f7c5d3a,0x3f7ac516,0x3f78e3d6
.long 0x3f7d3aac,0x3f7baccd,0x3f79c79d,0x3f778bc5,0x3f7cbfc9,0x3f7aed37,0x3f78b47b,0x3f76167a
.long 0x3f7c3b28,0x3f7a1e84,0x3f778bc5,0x3f748422,0x3f7baccd,0x3f7940c0,0x3f764d97,0x3f72d4eb
.long 0x3f800000,0x3f800000,0x3f800000,0x3f800000,0x3f7fec43,0x3f7fe705,0x3f7fe129,0x3f7fdaaf
.long 0x3f7fb10f,0x3f7f9c18,0x3f7f84ab,0x3f7f6ac7,0x3f7f4e6d,0x3f7f1f49,0x3f7eea9d,0x3f7eb069
.long 0x3f7ec46d,0x3f7e70b0,0x3f7e1324,0x3f7dabcc,0x3f7e1324,0x3f7d906e,0x3f7cfe73,0x3f7c5d3a
.long 0x3f7d3aac,0x3f7c7eb0,0x3f7baccd,0x3f7ac516,0x3f7c3b28,0x3f7b3bab,0x3f7a1e84,0x3f78e3d6
.long 0x3f7b14be,0x3f79c79d,0x3f7853f8,0x3f76ba07,0x3f79c79d,0x3f7822d1,0x3f764d97,0x3f74484b
.long 0x3f7853f8,0x3f764d97,0x3f740bdd,0x3f718f57,0x3f76ba07,0x3f74484b,0x3f718f57,0x3f6e8ff8
.long 0x3f74fa0b,0x3f721352,0x3f6ed89e,0x3f6b4b0c,0x3f731447,0x3f6faf1b,0x3f6be858,0x3f67c187
.long 0x3f710908,0x3f6d1c1d,0x3f68bf3c,0x3f63f473,0x3f6ed89e,0x3f6a5ad9,0x3f655e0b,0x3f5fe4e9
.long 0x3f800000,0x3f800000,0x3f800000,0x3f800000,0x3f7fd397,0x3f7fcbe2,0x3f7fc38f,0x3f7fba9e
.long 0x3f7f4e6d,0x3f7f2f9d,0x3f7f0e58,0x3f7eea9d,0x3f7e70b0,0x3f7e2b72,0x3f7de0b1,0x3f7d906e
.long 0x3f7d3aac,0x3f7cbfc9,0x3f7c3b28,0x3f7baccd,0x3f7baccd,0x3f7aed37,0x3f7a1e84,0x3f7940c0
.long 0x3f79c79d,0x3f78b47b,0x3f778bc5,0x3f764d97,0x3f778bc5,0x3f76167a,0x3f748422,0x3f72d4eb
.long 0x3f74fa0b,0x3f731447,0x3f710908,0x3f6ed89e,0x3f721352,0x3f6faf1b,0x3f6d1c1d,0x3f6a5ad9
.long 0x3f6ed89e,0x3f6be858,0x3f68bf3c,0x3f655e0b,0x3f6b4b0c,0x3f67c187,0x3f63f473,0x3f5fe4e9
.long 0x3f676bd8,0x3f633c5a,0x3f5ebe05,0x3f59f26a,0x3f633c5a,0x3f5e5aa6,0x3f591e6a,0x3f5389c7
.long 0x3f5ebe05,0x3f591e6a,0x3f531849,0x3f4cae79,0x3f59f26a,0x3f5389c7,0x3f4cae79,0x3f456439
.long 0x3f800000,0x3f800000,0x3f800000,0x3f800000,0x3f7fb10f,0x3f7fa6e3,0x3f7f9c18,0x3f7f90b1
.long 0x3f7ec46d,0x3f7e9bc9,0x3f7e70b0,0x3f7e4323,0x3f7d3aac,0x3f7cdf6c,0x3f7c7eb0,0x3f7c187a
.long 0x3f7b14be,0x3f7a7302,0x3f79c79d,0x3f791298,0x3f7853f8,0x3f77583a,0x3f764d97,0x3f75341d
.long 0x3f74fa0b,0x3f73913f,0x3f721352,0x3f708066,0x3f710908,0x3f6f20b0,0x3f6d1c1d,0x3f6afb8c
.long 0x3f6c835e,0x3f6a09a7,0x3f676bd8,0x3f64aa59,0x3f676bd8,0x3f644fac,0x3f6106f2,0x3f5d924d
.long 0x3f61c598,0x3f5df6be,0x3f59f26a,0x3f55b993,0x3f5b941a,0x3f570348,0x3f5233c6,0x3f4d26fd
.long 0x3f54db31,0x3f4f7a1f,0x3f49d112,0x3f43e200,0x3f4d9f02,0x3f476085,0x3f40d0da,0x3f39f2ac
.long 0x3f45e403,0x3f3ebc1b,0x3f373a23,0x3f2f61a5,0x3f3daef9,0x3f3592e7,0x3f2d1469,0x3f24381a
.long 0x3f800000,0x3f800000,0x3f800000,0x3f800000,0x3f7f84ab,0x3f7f7808,0x3f7f6ac7,0x3f7f5ce9
.long 0x3f7e1324,0x3f7de0b1,0x3f7dabcc,0x3f7d7474,0x3f7baccd,0x3f7b3bab,0x3f7ac516,0x3f7a4910
.long 0x3f7853f8,0x3f778bc5,0x3f76ba07,0x3f75dec6,0x3f740bdd,0x3f72d4eb,0x3f718f57,0x3f703b37
.long 0x3f6ed89e,0x3f6d1c1d,0x3f6b4b0c,0x3f696591,0x3f68bf3c,0x3f666771,0x3f63f473,0x3f61668a
.long 0x3f61c598,0x3f5ebe05,0x3f5b941a,0x3f584853,0x3f59f26a,0x3f5627fe,0x3f5233c6,0x3f4e1689
.long 0x3f514d3d,0x3f4cae79,0x3f47de65,0x3f42de29,0x3f47de65,0x3f425b89,0x3f3ca003,0x3f36ad7f
.long 0x3f3daef9,0x3f373a23,0x3f3085bb,0x3f299415,0x3f32c8c9,0x3f2b561b,0x3f239da9,0x3f1ba299
.long 0x3f273656,0x3f1ebc12,0x3f15f6d9,0x3f0cead0,0x3f1b02c6,0x3f11796b,0x3f07a136,0x3efafef7
.long 0x3f800000,0x3f800000,0x3f800000,0x3f800000,0x3f7f4e6d,0x3f7f3f54,0x3f7f2f9d,0x3f7f1f49
.long 0x3f7d3aac,0x3f7cfe73,0x3f7cbfc9,0x3f7c7eb0,0x3f79c79d,0x3f7940c0,0x3f78b47b,0x3f7822d1
.long 0x3f74fa0b,0x3f740bdd,0x3f731447,0x3f721352,0x3f6ed89e,0x3f6d67a1,0x3f6be858,0x3f6a5ad9
.long 0x3f676bd8,0x3f655e0b,0x3f633c5a,0x3f6106f2,0x3f5ebe05,0x3f5bfb34,0x3f591e6a,0x3f5627fe
.long 0x3f54db31,0x3f514d3d,0x3f4d9f02,0x3f49d112,0x3f49d112,0x3f456439,0x3f40d0da,0x3f3c17d9
.long 0x3f3daef9,0x3f385216,0x3f32c8c9,0x3f2d1469,0x3f3085bb,0x3f2a2a80,0x3f239da9,0x3f1ce11f
.long 0x3f226799,0x3f1b02c6,0x3f13682a,0x3f0b9a6b,0x3f13682a,0x3f0af1b7,0x3f0242b1,0x3ef2bd43
.long 0x3f039c3d,0x3ef41f07,0x3ee0924f,0x3ecc9b8b,0x3ee63375,0x3ed0eb2a,0x3ebb31a0,0x3ea5129f
.long 0x3f800000,0x3f800000,0x3f800000,0x3f800000,0x3f7f0e58,0x3f7efcc9,0x3f7eea9d,0x3f7ed7d4
.long 0x3f7c3b28,0x3f7bf531,0x3f7baccd,0x3f7b61fc,0x3f778bc5,0x3f76ef5b,0x3f764d97,0x3f75a67b
.long 0x3f710908,0x3f6ff573,0x3f6ed89e,0x3f6db293,0x3f68bf3c,0x3f671599,0x3f655e0b,0x3f6398ac
.long 0x3f5ebe05,0x3f5c61c7,0x3f59f26a,0x3f577026,0x3f531849,0x3f4fefa8,0x3f4cae79,0x3f495521
.long 0x3f45e403,0x3f41d870,0x3f3daef9,0x3f396842,0x3f373a23,0x3f3238aa,0x3f2d1469,0x3f27ce61
.long 0x3f273656,0x3f212ff9,0x3f1b02c6,0x3f14b039,0x3f15f6d9,0x3f0ee0db,0x3f07a136,0x3f003a06
.long 0x3f039c3d,0x3ef6e0cb,0x3ee63375,0x3ed53641,0x3ee0924f,0x3ece0bea,0x3ebb31a0,0x3ea80b1f
.long 0x3eb8442a,0x3ea395c5,0x3e8e9a22,0x3e72b651,0x3e8e9a22,0x3e6fa8b2,0x3e419b37,0x3e1324ca
.long 0x0,0x0,0x0,0x0,0x0,0x3b490fc6,0x3bc90f88,0x3c16cb58
.long 0x0,0x3bc90f88,0x3c490e90,0x3c96c9b6,0x0,0x3c16cb58,0x3c96c9b6,0x3ce22a7a
.long 0x0,0x3c490e90,0x3cc90ab0,0x3d16c32c,0x0,0x3c7b514b,0x3cfb49ba,0x3d3c6dd5
.long 0x0,0x3c96c9b6,0x3d16c32c,0x3d621469,0x0,0x3cafea69,0x3d2fe007,0x3d83db0a
.long 0x0,0x3cc90ab0,0x3d48fb30,0x3d96a905,0x0,0x3ce22a7a,0x3d621469,0x3da973ba
.long 0x0,0x3cfb49ba,0x3d7b2b74,0x3dbc3ac3,0x0,0x3d0a342f,0x3d8a200a,0x3dcefdb7
.long 0x0,0x3d16c32c,0x3d96a905,0x3de1bc2e,0x0,0x3d2351cb,0x3da3308c,0x3df475c0
.long 0x0,0x3d2fe007,0x3dafb680,0x3e039502,0x0,0x3d3c6dd5,0x3dbc3ac3,0x3e0cec4a
.long 0x0,0x0,0x0,0x0,0x3c490e90,0x3c7b514b,0x3c96c9b6,0x3cafea69
.long 0x3cc90ab0,0x3cfb49ba,0x3d16c32c,0x3d2fe007,0x3d16c32c,0x3d3c6dd5,0x3d621469,0x3d83db0a
.long 0x3d48fb30,0x3d7b2b74,0x3d96a905,0x3dafb680,0x3d7b2b74,0x3d9cecf9,0x3dbc3ac3,0x3ddb7d37
.long 0x3d96a905,0x3dbc3ac3,0x3de1bc2e,0x3e039502,0x3dafb680,0x3ddb7d37,0x3e039502,0x3e195be0
.long 0x3dc8bd36,0x3dfab273,0x3e164083,0x3e2f10a2,0x3de1bc2e,0x3e0cec4a,0x3e28defc,0x3e44b0b9
.long 0x3dfab273,0x3e1c76de,0x3e3b6ecf,0x3e5a3997,0x3e09cf86,0x3e2bf804,0x3e4dee60,0x3e6fa8b2
.long 0x3e164083,0x3e3b6ecf,0x3e605c13,0x3e827dc0,0x3e22abb6,0x3e4ada4f,0x3e72b651,0x3e8d17c0
.long 0x3e2f10a2,0x3e5a3997,0x3e827dc0,0x3e97a117,0x3e3b6ecf,0x3e698bba,0x3e8b9507,0x3ea21887
.long 0x0,0x0,0x0,0x0,0x3cc90ab0,0x3ce22a7a,0x3cfb49ba,0x3d0a342f
.long 0x3d48fb30,0x3d621469,0x3d7b2b74,0x3d8a200a,0x3d96a905,0x3da973ba,0x3dbc3ac3,0x3dcefdb7
.long 0x3dc8bd36,0x3de1bc2e,0x3dfab273,0x3e09cf86,0x3dfab273,0x3e0cec4a,0x3e1c76de,0x3e2bf804
.long 0x3e164083,0x3e28defc,0x3e3b6ecf,0x3e4dee60,0x3e2f10a2,0x3e44b0b9,0x3e5a3997,0x3e6fa8b2
.long 0x3e47c5c2,0x3e605c13,0x3e78cfcc,0x3e888e93,0x3e605c13,0x3e7bdba4,0x3e8b9507,0x3e9920fe
.long 0x3e78cfcc,0x3e8b9507,0x3e9aa086,0x3ea986c4,0x3e888e93,0x3e9920fe,0x3ea986c4,0x3eb9bb1e
.long 0x3e94a031,0x3ea68f12,0x3eb8442a,0x3ec9b953,0x3ea09ae5,0x3eb3dca5,0x3ec6d529,0x3ed97cb9
.long 0x3eac7cd4,0x3ec1071e,0x3ed53641,0x3ee900b7,0x3eb8442a,0x3ece0bea,0x3ee363fa,0x3ef840c8
.long 0x0,0x0,0x0,0x0,0x3d16c32c,0x3d2351cb,0x3d2fe007,0x3d3c6dd5
.long 0x3d96a905,0x3da3308c,0x3dafb680,0x3dbc3ac3,0x3de1bc2e,0x3df475c0,0x3e039502,0x3e0cec4a
.long 0x3e164083,0x3e22abb6,0x3e2f10a2,0x3e3b6ecf,0x3e3b6ecf,0x3e4ada4f,0x3e5a3997,0x3e698bba
.long 0x3e605c13,0x3e72b651,0x3e827dc0,0x3e8b9507,0x3e827dc0,0x3e8d17c0,0x3e97a117,0x3ea21887
.long 0x3e94a031,0x3ea09ae5,0x3eac7cd4,0x3eb8442a,0x3ea68f12,0x3eb3dca5,0x3ec1071e,0x3ece0bea
.long 0x3eb8442a,0x3ec6d529,0x3ed53641,0x3ee363fa,0x3ec9b953,0x3ed97cb9,0x3ee900b7,0x3ef840c8
.long 0x3edae880,0x3eebcbbb,0x3efc5d27,0x3f064b82,0x3eebcbbb,0x3efdbabb,0x3f07a136,0x3f102dd5
.long 0x3efc5d27,0x3f07a136,0x3f10d3cd,0x3f19c200,0x3f064b82,0x3f102dd5,0x3f19c200,0x3f2302d3
.long 0x0,0x0,0x0,0x0,0x3d48fb30,0x3d55880e,0x3d621469,0x3d6ea038
.long 0x3dc8bd36,0x3dd53db9,0x3de1bc2e,0x3dee3876,0x3e164083,0x3e1f917b,0x3e28defc,0x3e3228d4
.long 0x3e47c5c2,0x3e541501,0x3e605c13,0x3e6c9a7f,0x3e78cfcc,0x3e840270,0x3e8b9507,0x3e931f35
.long 0x3e94a031,0x3e9d9e78,0x3ea68f12,0x3eaf713a,0x3eac7cd4,0x3eb6ccc3,0x3ec1071e,0x3ecb2aae
.long 0x3ec3ef15,0x3ecf7bca,0x3edae880,0x3ee63375,0x3edae880,0x3ee79a5d,0x3ef41f07,0x3f003a06
.long 0x3ef15aea,0x3eff17b2,0x3f064b82,0x3f0cead0,0x3f039c3d,0x3f0af1b7,0x3f121eb0,0x3f19210f
.long 0x3f0e39da,0x3f15f6d9,0x3f1d7fd1,0x3f24d225,0x3f187fc0,0x3f209393,0x3f286605,0x3f2ff3e6
.long 0x3f226799,0x3f2ac082,0x3f32c8c9,0x3f3a7ca4,0x3f2beb4a,0x3f34768f,0x3f3ca003,0x3f446337
.long 0x0,0x0,0x0,0x0,0x3d7b2b74,0x3d83db0a,0x3d8a200a,0x3d9064b4
.long 0x3dfab273,0x3e039502,0x3e09cf86,0x3e1008b7,0x3e3b6ecf,0x3e44b0b9,0x3e4dee60,0x3e57278f
.long 0x3e78cfcc,0x3e827dc0,0x3e888e93,0x3e8e9a22,0x3e9aa086,0x3ea21887,0x3ea986c4,0x3eb0eacb
.long 0x3eb8442a,0x3ec1071e,0x3ec9b953,0x3ed25a09,0x3ed53641,0x3edf28a9,0x3ee900b7,0x3ef2bd43
.long 0x3ef15aea,0x3efc5d27,0x3f039c3d,0x3f08f59b,0x3f064b82,0x3f0c42c9,0x3f121eb0,0x3f17de12
.long 0x3f13682a,0x3f19c200,0x3f1ff6cb,0x3f26050a,0x3f1ff6cb,0x3f269de3,0x3f2d1469,0x3f33587a
.long 0x3f2beb4a,0x3f32c8c9,0x3f396842,0x3f3fc767,0x3f373a23,0x3f3e35c5,0x3f44e3f5,0x3f4b41fa
.long 0x3f41d870,0x3f48d8b3,0x3f4f7a1f,0x3f55b993,0x3f4bbbf8,0x3f52a649,0x3f591e6a,0x3f5f20db
.long 0x0,0x0,0x0,0x0,0x3d96a905,0x3d9cecf9,0x3da3308c,0x3da973ba
.long 0x3e164083,0x3e1c76de,0x3e22abb6,0x3e28defc,0x3e605c13,0x3e698bba,0x3e72b651,0x3e7bdba4
.long 0x3e94a031,0x3e9aa086,0x3ea09ae5,0x3ea68f12,0x3eb8442a,0x3ebf926f,0x3ec6d529,0x3ece0bea
.long 0x3edae880,0x3ee363fa,0x3eebcbbb,0x3ef41f07,0x3efc5d27,0x3f02ef9f,0x3f07a136,0x3f0c42c9
.long 0x3f0e39da,0x3f13682a,0x3f187fc0,0x3f1d7fd1,0x3f1d7fd1,0x3f2302d3,0x3f286605,0x3f2da859
.long 0x3f2beb4a,0x3f31a81d,0x3f373a23,0x3f3ca003,0x3f396842,0x3f3f41fc,0x3f44e3f5,0x3f4a4c87
.long 0x3f45e403,0x3f4bbbf8,0x3f514d3d,0x3f5695e5,0x3f514d3d,0x3f570348,0x3f5c61c7,0x3f61668a
.long 0x3f5b941a,0x3f6106f2,0x3f660f88,0x3f6aab7b,0x3f64aa59,0x3f69b7e4,0x3f6e46be,0x3f725470
.long 0x0,0x0,0x0,0x0,0x3dafb680,0x3db5f8da,0x3dbc3ac3,0x3dc27c39
.long 0x3e2f10a2,0x3e354098,0x3e3b6ecf,0x3e419b37,0x3e827dc0,0x3e870ada,0x3e8b9507,0x3e901c2c
.long 0x3eac7cd4,0x3eb263ef,0x3eb8442a,0x3ebe1d4a,0x3ed53641,0x3edc53c1,0x3ee363fa,0x3eea6681
.long 0x3efc5d27,0x3f0242b1,0x3f064b82,0x3f0a48ad,0x3f10d3cd,0x3f1553b7,0x3f19c200,0x3f1e1e22
.long 0x3f226799,0x3f273656,0x3f2beb4a,0x3f3085bb,0x3f32c8c9,0x3f37c655,0x3f3ca003,0x3f4154e1
.long 0x3f41d870,0x3f46e22a,0x3f4bbbf8,0x3f5064af,0x3f4f7a1f,0x3f546b3b,0x3f591e6a,0x3f5d924d
.long 0x3f5b941a,0x3f604621,0x3f64aa59,0x3f68bf3c,0x3f660f88,0x3f6a5ad9,0x3f6e46be,0x3f71d19f
.long 0x3f6ed89e,0x3f7294f8,0x3f75dec6,0x3f78b47b,0x3f75dec6,0x3f78e3d6,0x3f7b61fc,0x3f7d57de
.long 0x3f800000,0x3f800000,0x3f800000,0x3f800000,0x3f800000,0x3f7fffb1,0x3f7ffec4,0x3f7ffd39
.long 0x3f800000,0x3f7ffec4,0x3f7ffb11,0x3f7ff4e6,0x3f800000,0x3f7ffd39,0x3f7ff4e6,0x3f7fe705
.long 0x3f800000,0x3f7ffb11,0x3f7fec43,0x3f7fd397,0x3f800000,0x3f7ff84a,0x3f7fe129,0x3f7fba9e
.long 0x3f800000,0x3f7ff4e6,0x3f7fd397,0x3f7f9c18,0x3f800000,0x3f7ff0e3,0x3f7fc38f,0x3f7f7808
.long 0x3f800000,0x3f7fec43,0x3f7fb10f,0x3f7f4e6d,0x3f800000,0x3f7fe705,0x3f7f9c18,0x3f7f1f49
.long 0x3f800000,0x3f7fe129,0x3f7f84ab,0x3f7eea9d,0x3f800000,0x3f7fdaaf,0x3f7f6ac7,0x3f7eb069
.long 0x3f800000,0x3f7fd397,0x3f7f4e6d,0x3f7e70b0,0x3f800000,0x3f7fcbe2,0x3f7f2f9d,0x3f7e2b72
.long 0x3f800000,0x3f7fc38f,0x3f7f0e58,0x3f7de0b1,0x3f800000,0x3f7fba9e,0x3f7eea9d,0x3f7d906e
.long 0x3f800000,0x3f800000,0x3f800000,0x3f800000,0x3f7ffb11,0x3f7ff84a,0x3f7ff4e6,0x3f7ff0e3
.long 0x3f7fec43,0x3f7fe129,0x3f7fd397,0x3f7fc38f,0x3f7fd397,0x3f7fba9e,0x3f7f9c18,0x3f7f7808
.long 0x3f7fb10f,0x3f7f84ab,0x3f7f4e6d,0x3f7f0e58,0x3f7f84ab,0x3f7f3f54,0x3f7eea9d,0x3f7e868b
.long 0x3f7f4e6d,0x3f7eea9d,0x3f7e70b0,0x3f7de0b1,0x3f7f0e58,0x3f7e868b,0x3f7de0b1,0x3f7d1cdd
.long 0x3f7ec46d,0x3f7e1324,0x3f7d3aac,0x3f7c3b28,0x3f7e70b0,0x3f7d906e,0x3f7c7eb0,0x3f7b3bab
.long 0x3f7e1324,0x3f7cfe73,0x3f7baccd,0x3f7a1e84,0x3f7dabcc,0x3f7c5d3a,0x3f7ac516,0x3f78e3d6
.long 0x3f7d3aac,0x3f7baccd,0x3f79c79d,0x3f778bc5,0x3f7cbfc9,0x3f7aed37,0x3f78b47b,0x3f76167a
.long 0x3f7c3b28,0x3f7a1e84,0x3f778bc5,0x3f748422,0x3f7baccd,0x3f7940c0,0x3f764d97,0x3f72d4eb
.long 0x3f800000,0x3f800000,0x3f800000,0x3f800000,0x3f7fec43,0x3f7fe705,0x3f7fe129,0x3f7fdaaf
.long 0x3f7fb10f,0x3f7f9c18,0x3f7f84ab,0x3f7f6ac7,0x3f7f4e6d,0x3f7f1f49,0x3f7eea9d,0x3f7eb069
.long 0x3f7ec46d,0x3f7e70b0,0x3f7e1324,0x3f7dabcc,0x3f7e1324,0x3f7d906e,0x3f7cfe73,0x3f7c5d3a
.long 0x3f7d3aac,0x3f7c7eb0,0x3f7baccd,0x3f7ac516,0x3f7c3b28,0x3f7b3bab,0x3f7a1e84,0x3f78e3d6
.long 0x3f7b14be,0x3f79c79d,0x3f7853f8,0x3f76ba07,0x3f79c79d,0x3f7822d1,0x3f764d97,0x3f74484b
.long 0x3f7853f8,0x3f764d97,0x3f740bdd,0x3f718f57,0x3f76ba07,0x3f74484b,0x3f718f57,0x3f6e8ff8
.long 0x3f74fa0b,0x3f721352,0x3f6ed89e,0x3f6b4b0c,0x3f731447,0x3f6faf1b,0x3f6be858,0x3f67c187
.long 0x3f710908,0x3f6d1c1d,0x3f68bf3c,0x3f63f473,0x3f6ed89e,0x3f6a5ad9,0x3f655e0b,0x3f5fe4e9
.long 0x3f800000,0x3f800000,0x3f800000,0x3f800000,0x3f7fd397,0x3f7fcbe2,0x3f7fc38f,0x3f7fba9e
.long 0x3f7f4e6d,0x3f7f2f9d,0x3f7f0e58,0x3f7eea9d,0x3f7e70b0,0x3f7e2b72,0x3f7de0b1,0x3f7d906e
.long 0x3f7d3aac,0x3f7cbfc9,0x3f7c3b28,0x3f7baccd,0x3f7baccd,0x3f7aed37,0x3f7a1e84,0x3f7940c0
.long 0x3f79c79d,0x3f78b47b,0x3f778bc5,0x3f764d97,0x3f778bc5,0x3f76167a,0x3f748422,0x3f72d4eb
.long 0x3f74fa0b,0x3f731447,0x3f710908,0x3f6ed89e,0x3f721352,0x3f6faf1b,0x3f6d1c1d,0x3f6a5ad9
.long 0x3f6ed89e,0x3f6be858,0x3f68bf3c,0x3f655e0b,0x3f6b4b0c,0x3f67c187,0x3f63f473,0x3f5fe4e9
.long 0x3f676bd8,0x3f633c5a,0x3f5ebe05,0x3f59f26a,0x3f633c5a,0x3f5e5aa6,0x3f591e6a,0x3f5389c7
.long 0x3f5ebe05,0x3f591e6a,0x3f531849,0x3f4cae79,0x3f59f26a,0x3f5389c7,0x3f4cae79,0x3f456439
.long 0x3f800000,0x3f7fb10f,0x3f7ec46d,0x3f7d3aac,0x3f800000,0x3f7fa6e3,0x3f7e9bc9,0x3f7cdf6c
.long 0x3f800000,0x3f7f9c18,0x3f7e70b0,0x3f7c7eb0,0x3f800000,0x3f7f90b1,0x3f7e4323,0x3f7c187a
.long 0x3f800000,0x3f7f84ab,0x3f7e1324,0x3f7baccd,0x3f800000,0x3f7f7808,0x3f7de0b1,0x3f7b3bab
.long 0x3f800000,0x3f7f6ac7,0x3f7dabcc,0x3f7ac516,0x3f800000,0x3f7f5ce9,0x3f7d7474,0x3f7a4910
.long 0x3f800000,0x3f7f4e6d,0x3f7d3aac,0x3f79c79d,0x3f800000,0x3f7f3f54,0x3f7cfe73,0x3f7940c0
.long 0x3f800000,0x3f7f2f9d,0x3f7cbfc9,0x3f78b47b,0x3f800000,0x3f7f1f49,0x3f7c7eb0,0x3f7822d1
.long 0x3f800000,0x3f7f0e58,0x3f7c3b28,0x3f778bc5,0x3f800000,0x3f7efcc9,0x3f7bf531,0x3f76ef5b
.long 0x3f800000,0x3f7eea9d,0x3f7baccd,0x3f764d97,0x3f800000,0x3f7ed7d4,0x3f7b61fc,0x3f75a67b
.long 0x3f7b14be,0x3f7853f8,0x3f74fa0b,0x3f710908,0x3f7a7302,0x3f77583a,0x3f73913f,0x3f6f20b0
.long 0x3f79c79d,0x3f764d97,0x3f721352,0x3f6d1c1d,0x3f791298,0x3f75341d,0x3f708066,0x3f6afb8c
.long 0x3f7853f8,0x3f740bdd,0x3f6ed89e,0x3f68bf3c,0x3f778bc5,0x3f72d4eb,0x3f6d1c1d,0x3f666771
.long 0x3f76ba07,0x3f718f57,0x3f6b4b0c,0x3f63f473,0x3f75dec6,0x3f703b37,0x3f696591,0x3f61668a
.long 0x3f74fa0b,0x3f6ed89e,0x3f676bd8,0x3f5ebe05,0x3f740bdd,0x3f6d67a1,0x3f655e0b,0x3f5bfb34
.long 0x3f731447,0x3f6be858,0x3f633c5a,0x3f591e6a,0x3f721352,0x3f6a5ad9,0x3f6106f2,0x3f5627fe
.long 0x3f710908,0x3f68bf3c,0x3f5ebe05,0x3f531849,0x3f6ff573,0x3f671599,0x3f5c61c7,0x3f4fefa8
.long 0x3f6ed89e,0x3f655e0b,0x3f59f26a,0x3f4cae79,0x3f6db293,0x3f6398ac,0x3f577026,0x3f495521
.long 0x3f6c835e,0x3f676bd8,0x3f61c598,0x3f5b941a,0x3f6a09a7,0x3f644fac,0x3f5df6be,0x3f570348
.long 0x3f676bd8,0x3f6106f2,0x3f59f26a,0x3f5233c6,0x3f64aa59,0x3f5d924d,0x3f55b993,0x3f4d26fd
.long 0x3f61c598,0x3f59f26a,0x3f514d3d,0x3f47de65,0x3f5ebe05,0x3f5627fe,0x3f4cae79,0x3f425b89
.long 0x3f5b941a,0x3f5233c6,0x3f47de65,0x3f3ca003,0x3f584853,0x3f4e1689,0x3f42de29,0x3f36ad7f
.long 0x3f54db31,0x3f49d112,0x3f3daef9,0x3f3085bb,0x3f514d3d,0x3f456439,0x3f385216,0x3f2a2a80
.long 0x3f4d9f02,0x3f40d0da,0x3f32c8c9,0x3f239da9,0x3f49d112,0x3f3c17d9,0x3f2d1469,0x3f1ce11f
.long 0x3f45e403,0x3f373a23,0x3f273656,0x3f15f6d9,0x3f41d870,0x3f3238aa,0x3f212ff9,0x3f0ee0db
.long 0x3f3daef9,0x3f2d1469,0x3f1b02c6,0x3f07a136,0x3f396842,0x3f27ce61,0x3f14b039,0x3f003a06
.long 0x3f54db31,0x3f4d9f02,0x3f45e403,0x3f3daef9,0x3f4f7a1f,0x3f476085,0x3f3ebc1b,0x3f3592e7
.long 0x3f49d112,0x3f40d0da,0x3f373a23,0x3f2d1469,0x3f43e200,0x3f39f2ac,0x3f2f61a5,0x3f24381a
.long 0x3f3daef9,0x3f32c8c9,0x3f273656,0x3f1b02c6,0x3f373a23,0x3f2b561b,0x3f1ebc12,0x3f11796b
.long 0x3f3085bb,0x3f239da9,0x3f15f6d9,0x3f07a136,0x3f299415,0x3f1ba299,0x3f0cead0,0x3efafef7
.long 0x3f226799,0x3f13682a,0x3f039c3d,0x3ee63375,0x3f1b02c6,0x3f0af1b7,0x3ef41f07,0x3ed0eb2a
.long 0x3f13682a,0x3f0242b1,0x3ee0924f,0x3ebb31a0,0x3f0b9a6b,0x3ef2bd43,0x3ecc9b8b,0x3ea5129f
.long 0x3f039c3d,0x3ee0924f,0x3eb8442a,0x3e8e9a22,0x3ef6e0cb,0x3ece0bea,0x3ea395c5,0x3e6fa8b2
.long 0x3ee63375,0x3ebb31a0,0x3e8e9a22,0x3e419b37,0x3ed53641,0x3ea80b1f,0x3e72b651,0x3e1324ca
.long 0x0,0x0,0x0,0x0,0x0,0x3b490fc6,0x3bc90f88,0x3c16cb58
.long 0x0,0x3bc90f88,0x3c490e90,0x3c96c9b6,0x0,0x3c16cb58,0x3c96c9b6,0x3ce22a7a
.long 0x0,0x3c490e90,0x3cc90ab0,0x3d16c32c,0x0,0x3c7b514b,0x3cfb49ba,0x3d3c6dd5
.long 0x0,0x3c96c9b6,0x3d16c32c,0x3d621469,0x0,0x3cafea69,0x3d2fe007,0x3d83db0a
.long 0x0,0x3cc90ab0,0x3d48fb30,0x3d96a905,0x0,0x3ce22a7a,0x3d621469,0x3da973ba
.long 0x0,0x3cfb49ba,0x3d7b2b74,0x3dbc3ac3,0x0,0x3d0a342f,0x3d8a200a,0x3dcefdb7
.long 0x0,0x3d16c32c,0x3d96a905,0x3de1bc2e,0x0,0x3d2351cb,0x3da3308c,0x3df475c0
.long 0x0,0x3d2fe007,0x3dafb680,0x3e039502,0x0,0x3d3c6dd5,0x3dbc3ac3,0x3e0cec4a
.long 0x0,0x0,0x0,0x0,0x3c490e90,0x3c7b514b,0x3c96c9b6,0x3cafea69
.long 0x3cc90ab0,0x3cfb49ba,0x3d16c32c,0x3d2fe007,0x3d16c32c,0x3d3c6dd5,0x3d621469,0x3d83db0a
.long 0x3d48fb30,0x3d7b2b74,0x3d96a905,0x3dafb680,0x3d7b2b74,0x3d9cecf9,0x3dbc3ac3,0x3ddb7d37
.long 0x3d96a905,0x3dbc3ac3,0x3de1bc2e,0x3e039502,0x3dafb680,0x3ddb7d37,0x3e039502,0x3e195be0
.long 0x3dc8bd36,0x3dfab273,0x3e164083,0x3e2f10a2,0x3de1bc2e,0x3e0cec4a,0x3e28defc,0x3e44b0b9
.long 0x3dfab273,0x3e1c76de,0x3e3b6ecf,0x3e5a3997,0x3e09cf86,0x3e2bf804,0x3e4dee60,0x3e6fa8b2
.long 0x3e164083,0x3e3b6ecf,0x3e605c13,0x3e827dc0,0x3e22abb6,0x3e4ada4f,0x3e72b651,0x3e8d17c0
.long 0x3e2f10a2,0x3e5a3997,0x3e827dc0,0x3e97a117,0x3e3b6ecf,0x3e698bba,0x3e8b9507,0x3ea21887
.long 0x0,0x0,0x0,0x0,0x3cc90ab0,0x3ce22a7a,0x3cfb49ba,0x3d0a342f
.long 0x3d48fb30,0x3d621469,0x3d7b2b74,0x3d8a200a,0x3d96a905,0x3da973ba,0x3dbc3ac3,0x3dcefdb7
.long 0x3dc8bd36,0x3de1bc2e,0x3dfab273,0x3e09cf86,0x3dfab273,0x3e0cec4a,0x3e1c76de,0x3e2bf804
.long 0x3e164083,0x3e28defc,0x3e3b6ecf,0x3e4dee60,0x3e2f10a2,0x3e44b0b9,0x3e5a3997,0x3e6fa8b2
.long 0x3e47c5c2,0x3e605c13,0x3e78cfcc,0x3e888e93,0x3e605c13,0x3e7bdba4,0x3e8b9507,0x3e9920fe
.long 0x3e78cfcc,0x3e8b9507,0x3e9aa086,0x3ea986c4,0x3e888e93,0x3e9920fe,0x3ea986c4,0x3eb9bb1e
.long 0x3e94a031,0x3ea68f12,0x3eb8442a,0x3ec9b953,0x3ea09ae5,0x3eb3dca5,0x3ec6d529,0x3ed97cb9
.long 0x3eac7cd4,0x3ec1071e,0x3ed53641,0x3ee900b7,0x3eb8442a,0x3ece0bea,0x3ee363fa,0x3ef840c8
.long 0x0,0x0,0x0,0x0,0x3d16c32c,0x3d2351cb,0x3d2fe007,0x3d3c6dd5
.long 0x3d96a905,0x3da3308c,0x3dafb680,0x3dbc3ac3,0x3de1bc2e,0x3df475c0,0x3e039502,0x3e0cec4a
.long 0x3e164083,0x3e22abb6,0x3e2f10a2,0x3e3b6ecf,0x3e3b6ecf,0x3e4ada4f,0x3e5a3997,0x3e698bba
.long 0x3e605c13,0x3e72b651,0x3e827dc0,0x3e8b9507,0x3e827dc0,0x3e8d17c0,0x3e97a117,0x3ea21887
.long 0x3e94a031,0x3ea09ae5,0x3eac7cd4,0x3eb8442a,0x3ea68f12,0x3eb3dca5,0x3ec1071e,0x3ece0bea
.long 0x3eb8442a,0x3ec6d529,0x3ed53641,0x3ee363fa,0x3ec9b953,0x3ed97cb9,0x3ee900b7,0x3ef840c8
.long 0x3edae880,0x3eebcbbb,0x3efc5d27,0x3f064b82,0x3eebcbbb,0x3efdbabb,0x3f07a136,0x3f102dd5
.long 0x3efc5d27,0x3f07a136,0x3f10d3cd,0x3f19c200,0x3f064b82,0x3f102dd5,0x3f19c200,0x3f2302d3
.long 0x0,0x3d48fb30,0x3dc8bd36,0x3e164083,0x0,0x3d55880e,0x3dd53db9,0x3e1f917b
.long 0x0,0x3d621469,0x3de1bc2e,0x3e28defc,0x0,0x3d6ea038,0x3dee3876,0x3e3228d4
.long 0x0,0x3d7b2b74,0x3dfab273,0x3e3b6ecf,0x0,0x3d83db0a,0x3e039502,0x3e44b0b9
.long 0x0,0x3d8a200a,0x3e09cf86,0x3e4dee60,0x0,0x3d9064b4,0x3e1008b7,0x3e57278f
.long 0x0,0x3d96a905,0x3e164083,0x3e605c13,0x0,0x3d9cecf9,0x3e1c76de,0x3e698bba
.long 0x0,0x3da3308c,0x3e22abb6,0x3e72b651,0x0,0x3da973ba,0x3e28defc,0x3e7bdba4
.long 0x0,0x3dafb680,0x3e2f10a2,0x3e827dc0,0x0,0x3db5f8da,0x3e354098,0x3e870ada
.long 0x0,0x3dbc3ac3,0x3e3b6ecf,0x3e8b9507,0x0,0x3dc27c39,0x3e419b37,0x3e901c2c
.long 0x3e47c5c2,0x3e78cfcc,0x3e94a031,0x3eac7cd4,0x3e541501,0x3e840270,0x3e9d9e78,0x3eb6ccc3
.long 0x3e605c13,0x3e8b9507,0x3ea68f12,0x3ec1071e,0x3e6c9a7f,0x3e931f35,0x3eaf713a,0x3ecb2aae
.long 0x3e78cfcc,0x3e9aa086,0x3eb8442a,0x3ed53641,0x3e827dc0,0x3ea21887,0x3ec1071e,0x3edf28a9
.long 0x3e888e93,0x3ea986c4,0x3ec9b953,0x3ee900b7,0x3e8e9a22,0x3eb0eacb,0x3ed25a09,0x3ef2bd43
.long 0x3e94a031,0x3eb8442a,0x3edae880,0x3efc5d27,0x3e9aa086,0x3ebf926f,0x3ee363fa,0x3f02ef9f
.long 0x3ea09ae5,0x3ec6d529,0x3eebcbbb,0x3f07a136,0x3ea68f12,0x3ece0bea,0x3ef41f07,0x3f0c42c9
.long 0x3eac7cd4,0x3ed53641,0x3efc5d27,0x3f10d3cd,0x3eb263ef,0x3edc53c1,0x3f0242b1,0x3f1553b7
.long 0x3eb8442a,0x3ee363fa,0x3f064b82,0x3f19c200,0x3ebe1d4a,0x3eea6681,0x3f0a48ad,0x3f1e1e22
.long 0x3ec3ef15,0x3edae880,0x3ef15aea,0x3f039c3d,0x3ecf7bca,0x3ee79a5d,0x3eff17b2,0x3f0af1b7
.long 0x3edae880,0x3ef41f07,0x3f064b82,0x3f121eb0,0x3ee63375,0x3f003a06,0x3f0cead0,0x3f19210f
.long 0x3ef15aea,0x3f064b82,0x3f13682a,0x3f1ff6cb,0x3efc5d27,0x3f0c42c9,0x3f19c200,0x3f269de3
.long 0x3f039c3d,0x3f121eb0,0x3f1ff6cb,0x3f2d1469,0x3f08f59b,0x3f17de12,0x3f26050a,0x3f33587a
.long 0x3f0e39da,0x3f1d7fd1,0x3f2beb4a,0x3f396842,0x3f13682a,0x3f2302d3,0x3f31a81d,0x3f3f41fc
.long 0x3f187fc0,0x3f286605,0x3f373a23,0x3f44e3f5,0x3f1d7fd1,0x3f2da859,0x3f3ca003,0x3f4a4c87
.long 0x3f226799,0x3f32c8c9,0x3f41d870,0x3f4f7a1f,0x3f273656,0x3f37c655,0x3f46e22a,0x3f546b3b
.long 0x3f2beb4a,0x3f3ca003,0x3f4bbbf8,0x3f591e6a,0x3f3085bb,0x3f4154e1,0x3f5064af,0x3f5d924d
.long 0x3f0e39da,0x3f187fc0,0x3f226799,0x3f2beb4a,0x3f15f6d9,0x3f209393,0x3f2ac082,0x3f34768f
.long 0x3f1d7fd1,0x3f286605,0x3f32c8c9,0x3f3ca003,0x3f24d225,0x3f2ff3e6,0x3f3a7ca4,0x3f446337
.long 0x3f2beb4a,0x3f373a23,0x3f41d870,0x3f4bbbf8,0x3f32c8c9,0x3f3e35c5,0x3f48d8b3,0x3f52a649
.long 0x3f396842,0x3f44e3f5,0x3f4f7a1f,0x3f591e6a,0x3f3fc767,0x3f4b41fa,0x3f55b993,0x3f5f20db
.long 0x3f45e403,0x3f514d3d,0x3f5b941a,0x3f64aa59,0x3f4bbbf8,0x3f570348,0x3f6106f2,0x3f69b7e4
.long 0x3f514d3d,0x3f5c61c7,0x3f660f88,0x3f6e46be,0x3f5695e5,0x3f61668a,0x3f6aab7b,0x3f725470
.long 0x3f5b941a,0x3f660f88,0x3f6ed89e,0x3f75dec6,0x3f604621,0x3f6a5ad9,0x3f7294f8,0x3f78e3d6
.long 0x3f64aa59,0x3f6e46be,0x3f75dec6,0x3f7b61fc,0x3f68bf3c,0x3f71d19f,0x3f78b47b,0x3f7d57de
.long 0x3f800000,0x3f7fb10f,0x3f7ec46d,0x3f7d3aac,0x3f800000,0x3f7fa6e3,0x3f7e9bc9,0x3f7cdf6c
.long 0x3f800000,0x3f7f9c18,0x3f7e70b0,0x3f7c7eb0,0x3f800000,0x3f7f90b1,0x3f7e4323,0x3f7c187a
.long 0x3f800000,0x3f7f84ab,0x3f7e1324,0x3f7baccd,0x3f800000,0x3f7f7808,0x3f7de0b1,0x3f7b3bab
.long 0x3f800000,0x3f7f6ac7,0x3f7dabcc,0x3f7ac516,0x3f800000,0x3f7f5ce9,0x3f7d7474,0x3f7a4910
.long 0x3f800000,0x3f7f4e6d,0x3f7d3aac,0x3f79c79d,0x3f800000,0x3f7f3f54,0x3f7cfe73,0x3f7940c0
.long 0x3f800000,0x3f7f2f9d,0x3f7cbfc9,0x3f78b47b,0x3f800000,0x3f7f1f49,0x3f7c7eb0,0x3f7822d1
.long 0x3f800000,0x3f7f0e58,0x3f7c3b28,0x3f778bc5,0x3f800000,0x3f7efcc9,0x3f7bf531,0x3f76ef5b
.long 0x3f800000,0x3f7eea9d,0x3f7baccd,0x3f764d97,0x3f800000,0x3f7ed7d4,0x3f7b61fc,0x3f75a67b
.long 0x3f7b14be,0x3f7853f8,0x3f74fa0b,0x3f710908,0x3f7a7302,0x3f77583a,0x3f73913f,0x3f6f20b0
.long 0x3f79c79d,0x3f764d97,0x3f721352,0x3f6d1c1d,0x3f791298,0x3f75341d,0x3f708066,0x3f6afb8c
.long 0x3f7853f8,0x3f740bdd,0x3f6ed89e,0x3f68bf3c,0x3f778bc5,0x3f72d4eb,0x3f6d1c1d,0x3f666771
.long 0x3f76ba07,0x3f718f57,0x3f6b4b0c,0x3f63f473,0x3f75dec6,0x3f703b37,0x3f696591,0x3f61668a
.long 0x3f74fa0b,0x3f6ed89e,0x3f676bd8,0x3f5ebe05,0x3f740bdd,0x3f6d67a1,0x3f655e0b,0x3f5bfb34
.long 0x3f731447,0x3f6be858,0x3f633c5a,0x3f591e6a,0x3f721352,0x3f6a5ad9,0x3f6106f2,0x3f5627fe
.long 0x3f710908,0x3f68bf3c,0x3f5ebe05,0x3f531849,0x3f6ff573,0x3f671599,0x3f5c61c7,0x3f4fefa8
.long 0x3f6ed89e,0x3f655e0b,0x3f59f26a,0x3f4cae79,0x3f6db293,0x3f6398ac,0x3f577026,0x3f495521
.long 0x3f6c835e,0x3f676bd8,0x3f61c598,0x3f5b941a,0x3f6a09a7,0x3f644fac,0x3f5df6be,0x3f570348
.long 0x3f676bd8,0x3f6106f2,0x3f59f26a,0x3f5233c6,0x3f64aa59,0x3f5d924d,0x3f55b993,0x3f4d26fd
.long 0x3f61c598,0x3f59f26a,0x3f514d3d,0x3f47de65,0x3f5ebe05,0x3f5627fe,0x3f4cae79,0x3f425b89
.long 0x3f5b941a,0x3f5233c6,0x3f47de65,0x3f3ca003,0x3f584853,0x3f4e1689,0x3f42de29,0x3f36ad7f
.long 0x3f54db31,0x3f49d112,0x3f3daef9,0x3f3085bb,0x3f514d3d,0x3f456439,0x3f385216,0x3f2a2a80
.long 0x3f4d9f02,0x3f40d0da,0x3f32c8c9,0x3f239da9,0x3f49d112,0x3f3c17d9,0x3f2d1469,0x3f1ce11f
.long 0x3f45e403,0x3f373a23,0x3f273656,0x3f15f6d9,0x3f41d870,0x3f3238aa,0x3f212ff9,0x3f0ee0db
.long 0x3f3daef9,0x3f2d1469,0x3f1b02c6,0x3f07a136,0x3f396842,0x3f27ce61,0x3f14b039,0x3f003a06
.long 0x3f54db31,0x3f4d9f02,0x3f45e403,0x3f3daef9,0x3f4f7a1f,0x3f476085,0x3f3ebc1b,0x3f3592e7
.long 0x3f49d112,0x3f40d0da,0x3f373a23,0x3f2d1469,0x3f43e200,0x3f39f2ac,0x3f2f61a5,0x3f24381a
.long 0x3f3daef9,0x3f32c8c9,0x3f273656,0x3f1b02c6,0x3f373a23,0x3f2b561b,0x3f1ebc12,0x3f11796b
.long 0x3f3085bb,0x3f239da9,0x3f15f6d9,0x3f07a136,0x3f299415,0x3f1ba299,0x3f0cead0,0x3efafef7
.long 0x3f226799,0x3f13682a,0x3f039c3d,0x3ee63375,0x3f1b02c6,0x3f0af1b7,0x3ef41f07,0x3ed0eb2a
.long 0x3f13682a,0x3f0242b1,0x3ee0924f,0x3ebb31a0,0x3f0b9a6b,0x3ef2bd43,0x3ecc9b8b,0x3ea5129f
.long 0x3f039c3d,0x3ee0924f,0x3eb8442a,0x3e8e9a22,0x3ef6e0cb,0x3ece0bea,0x3ea395c5,0x3e6fa8b2
.long 0x3ee63375,0x3ebb31a0,0x3e8e9a22,0x3e419b37,0x3ed53641,0x3ea80b1f,0x3e72b651,0x3e1324ca
.long 0x3f3504f3,0x3f2beb4a,0x3f226799,0x3f187fc0,0x3f2beb4a,0x3f21cbfb,0x3f173c07,0x3f0c42c9
.long 0x3f226799,0x3f173c07,0x3f0b9a6b,0x3eff17b2,0x3f187fc0,0x3f0c42c9,0x3eff17b2,0x3ee4cbfe
.long 0x3f0e39da,0x3f00e7e4,0x3ee63375,0x3ec9b953,0x3f039c3d,0x3eea6681,0x3ecc9b8b,0x3eadf73c
.long 0x3ef15aea,0x3ed25a09,0x3eb263ef,0x3e919ddd,0x3edae880,0x3eb9bb1e,0x3e97a117,0x3e698bba
.long 0x3ec3ef15,0x3ea09ae5,0x3e78cfcc,0x3e2f10a2,0x3eac7cd4,0x3e870ada,0x3e419b37,0x3de7fa9a
.long 0x3e94a031,0x3e5a3997,0x3e09cf86,0x3d621469,0x3e78cfcc,0x3e25c58c,0x3da3308c,0xbb490fc6
.long 0x3e47c5c2,0x3de1bc2e,0x3cc90ab0,0xbd7b2b74,0x3e164083,0x3d6ea038,0xbcfb49ba,0xbdf475c0
.long 0x3dc8bd36,0x3bc90f88,0xbdafb680,0xbe354098,0x3d48fb30,0xbd3c6dd5,0xbe1008b7,0xbe6fa8b2
.long 0x3f0e39da,0x3f039c3d,0x3ef15aea,0x3edae880,0x3f00e7e4,0x3eea6681,0x3ed25a09,0x3eb9bb1e
.long 0x3ee63375,0x3ecc9b8b,0x3eb263ef,0x3e97a117,0x3ec9b953,0x3eadf73c,0x3e919ddd,0x3e698bba
.long 0x3eac7cd4,0x3e8e9a22,0x3e605c13,0x3e22abb6,0x3e8e9a22,0x3e5d4b1a,0x3e1c76de,0x3db5f8da
.long 0x3e605c13,0x3e1c76de,0x3dafb680,0x3c96c9b6,0x3e22abb6,0x3db5f8da,0x3c96c9b6,0xbd55880e
.long 0x3dc8bd36,0x3cc90ab0,0xbd48fb30,0xbdfab273,0x3d16c32c,0xbd2351cb,0xbdee3876,0xbe44b0b9
.long 0xbcc90ab0,0xbdd53db9,0xbe3b6ecf,0xbe8586ce,0xbdafb680,0xbe2bf804,0xbe7ee6e1,0xbea80b1f
.long 0xbe164083,0xbe6c9a7f,0xbea09ae5,0xbec9b953,0xbe541501,0xbe9620d2,0xbec1071e,0xbeea6681
.long 0xbe888e93,0xbeb554ec,0xbee0924f,0xbf04f484,0xbea68f12,0xbed3c867,0xbeff17b2,0xbf140c5f
.long 0x3ec3ef15,0x3eac7cd4,0x3e94a031,0x3e78cfcc,0x3ea09ae5,0x3e870ada,0x3e5a3997,0x3e25c58c
.long 0x3e78cfcc,0x3e419b37,0x3e09cf86,0x3da3308c,0x3e2f10a2,0x3de7fa9a,0x3d621469,0xbb490fc6
.long 0x3dc8bd36,0x3d16c32c,0xbcc90ab0,0xbdafb680,0x3cc90ab0,0xbd2351cb,0xbdd53db9,0xbe2bf804
.long 0xbd48fb30,0xbdee3876,0xbe3b6ecf,0xbe7ee6e1,0xbdfab273,0xbe44b0b9,0xbe8586ce,0xbea80b1f
.long 0xbe47c5c2,0xbe888e93,0xbeac7cd4,0xbecf7bca,0xbe888e93,0xbeadf73c,0xbed25a09,0xbef58035
.long 0xbeac7cd4,0xbed25a09,0xbef6e0cb,0xbf0cead0,0xbecf7bca,0xbef58035,0xbf0cead0,0xbf1e1e22
.long 0xbef15aea,0xbf0b9a6b,0xbf1d7fd1,0xbf2e3bde,0xbf08f59b,0xbf1ba299,0xbf2d1469,0xbf3d27b8
.long 0xbf187fc0,0xbf2ac082,0xbf3b8f3b,0xbf4ac77f,0xbf273656,0xbf38dd65,0xbf48d8b3,0xbf570348
.long 0x3e47c5c2,0x3e164083,0x3dc8bd36,0x3d48fb30,0x3de1bc2e,0x3d6ea038,0x3bc90f88,0xbd3c6dd5
.long 0x3cc90ab0,0xbcfb49ba,0xbdafb680,0xbe1008b7,0xbd7b2b74,0xbdf475c0,0xbe354098,0xbe6fa8b2
.long 0xbe164083,0xbe541501,0xbe888e93,0xbea68f12,0xbe6c9a7f,0xbe9620d2,0xbeb554ec,0xbed3c867
.long 0xbea09ae5,0xbec1071e,0xbee0924f,0xbeff17b2,0xbec9b953,0xbeea6681,0xbf04f484,0xbf140c5f
.long 0xbef15aea,0xbf08f59b,0xbf187fc0,0xbf273656,0xbf0b9a6b,0xbf1ba299,0xbf2ac082,0xbf38dd65
.long 0xbf1d7fd1,0xbf2d1469,0xbf3b8f3b,0xbf48d8b3,0xbf2e3bde,0xbf3d27b8,0xbf4ac77f,0xbf570348
.long 0xbf3daef9,0xbf4bbbf8,0xbf584853,0xbf633c5a,0xbf4bbbf8,0xbf58b3a1,0xbf63f473,0xbf6d67a1
.long 0xbf584853,0xbf63f473,0xbf6db293,0xbf756d97,0xbf633c5a,0xbf6d67a1,0xbf756d97,0xbf7b3bab
.long 0x0,0x3d48fb30,0x3dc8bd36,0x3e164083,0x0,0x3d55880e,0x3dd53db9,0x3e1f917b
.long 0x0,0x3d621469,0x3de1bc2e,0x3e28defc,0x0,0x3d6ea038,0x3dee3876,0x3e3228d4
.long 0x0,0x3d7b2b74,0x3dfab273,0x3e3b6ecf,0x0,0x3d83db0a,0x3e039502,0x3e44b0b9
.long 0x0,0x3d8a200a,0x3e09cf86,0x3e4dee60,0x0,0x3d9064b4,0x3e1008b7,0x3e57278f
.long 0x0,0x3d96a905,0x3e164083,0x3e605c13,0x0,0x3d9cecf9,0x3e1c76de,0x3e698bba
.long 0x0,0x3da3308c,0x3e22abb6,0x3e72b651,0x0,0x3da973ba,0x3e28defc,0x3e7bdba4
.long 0x0,0x3dafb680,0x3e2f10a2,0x3e827dc0,0x0,0x3db5f8da,0x3e354098,0x3e870ada
.long 0x0,0x3dbc3ac3,0x3e3b6ecf,0x3e8b9507,0x0,0x3dc27c39,0x3e419b37,0x3e901c2c
.long 0x3e47c5c2,0x3e78cfcc,0x3e94a031,0x3eac7cd4,0x3e541501,0x3e840270,0x3e9d9e78,0x3eb6ccc3
.long 0x3e605c13,0x3e8b9507,0x3ea68f12,0x3ec1071e,0x3e6c9a7f,0x3e931f35,0x3eaf713a,0x3ecb2aae
.long 0x3e78cfcc,0x3e9aa086,0x3eb8442a,0x3ed53641,0x3e827dc0,0x3ea21887,0x3ec1071e,0x3edf28a9
.long 0x3e888e93,0x3ea986c4,0x3ec9b953,0x3ee900b7,0x3e8e9a22,0x3eb0eacb,0x3ed25a09,0x3ef2bd43
.long 0x3e94a031,0x3eb8442a,0x3edae880,0x3efc5d27,0x3e9aa086,0x3ebf926f,0x3ee363fa,0x3f02ef9f
.long 0x3ea09ae5,0x3ec6d529,0x3eebcbbb,0x3f07a136,0x3ea68f12,0x3ece0bea,0x3ef41f07,0x3f0c42c9
.long 0x3eac7cd4,0x3ed53641,0x3efc5d27,0x3f10d3cd,0x3eb263ef,0x3edc53c1,0x3f0242b1,0x3f1553b7
.long 0x3eb8442a,0x3ee363fa,0x3f064b82,0x3f19c200,0x3ebe1d4a,0x3eea6681,0x3f0a48ad,0x3f1e1e22
.long 0x3ec3ef15,0x3edae880,0x3ef15aea,0x3f039c3d,0x3ecf7bca,0x3ee79a5d,0x3eff17b2,0x3f0af1b7
.long 0x3edae880,0x3ef41f07,0x3f064b82,0x3f121eb0,0x3ee63375,0x3f003a06,0x3f0cead0,0x3f19210f
.long 0x3ef15aea,0x3f064b82,0x3f13682a,0x3f1ff6cb,0x3efc5d27,0x3f0c42c9,0x3f19c200,0x3f269de3
.long 0x3f039c3d,0x3f121eb0,0x3f1ff6cb,0x3f2d1469,0x3f08f59b,0x3f17de12,0x3f26050a,0x3f33587a
.long 0x3f0e39da,0x3f1d7fd1,0x3f2beb4a,0x3f396842,0x3f13682a,0x3f2302d3,0x3f31a81d,0x3f3f41fc
.long 0x3f187fc0,0x3f286605,0x3f373a23,0x3f44e3f5,0x3f1d7fd1,0x3f2da859,0x3f3ca003,0x3f4a4c87
.long 0x3f226799,0x3f32c8c9,0x3f41d870,0x3f4f7a1f,0x3f273656,0x3f37c655,0x3f46e22a,0x3f546b3b
.long 0x3f2beb4a,0x3f3ca003,0x3f4bbbf8,0x3f591e6a,0x3f3085bb,0x3f4154e1,0x3f5064af,0x3f5d924d
.long 0x3f0e39da,0x3f187fc0,0x3f226799,0x3f2beb4a,0x3f15f6d9,0x3f209393,0x3f2ac082,0x3f34768f
.long 0x3f1d7fd1,0x3f286605,0x3f32c8c9,0x3f3ca003,0x3f24d225,0x3f2ff3e6,0x3f3a7ca4,0x3f446337
.long 0x3f2beb4a,0x3f373a23,0x3f41d870,0x3f4bbbf8,0x3f32c8c9,0x3f3e35c5,0x3f48d8b3,0x3f52a649
.long 0x3f396842,0x3f44e3f5,0x3f4f7a1f,0x3f591e6a,0x3f3fc767,0x3f4b41fa,0x3f55b993,0x3f5f20db
.long 0x3f45e403,0x3f514d3d,0x3f5b941a,0x3f64aa59,0x3f4bbbf8,0x3f570348,0x3f6106f2,0x3f69b7e4
.long 0x3f514d3d,0x3f5c61c7,0x3f660f88,0x3f6e46be,0x3f5695e5,0x3f61668a,0x3f6aab7b,0x3f725470
.long 0x3f5b941a,0x3f660f88,0x3f6ed89e,0x3f75dec6,0x3f604621,0x3f6a5ad9,0x3f7294f8,0x3f78e3d6
.long 0x3f64aa59,0x3f6e46be,0x3f75dec6,0x3f7b61fc,0x3f68bf3c,0x3f71d19f,0x3f78b47b,0x3f7d57de
.long 0x3f3504f3,0x3f3daef9,0x3f45e403,0x3f4d9f02,0x3f3daef9,0x3f466354,0x3f4e8d90,0x3f5627fe
.long 0x3f45e403,0x3f4e8d90,0x3f5695e5,0x3f5df6be,0x3f4d9f02,0x3f5627fe,0x3f5df6be,0x3f650479
.long 0x3f54db31,0x3f5d2d53,0x3f64aa59,0x3f6b4b0c,0x3f5b941a,0x3f6398ac,0x3f6aab7b,0x3f70c501
.long 0x3f61c598,0x3f696591,0x3f6ff573,0x3f756d97,0x3f676bd8,0x3f6e8ff8,0x3f748422,0x3f7940c0
.long 0x3f6c835e,0x3f731447,0x3f7853f8,0x3f7c3b28,0x3f710908,0x3f76ef5b,0x3f7b61fc,0x3f7e5a38
.long 0x3f74fa0b,0x3f7a1e84,0x3f7dabcc,0x3f7f9c18,0x3f7853f8,0x3f7c9f8a,0x3f7f2f9d,0x3f7fffb1
.long 0x3f7b14be,0x3f7e70b0,0x3f7fec43,0x3f7f84ab,0x3f7d3aac,0x3f7f90b1,0x3f7fe129,0x3f7e2b72
.long 0x3f7ec46d,0x3f7ffec4,0x3f7f0e58,0x3f7bf531,0x3f7fb10f,0x3f7fba9e,0x3f7d7474,0x3f78e3d6
.long 0x3f54db31,0x3f5b941a,0x3f61c598,0x3f676bd8,0x3f5d2d53,0x3f6398ac,0x3f696591,0x3f6e8ff8
.long 0x3f64aa59,0x3f6aab7b,0x3f6ff573,0x3f748422,0x3f6b4b0c,0x3f70c501,0x3f756d97,0x3f7940c0
.long 0x3f710908,0x3f75dec6,0x3f79c79d,0x3f7cbfc9,0x3f75dec6,0x3f79f35e,0x3f7cfe73,0x3f7efcc9
.long 0x3f79c79d,0x3f7cfe73,0x3f7f0e58,0x3f7ff4e6,0x3f7cbfc9,0x3f7efcc9,0x3f7ff4e6,0x3f7fa6e3
.long 0x3f7ec46d,0x3f7fec43,0x3f7fb10f,0x3f7e1324,0x3f7fd397,0x3f7fcbe2,0x3f7e4323,0x3f7b3bab
.long 0x3f7fec43,0x3f7e9bc9,0x3f7baccd,0x3f772417,0x3f7f0e58,0x3f7c5d3a,0x3f77f110,0x3f71d19f
.long 0x3f7d3aac,0x3f791298,0x3f731447,0x3f6b4b0c,0x3f7a7302,0x3f74bf62,0x3f6d1c1d,0x3f6398ac
.long 0x3f76ba07,0x3f6f6830,0x3f660f88,0x3f5ac450,0x3f721352,0x3f6912ae,0x3f5df6be,0x3f50d937
.long 0x3f6c835e,0x3f710908,0x3f74fa0b,0x3f7853f8,0x3f731447,0x3f76ef5b,0x3f7a1e84,0x3f7c9f8a
.long 0x3f7853f8,0x3f7b61fc,0x3f7dabcc,0x3f7f2f9d,0x3f7c3b28,0x3f7e5a38,0x3f7f9c18,0x3f7fffb1
.long 0x3f7ec46d,0x3f7fd397,0x3f7fec43,0x3f7f0e58,0x3f7fec43,0x3f7fcbe2,0x3f7e9bc9,0x3f7c5d3a
.long 0x3f7fb10f,0x3f7e4323,0x3f7baccd,0x3f77f110,0x3f7e1324,0x3f7b3bab,0x3f772417,0x3f71d19f
.long 0x3f7b14be,0x3f76ba07,0x3f710908,0x3f6a09a7,0x3f76ba07,0x3f70c501,0x3f696591,0x3f60a6cf
.long 0x3f710908,0x3f696591,0x3f604621,0x3f55b993,0x3f6a09a7,0x3f60a6cf,0x3f55b993,0x3f495521
.long 0x3f61c598,0x3f5695e5,0x3f49d112,0x3f3b8f3b,0x3f584853,0x3f4b41fa,0x3f3ca003,0x3f2c800f
.long 0x3f4d9f02,0x3f3ebc1b,0x3f2e3bde,0x3f1c420c,0x3f41d870,0x3f311722,0x3f1ebc12,0x3f0af1b7
.long 0x3f7b14be,0x3f7d3aac,0x3f7ec46d,0x3f7fb10f,0x3f7e70b0,0x3f7f90b1,0x3f7ffec4,0x3f7fba9e
.long 0x3f7fec43,0x3f7fe129,0x3f7f0e58,0x3f7d7474,0x3f7f84ab,0x3f7e2b72,0x3f7bf531,0x3f78e3d6
.long 0x3f7d3aac,0x3f7a7302,0x3f76ba07,0x3f721352,0x3f791298,0x3f74bf62,0x3f6f6830,0x3f6912ae
.long 0x3f731447,0x3f6d1c1d,0x3f660f88,0x3f5df6be,0x3f6b4b0c,0x3f6398ac,0x3f5ac450,0x3f50d937
.long 0x3f61c598,0x3f584853,0x3f4d9f02,0x3f41d870,0x3f5695e5,0x3f4b41fa,0x3f3ebc1b,0x3f311722
.long 0x3f49d112,0x3f3ca003,0x3f2e3bde,0x3f1ebc12,0x3f3b8f3b,0x3f2c800f,0x3f1c420c,0x3f0af1b7
.long 0x3f2beb4a,0x3f1b02c6,0x3f08f59b,0x3eebcbbb,0x3f1b02c6,0x3f084b92,0x3ee900b7,0x3ebf926f
.long 0x3f08f59b,0x3ee900b7,0x3ebe1d4a,0x3e919ddd,0x3eebcbbb,0x3ebf926f,0x3e919ddd,0x3e44b0b9
.long 0x3f800000,0x3f800000,0x3f800000,0x3f800000,0x3f7fb10f,0x3f7fa6e3,0x3f7f9c18,0x3f7f90b1
.long 0x3f7ec46d,0x3f7e9bc9,0x3f7e70b0,0x3f7e4323,0x3f7d3aac,0x3f7cdf6c,0x3f7c7eb0,0x3f7c187a
.long 0x3f7b14be,0x3f7a7302,0x3f79c79d,0x3f791298,0x3f7853f8,0x3f77583a,0x3f764d97,0x3f75341d
.long 0x3f74fa0b,0x3f73913f,0x3f721352,0x3f708066,0x3f710908,0x3f6f20b0,0x3f6d1c1d,0x3f6afb8c
.long 0x3f6c835e,0x3f6a09a7,0x3f676bd8,0x3f64aa59,0x3f676bd8,0x3f644fac,0x3f6106f2,0x3f5d924d
.long 0x3f61c598,0x3f5df6be,0x3f59f26a,0x3f55b993,0x3f5b941a,0x3f570348,0x3f5233c6,0x3f4d26fd
.long 0x3f54db31,0x3f4f7a1f,0x3f49d112,0x3f43e200,0x3f4d9f02,0x3f476085,0x3f40d0da,0x3f39f2ac
.long 0x3f45e403,0x3f3ebc1b,0x3f373a23,0x3f2f61a5,0x3f3daef9,0x3f3592e7,0x3f2d1469,0x3f24381a
.long 0x3f800000,0x3f800000,0x3f800000,0x3f800000,0x3f7f84ab,0x3f7f7808,0x3f7f6ac7,0x3f7f5ce9
.long 0x3f7e1324,0x3f7de0b1,0x3f7dabcc,0x3f7d7474,0x3f7baccd,0x3f7b3bab,0x3f7ac516,0x3f7a4910
.long 0x3f7853f8,0x3f778bc5,0x3f76ba07,0x3f75dec6,0x3f740bdd,0x3f72d4eb,0x3f718f57,0x3f703b37
.long 0x3f6ed89e,0x3f6d1c1d,0x3f6b4b0c,0x3f696591,0x3f68bf3c,0x3f666771,0x3f63f473,0x3f61668a
.long 0x3f61c598,0x3f5ebe05,0x3f5b941a,0x3f584853,0x3f59f26a,0x3f5627fe,0x3f5233c6,0x3f4e1689
.long 0x3f514d3d,0x3f4cae79,0x3f47de65,0x3f42de29,0x3f47de65,0x3f425b89,0x3f3ca003,0x3f36ad7f
.long 0x3f3daef9,0x3f373a23,0x3f3085bb,0x3f299415,0x3f32c8c9,0x3f2b561b,0x3f239da9,0x3f1ba299
.long 0x3f273656,0x3f1ebc12,0x3f15f6d9,0x3f0cead0,0x3f1b02c6,0x3f11796b,0x3f07a136,0x3efafef7
.long 0x3f800000,0x3f800000,0x3f800000,0x3f800000,0x3f7f4e6d,0x3f7f3f54,0x3f7f2f9d,0x3f7f1f49
.long 0x3f7d3aac,0x3f7cfe73,0x3f7cbfc9,0x3f7c7eb0,0x3f79c79d,0x3f7940c0,0x3f78b47b,0x3f7822d1
.long 0x3f74fa0b,0x3f740bdd,0x3f731447,0x3f721352,0x3f6ed89e,0x3f6d67a1,0x3f6be858,0x3f6a5ad9
.long 0x3f676bd8,0x3f655e0b,0x3f633c5a,0x3f6106f2,0x3f5ebe05,0x3f5bfb34,0x3f591e6a,0x3f5627fe
.long 0x3f54db31,0x3f514d3d,0x3f4d9f02,0x3f49d112,0x3f49d112,0x3f456439,0x3f40d0da,0x3f3c17d9
.long 0x3f3daef9,0x3f385216,0x3f32c8c9,0x3f2d1469,0x3f3085bb,0x3f2a2a80,0x3f239da9,0x3f1ce11f
.long 0x3f226799,0x3f1b02c6,0x3f13682a,0x3f0b9a6b,0x3f13682a,0x3f0af1b7,0x3f0242b1,0x3ef2bd43
.long 0x3f039c3d,0x3ef41f07,0x3ee0924f,0x3ecc9b8b,0x3ee63375,0x3ed0eb2a,0x3ebb31a0,0x3ea5129f
.long 0x3f800000,0x3f800000,0x3f800000,0x3f800000,0x3f7f0e58,0x3f7efcc9,0x3f7eea9d,0x3f7ed7d4
.long 0x3f7c3b28,0x3f7bf531,0x3f7baccd,0x3f7b61fc,0x3f778bc5,0x3f76ef5b,0x3f764d97,0x3f75a67b
.long 0x3f710908,0x3f6ff573,0x3f6ed89e,0x3f6db293,0x3f68bf3c,0x3f671599,0x3f655e0b,0x3f6398ac
.long 0x3f5ebe05,0x3f5c61c7,0x3f59f26a,0x3f577026,0x3f531849,0x3f4fefa8,0x3f4cae79,0x3f495521
.long 0x3f45e403,0x3f41d870,0x3f3daef9,0x3f396842,0x3f373a23,0x3f3238aa,0x3f2d1469,0x3f27ce61
.long 0x3f273656,0x3f212ff9,0x3f1b02c6,0x3f14b039,0x3f15f6d9,0x3f0ee0db,0x3f07a136,0x3f003a06
.long 0x3f039c3d,0x3ef6e0cb,0x3ee63375,0x3ed53641,0x3ee0924f,0x3ece0bea,0x3ebb31a0,0x3ea80b1f
.long 0x3eb8442a,0x3ea395c5,0x3e8e9a22,0x3e72b651,0x3e8e9a22,0x3e6fa8b2,0x3e419b37,0x3e1324ca
.long 0x3f3504f3,0x3f2beb4a,0x3f226799,0x3f187fc0,0x3f2beb4a,0x3f21cbfb,0x3f173c07,0x3f0c42c9
.long 0x3f226799,0x3f173c07,0x3f0b9a6b,0x3eff17b2,0x3f187fc0,0x3f0c42c9,0x3eff17b2,0x3ee4cbfe
.long 0x3f0e39da,0x3f00e7e4,0x3ee63375,0x3ec9b953,0x3f039c3d,0x3eea6681,0x3ecc9b8b,0x3eadf73c
.long 0x3ef15aea,0x3ed25a09,0x3eb263ef,0x3e919ddd,0x3edae880,0x3eb9bb1e,0x3e97a117,0x3e698bba
.long 0x3ec3ef15,0x3ea09ae5,0x3e78cfcc,0x3e2f10a2,0x3eac7cd4,0x3e870ada,0x3e419b37,0x3de7fa9a
.long 0x3e94a031,0x3e5a3997,0x3e09cf86,0x3d621469,0x3e78cfcc,0x3e25c58c,0x3da3308c,0xbb490fc6
.long 0x3e47c5c2,0x3de1bc2e,0x3cc90ab0,0xbd7b2b74,0x3e164083,0x3d6ea038,0xbcfb49ba,0xbdf475c0
.long 0x3dc8bd36,0x3bc90f88,0xbdafb680,0xbe354098,0x3d48fb30,0xbd3c6dd5,0xbe1008b7,0xbe6fa8b2
.long 0x3f0e39da,0x3f039c3d,0x3ef15aea,0x3edae880,0x3f00e7e4,0x3eea6681,0x3ed25a09,0x3eb9bb1e
.long 0x3ee63375,0x3ecc9b8b,0x3eb263ef,0x3e97a117,0x3ec9b953,0x3eadf73c,0x3e919ddd,0x3e698bba
.long 0x3eac7cd4,0x3e8e9a22,0x3e605c13,0x3e22abb6,0x3e8e9a22,0x3e5d4b1a,0x3e1c76de,0x3db5f8da
.long 0x3e605c13,0x3e1c76de,0x3dafb680,0x3c96c9b6,0x3e22abb6,0x3db5f8da,0x3c96c9b6,0xbd55880e
.long 0x3dc8bd36,0x3cc90ab0,0xbd48fb30,0xbdfab273,0x3d16c32c,0xbd2351cb,0xbdee3876,0xbe44b0b9
.long 0xbcc90ab0,0xbdd53db9,0xbe3b6ecf,0xbe8586ce,0xbdafb680,0xbe2bf804,0xbe7ee6e1,0xbea80b1f
.long 0xbe164083,0xbe6c9a7f,0xbea09ae5,0xbec9b953,0xbe541501,0xbe9620d2,0xbec1071e,0xbeea6681
.long 0xbe888e93,0xbeb554ec,0xbee0924f,0xbf04f484,0xbea68f12,0xbed3c867,0xbeff17b2,0xbf140c5f
.long 0x3ec3ef15,0x3eac7cd4,0x3e94a031,0x3e78cfcc,0x3ea09ae5,0x3e870ada,0x3e5a3997,0x3e25c58c
.long 0x3e78cfcc,0x3e419b37,0x3e09cf86,0x3da3308c,0x3e2f10a2,0x3de7fa9a,0x3d621469,0xbb490fc6
.long 0x3dc8bd36,0x3d16c32c,0xbcc90ab0,0xbdafb680,0x3cc90ab0,0xbd2351cb,0xbdd53db9,0xbe2bf804
.long 0xbd48fb30,0xbdee3876,0xbe3b6ecf,0xbe7ee6e1,0xbdfab273,0xbe44b0b9,0xbe8586ce,0xbea80b1f
.long 0xbe47c5c2,0xbe888e93,0xbeac7cd4,0xbecf7bca,0xbe888e93,0xbeadf73c,0xbed25a09,0xbef58035
.long 0xbeac7cd4,0xbed25a09,0xbef6e0cb,0xbf0cead0,0xbecf7bca,0xbef58035,0xbf0cead0,0xbf1e1e22
.long 0xbef15aea,0xbf0b9a6b,0xbf1d7fd1,0xbf2e3bde,0xbf08f59b,0xbf1ba299,0xbf2d1469,0xbf3d27b8
.long 0xbf187fc0,0xbf2ac082,0xbf3b8f3b,0xbf4ac77f,0xbf273656,0xbf38dd65,0xbf48d8b3,0xbf570348
.long 0x3e47c5c2,0x3e164083,0x3dc8bd36,0x3d48fb30,0x3de1bc2e,0x3d6ea038,0x3bc90f88,0xbd3c6dd5
.long 0x3cc90ab0,0xbcfb49ba,0xbdafb680,0xbe1008b7,0xbd7b2b74,0xbdf475c0,0xbe354098,0xbe6fa8b2
.long 0xbe164083,0xbe541501,0xbe888e93,0xbea68f12,0xbe6c9a7f,0xbe9620d2,0xbeb554ec,0xbed3c867
.long 0xbea09ae5,0xbec1071e,0xbee0924f,0xbeff17b2,0xbec9b953,0xbeea6681,0xbf04f484,0xbf140c5f
.long 0xbef15aea,0xbf08f59b,0xbf187fc0,0xbf273656,0xbf0b9a6b,0xbf1ba299,0xbf2ac082,0xbf38dd65
.long 0xbf1d7fd1,0xbf2d1469,0xbf3b8f3b,0xbf48d8b3,0xbf2e3bde,0xbf3d27b8,0xbf4ac77f,0xbf570348
.long 0xbf3daef9,0xbf4bbbf8,0xbf584853,0xbf633c5a,0xbf4bbbf8,0xbf58b3a1,0xbf63f473,0xbf6d67a1
.long 0xbf584853,0xbf63f473,0xbf6db293,0xbf756d97,0xbf633c5a,0xbf6d67a1,0xbf756d97,0xbf7b3bab
.long 0x0,0x0,0x0,0x0,0x3d48fb30,0x3d55880e,0x3d621469,0x3d6ea038
.long 0x3dc8bd36,0x3dd53db9,0x3de1bc2e,0x3dee3876,0x3e164083,0x3e1f917b,0x3e28defc,0x3e3228d4
.long 0x3e47c5c2,0x3e541501,0x3e605c13,0x3e6c9a7f,0x3e78cfcc,0x3e840270,0x3e8b9507,0x3e931f35
.long 0x3e94a031,0x3e9d9e78,0x3ea68f12,0x3eaf713a,0x3eac7cd4,0x3eb6ccc3,0x3ec1071e,0x3ecb2aae
.long 0x3ec3ef15,0x3ecf7bca,0x3edae880,0x3ee63375,0x3edae880,0x3ee79a5d,0x3ef41f07,0x3f003a06
.long 0x3ef15aea,0x3eff17b2,0x3f064b82,0x3f0cead0,0x3f039c3d,0x3f0af1b7,0x3f121eb0,0x3f19210f
.long 0x3f0e39da,0x3f15f6d9,0x3f1d7fd1,0x3f24d225,0x3f187fc0,0x3f209393,0x3f286605,0x3f2ff3e6
.long 0x3f226799,0x3f2ac082,0x3f32c8c9,0x3f3a7ca4,0x3f2beb4a,0x3f34768f,0x3f3ca003,0x3f446337
.long 0x0,0x0,0x0,0x0,0x3d7b2b74,0x3d83db0a,0x3d8a200a,0x3d9064b4
.long 0x3dfab273,0x3e039502,0x3e09cf86,0x3e1008b7,0x3e3b6ecf,0x3e44b0b9,0x3e4dee60,0x3e57278f
.long 0x3e78cfcc,0x3e827dc0,0x3e888e93,0x3e8e9a22,0x3e9aa086,0x3ea21887,0x3ea986c4,0x3eb0eacb
.long 0x3eb8442a,0x3ec1071e,0x3ec9b953,0x3ed25a09,0x3ed53641,0x3edf28a9,0x3ee900b7,0x3ef2bd43
.long 0x3ef15aea,0x3efc5d27,0x3f039c3d,0x3f08f59b,0x3f064b82,0x3f0c42c9,0x3f121eb0,0x3f17de12
.long 0x3f13682a,0x3f19c200,0x3f1ff6cb,0x3f26050a,0x3f1ff6cb,0x3f269de3,0x3f2d1469,0x3f33587a
.long 0x3f2beb4a,0x3f32c8c9,0x3f396842,0x3f3fc767,0x3f373a23,0x3f3e35c5,0x3f44e3f5,0x3f4b41fa
.long 0x3f41d870,0x3f48d8b3,0x3f4f7a1f,0x3f55b993,0x3f4bbbf8,0x3f52a649,0x3f591e6a,0x3f5f20db
.long 0x0,0x0,0x0,0x0,0x3d96a905,0x3d9cecf9,0x3da3308c,0x3da973ba
.long 0x3e164083,0x3e1c76de,0x3e22abb6,0x3e28defc,0x3e605c13,0x3e698bba,0x3e72b651,0x3e7bdba4
.long 0x3e94a031,0x3e9aa086,0x3ea09ae5,0x3ea68f12,0x3eb8442a,0x3ebf926f,0x3ec6d529,0x3ece0bea
.long 0x3edae880,0x3ee363fa,0x3eebcbbb,0x3ef41f07,0x3efc5d27,0x3f02ef9f,0x3f07a136,0x3f0c42c9
.long 0x3f0e39da,0x3f13682a,0x3f187fc0,0x3f1d7fd1,0x3f1d7fd1,0x3f2302d3,0x3f286605,0x3f2da859
.long 0x3f2beb4a,0x3f31a81d,0x3f373a23,0x3f3ca003,0x3f396842,0x3f3f41fc,0x3f44e3f5,0x3f4a4c87
.long 0x3f45e403,0x3f4bbbf8,0x3f514d3d,0x3f5695e5,0x3f514d3d,0x3f570348,0x3f5c61c7,0x3f61668a
.long 0x3f5b941a,0x3f6106f2,0x3f660f88,0x3f6aab7b,0x3f64aa59,0x3f69b7e4,0x3f6e46be,0x3f725470
.long 0x0,0x0,0x0,0x0,0x3dafb680,0x3db5f8da,0x3dbc3ac3,0x3dc27c39
.long 0x3e2f10a2,0x3e354098,0x3e3b6ecf,0x3e419b37,0x3e827dc0,0x3e870ada,0x3e8b9507,0x3e901c2c
.long 0x3eac7cd4,0x3eb263ef,0x3eb8442a,0x3ebe1d4a,0x3ed53641,0x3edc53c1,0x3ee363fa,0x3eea6681
.long 0x3efc5d27,0x3f0242b1,0x3f064b82,0x3f0a48ad,0x3f10d3cd,0x3f1553b7,0x3f19c200,0x3f1e1e22
.long 0x3f226799,0x3f273656,0x3f2beb4a,0x3f3085bb,0x3f32c8c9,0x3f37c655,0x3f3ca003,0x3f4154e1
.long 0x3f41d870,0x3f46e22a,0x3f4bbbf8,0x3f5064af,0x3f4f7a1f,0x3f546b3b,0x3f591e6a,0x3f5d924d
.long 0x3f5b941a,0x3f604621,0x3f64aa59,0x3f68bf3c,0x3f660f88,0x3f6a5ad9,0x3f6e46be,0x3f71d19f
.long 0x3f6ed89e,0x3f7294f8,0x3f75dec6,0x3f78b47b,0x3f75dec6,0x3f78e3d6,0x3f7b61fc,0x3f7d57de
.long 0x3f3504f3,0x3f3daef9,0x3f45e403,0x3f4d9f02,0x3f3daef9,0x3f466354,0x3f4e8d90,0x3f5627fe
.long 0x3f45e403,0x3f4e8d90,0x3f5695e5,0x3f5df6be,0x3f4d9f02,0x3f5627fe,0x3f5df6be,0x3f650479
.long 0x3f54db31,0x3f5d2d53,0x3f64aa59,0x3f6b4b0c,0x3f5b941a,0x3f6398ac,0x3f6aab7b,0x3f70c501
.long 0x3f61c598,0x3f696591,0x3f6ff573,0x3f756d97,0x3f676bd8,0x3f6e8ff8,0x3f748422,0x3f7940c0
.long 0x3f6c835e,0x3f731447,0x3f7853f8,0x3f7c3b28,0x3f710908,0x3f76ef5b,0x3f7b61fc,0x3f7e5a38
.long 0x3f74fa0b,0x3f7a1e84,0x3f7dabcc,0x3f7f9c18,0x3f7853f8,0x3f7c9f8a,0x3f7f2f9d,0x3f7fffb1
.long 0x3f7b14be,0x3f7e70b0,0x3f7fec43,0x3f7f84ab,0x3f7d3aac,0x3f7f90b1,0x3f7fe129,0x3f7e2b72
.long 0x3f7ec46d,0x3f7ffec4,0x3f7f0e58,0x3f7bf531,0x3f7fb10f,0x3f7fba9e,0x3f7d7474,0x3f78e3d6
.long 0x3f54db31,0x3f5b941a,0x3f61c598,0x3f676bd8,0x3f5d2d53,0x3f6398ac,0x3f696591,0x3f6e8ff8
.long 0x3f64aa59,0x3f6aab7b,0x3f6ff573,0x3f748422,0x3f6b4b0c,0x3f70c501,0x3f756d97,0x3f7940c0
.long 0x3f710908,0x3f75dec6,0x3f79c79d,0x3f7cbfc9,0x3f75dec6,0x3f79f35e,0x3f7cfe73,0x3f7efcc9
.long 0x3f79c79d,0x3f7cfe73,0x3f7f0e58,0x3f7ff4e6,0x3f7cbfc9,0x3f7efcc9,0x3f7ff4e6,0x3f7fa6e3
.long 0x3f7ec46d,0x3f7fec43,0x3f7fb10f,0x3f7e1324,0x3f7fd397,0x3f7fcbe2,0x3f7e4323,0x3f7b3bab
.long 0x3f7fec43,0x3f7e9bc9,0x3f7baccd,0x3f772417,0x3f7f0e58,0x3f7c5d3a,0x3f77f110,0x3f71d19f
.long 0x3f7d3aac,0x3f791298,0x3f731447,0x3f6b4b0c,0x3f7a7302,0x3f74bf62,0x3f6d1c1d,0x3f6398ac
.long 0x3f76ba07,0x3f6f6830,0x3f660f88,0x3f5ac450,0x3f721352,0x3f6912ae,0x3f5df6be,0x3f50d937
.long 0x3f6c835e,0x3f710908,0x3f74fa0b,0x3f7853f8,0x3f731447,0x3f76ef5b,0x3f7a1e84,0x3f7c9f8a
.long 0x3f7853f8,0x3f7b61fc,0x3f7dabcc,0x3f7f2f9d,0x3f7c3b28,0x3f7e5a38,0x3f7f9c18,0x3f7fffb1
.long 0x3f7ec46d,0x3f7fd397,0x3f7fec43,0x3f7f0e58,0x3f7fec43,0x3f7fcbe2,0x3f7e9bc9,0x3f7c5d3a
.long 0x3f7fb10f,0x3f7e4323,0x3f7baccd,0x3f77f110,0x3f7e1324,0x3f7b3bab,0x3f772417,0x3f71d19f
.long 0x3f7b14be,0x3f76ba07,0x3f710908,0x3f6a09a7,0x3f76ba07,0x3f70c501,0x3f696591,0x3f60a6cf
.long 0x3f710908,0x3f696591,0x3f604621,0x3f55b993,0x3f6a09a7,0x3f60a6cf,0x3f55b993,0x3f495521
.long 0x3f61c598,0x3f5695e5,0x3f49d112,0x3f3b8f3b,0x3f584853,0x3f4b41fa,0x3f3ca003,0x3f2c800f
.long 0x3f4d9f02,0x3f3ebc1b,0x3f2e3bde,0x3f1c420c,0x3f41d870,0x3f311722,0x3f1ebc12,0x3f0af1b7
.long 0x3f7b14be,0x3f7d3aac,0x3f7ec46d,0x3f7fb10f,0x3f7e70b0,0x3f7f90b1,0x3f7ffec4,0x3f7fba9e
.long 0x3f7fec43,0x3f7fe129,0x3f7f0e58,0x3f7d7474,0x3f7f84ab,0x3f7e2b72,0x3f7bf531,0x3f78e3d6
.long 0x3f7d3aac,0x3f7a7302,0x3f76ba07,0x3f721352,0x3f791298,0x3f74bf62,0x3f6f6830,0x3f6912ae
.long 0x3f731447,0x3f6d1c1d,0x3f660f88,0x3f5df6be,0x3f6b4b0c,0x3f6398ac,0x3f5ac450,0x3f50d937
.long 0x3f61c598,0x3f584853,0x3f4d9f02,0x3f41d870,0x3f5695e5,0x3f4b41fa,0x3f3ebc1b,0x3f311722
.long 0x3f49d112,0x3f3ca003,0x3f2e3bde,0x3f1ebc12,0x3f3b8f3b,0x3f2c800f,0x3f1c420c,0x3f0af1b7
.long 0x3f2beb4a,0x3f1b02c6,0x3f08f59b,0x3eebcbbb,0x3f1b02c6,0x3f084b92,0x3ee900b7,0x3ebf926f
.long 0x3f08f59b,0x3ee900b7,0x3ebe1d4a,0x3e919ddd,0x3eebcbbb,0x3ebf926f,0x3e919ddd,0x3e44b0b9
.long 0x3f800000,0x3f7ec46d,0x3f7b14be,0x3f74fa0b,0x3f800000,0x3f7eb069,0x3f7ac516,0x3f74484b
.long 0x3f800000,0x3f7e9bc9,0x3f7a7302,0x3f73913f,0x3f800000,0x3f7e868b,0x3f7a1e84,0x3f72d4eb
.long 0x3f800000,0x3f7e70b0,0x3f79c79d,0x3f721352,0x3f800000,0x3f7e5a38,0x3f796e4e,0x3f714c7a
.long 0x3f800000,0x3f7e4323,0x3f791298,0x3f708066,0x3f800000,0x3f7e2b72,0x3f78b47b,0x3f6faf1b
.long 0x3f800000,0x3f7e1324,0x3f7853f8,0x3f6ed89e,0x3f800000,0x3f7dfa38,0x3f77f110,0x3f6dfcf2
.long 0x3f800000,0x3f7de0b1,0x3f778bc5,0x3f6d1c1d,0x3f800000,0x3f7dc68c,0x3f772417,0x3f6c3624
.long 0x3f800000,0x3f7dabcc,0x3f76ba07,0x3f6b4b0c,0x3f800000,0x3f7d906e,0x3f764d97,0x3f6a5ad9
.long 0x3f800000,0x3f7d7474,0x3f75dec6,0x3f696591,0x3f800000,0x3f7d57de,0x3f756d97,0x3f686b39
.long 0x3f6c835e,0x3f61c598,0x3f54db31,0x3f45e403,0x3f6b4b0c,0x3f5fe4e9,0x3f5233c6,0x3f425b89
.long 0x3f6a09a7,0x3f5df6be,0x3f4f7a1f,0x3f3ebc1b,0x3f68bf3c,0x3f5bfb34,0x3f4cae79,0x3f3b0629
.long 0x3f676bd8,0x3f59f26a,0x3f49d112,0x3f373a23,0x3f660f88,0x3f57dc7f,0x3f46e22a,0x3f33587a
.long 0x3f64aa59,0x3f55b993,0x3f43e200,0x3f2f61a5,0x3f633c5a,0x3f5389c7,0x3f40d0da,0x3f2b561b
.long 0x3f61c598,0x3f514d3d,0x3f3daef9,0x3f273656,0x3f604621,0x3f4f0417,0x3f3a7ca4,0x3f2302d3
.long 0x3f5ebe05,0x3f4cae79,0x3f373a23,0x3f1ebc12,0x3f5d2d53,0x3f4a4c87,0x3f33e7bc,0x3f1a6293
.long 0x3f5b941a,0x3f47de65,0x3f3085bb,0x3f15f6d9,0x3f59f26a,0x3f456439,0x3f2d1469,0x3f11796b
.long 0x3f584853,0x3f42de29,0x3f299415,0x3f0cead0,0x3f5695e5,0x3f404c5c,0x3f26050a,0x3f084b92
.long 0x3f3504f3,0x3f226799,0x3f0e39da,0x3ef15aea,0x3f3085bb,0x3f1ce11f,0x3f07a136,0x3ee1fb6a
.long 0x3f2beb4a,0x3f173c07,0x3f00e7e4,0x3ed25a09,0x3f273656,0x3f11796b,0x3ef41f07,0x3ec27b55
.long 0x3f226799,0x3f0b9a6b,0x3ee63375,0x3eb263ef,0x3f1d7fd1,0x3f05a02c,0x3ed8106b,0x3ea21887
.long 0x3f187fc0,0x3eff17b2,0x3ec9b953,0x3e919ddd,0x3f13682a,0x3ef2bd43,0x3ebb31a0,0x3e80f8c0
.long 0x3f0e39da,0x3ee63375,0x3eac7cd4,0x3e605c13,0x3f08f59b,0x3ed97cb9,0x3e9d9e78,0x3e3e853e
.long 0x3f039c3d,0x3ecc9b8b,0x3e8e9a22,0x3e1c76de,0x3efc5d27,0x3ebf926f,0x3e7ee6e1,0x3df475c0
.long 0x3ef15aea,0x3eb263ef,0x3e605c13,0x3dafb680,0x3ee63375,0x3ea5129f,0x3e419b37,0x3d55880e
.long 0x3edae880,0x3e97a117,0x3e22abb6,0x3c96c9b6,0x3ecf7bca,0x3e8a11f7,0x3e039502,0xbc7b514b
.long 0x3ec3ef15,0x3e94a031,0x3e47c5c2,0x3dc8bd36,0x3eb263ef,0x3e80f8c0,0x3e1c76de,0x3d55880e
.long 0x3ea09ae5,0x3e5a3997,0x3de1bc2e,0x3bc90f88,0x3e8e9a22,0x3e3228d4,0x3d8a200a,0xbd2351cb
.long 0x3e78cfcc,0x3e09cf86,0x3cc90ab0,0xbdafb680,0x3e541501,0x3dc27c39,0xbc96c9b6,0xbe06b26e
.long 0x3e2f10a2,0x3d621469,0xbd7b2b74,0xbe354098,0x3e09cf86,0x3c7b514b,0xbdd53db9,0xbe636c83
.long 0x3dc8bd36,0xbcc90ab0,0xbe164083,0xbe888e93,0x3d7b2b74,0xbd83db0a,0xbe419b37,0xbe9f1cdf
.long 0x3cc90ab0,0xbdd53db9,0xbe6c9a7f,0xbeb554ec,0xbc490e90,0xbe1324ca,0xbe8b9507,0xbecb2aae
.long 0xbd48fb30,0xbe3b6ecf,0xbea09ae5,0xbee0924f,0xbdafb680,0xbe636c83,0xbeb554ec,0xbef58035
.long 0xbdfab273,0xbe8586ce,0xbec9b953,0xbf04f484,0xbe22abb6,0xbe9920fe,0xbeddbe79,0xbf0ee0db
.long 0x248d3132,0xbdc8bd36,0xbe47c5c2,0xbe94a031,0xbd48fb30,0xbe195be0,0xbe7ee6e1,0xbeb0eacb
.long 0xbdc8bd36,0xbe4dee60,0xbe9aa086,0xbecc9b8b,0xbe164083,0xbe80f8c0,0xbeb554ec,0xbee79a5d
.long 0xbe47c5c2,0xbe9aa086,0xbecf7bca,0xbf00e7e4,0xbe78cfcc,0xbeb3dca5,0xbee900b7,0xbf0d9281
.long 0xbe94a031,0xbecc9b8b,0xbf00e7e4,0xbf19c200,0xbeac7cd4,0xbee4cbfe,0xbf0cead0,0xbf256bcb
.long 0xbec3ef15,0xbefc5d27,0xbf187fc0,0xbf3085bb,0xbedae880,0xbf099f4e,0xbf239da9,0xbf3b0629
.long 0xbef15aea,0xbf14b039,0xbf2e3bde,0xbf44e3f5,0xbf039c3d,0xbf1f599f,0xbf385216,0xbf4e1689
.long 0xbf0e39da,0xbf299415,0xbf41d870,0xbf5695e5,0xbf187fc0,0xbf33587a,0xbf4ac77f,0xbf5e5aa6
.long 0xbf226799,0xbf3ca003,0xbf531849,0xbf655e0b,0xbf2beb4a,0xbf456439,0xbf5ac450,0xbf6b99fb
.long 0xbec3ef15,0xbef15aea,0xbf0e39da,0xbf226799,0xbee0924f,0xbf06f686,0xbf1c420c,0xbf2ff3e6
.long 0xbefc5d27,0xbf14b039,0xbf299415,0xbf3ca003,0xbf0b9a6b,0xbf21cbfb,0xbf36206c,0xbf485bca
.long 0xbf187fc0,0xbf2e3bde,0xbf41d870,0xbf531849,0xbf24d225,0xbf39f2ac,0xbf4cae79,0xbf5cc7d1
.long 0xbf3085bb,0xbf44e3f5,0xbf5695e5,0xbf655e0b,0xbf3b8f3b,0xbf4f0417,0xbf5f8327,0xbf6cd007
.long 0xbf45e403,0xbf584853,0xbf676bd8,0xbf731447,0xbf4f7a1f,0xbf60a6cf,0xbf6e46be,0xbf7822d1
.long 0xbf584853,0xbf6816a8,0xbf740bdd,0xbf7bf531,0xbf604621,0xbf6e8ff8,0xbf78b47b,0xbf7e868b
.long 0xbf676bd8,0xbf740bdd,0xbf7c3b28,0xbf7fd397,0xbf6db293,0xbf788486,0xbf7e9bc9,0xbf7fdaaf
.long 0xbf731447,0xbf7bf531,0xbf7fd397,0xbf7e9bc9,0xbf778bc5,0xbf7e5a38,0xbf7fe129,0xbf7c187a
.long 0xbf3504f3,0xbf45e403,0xbf54db31,0xbf61c598,0xbf41d870,0xbf51c0c2,0xbf5f8327,0xbf6afb8c
.long 0xbf4d9f02,0xbf5c61c7,0xbf68bf3c,0xbf7294f8,0xbf584853,0xbf65b710,0xbf708066,0xbf788486
.long 0xbf61c598,0xbf6db293,0xbf76ba07,0xbf7cbfc9,0xbf6a09a7,0xbf74484b,0xbf7b61fc,0xbf7f3f54
.long 0xbf710908,0xbf796e4e,0xbf7e70b0,0xbf7ffec4,0xbf76ba07,0xbf7d1cdd,0xbf7fe129,0xbf7efcc9
.long 0xbf7b14be,0xbf7f4e6d,0xbf7fb10f,0xbf7c3b28,0xbf7e1324,0xbf7fffb1,0xbf7de0b1,0xbf77beb7
.long 0xbf7fb10f,0xbf7f2f9d,0xbf7a7302,0xbf718f57,0xbf7fec43,0xbf7cdf6c,0xbf756d97,0xbf69b7e4
.long 0xbf7ec46d,0xbf791298,0xbf6ed89e,0xbf604621,0xbf7c3b28,0xbf73ced9,0xbf66becc,0xbf554aa4
.long 0xbf7853f8,0xbf6d1c1d,0xbf5d2d53,0xbf48d8b3,0xbf731447,0xbf650479,0xbf5233c6,0xbf3b0629
.long 0xbf6c835e,0xbf74fa0b,0xbf7b14be,0xbf7ec46d,0xbf740bdd,0xbf7a9c59,0xbf7e9bc9,0xbf7fffb1
.long 0xbf79c79d,0xbf7e4323,0xbf7ffb11,0xbf7eea9d,0xbf7dabcc,0xbf7fe705,0xbf7f2f9d,0xbf7b87b2
.long 0xbf7fb10f,0xbf7f84ab,0xbf7c3b28,0xbf75dec6,0xbf7fd397,0xbf7d1cdd,0xbf772417,0xbf6dfcf2
.long 0xbf7e1324,0xbf78b47b,0xbf6ff573,0xbf63f473,0xbf7a7302,0xbf725470,0xbf66becc,0xbf57dc7f
.long 0xbf74fa0b,0xbf6a09a7,0xbf5b941a,0xbf49d112,0xbf6db293,0xbf5fe4e9,0xbf4e8d90,0xbf39f2ac
.long 0xbf64aa59,0xbf53fac3,0xbf3fc767,0xbf286605,0xbf59f26a,0xbf466354,0xbf2f61a5,0xbf1553b7
.long 0xbf4d9f02,0xbf373a23,0xbf1d7fd1,0xbf00e7e4,0xbf3fc767,0xbf269de3,0xbf0a48ad,0xbed6a399
.long 0xbf3085bb,0xbf14b039,0xbeebcbbb,0xbea986c4,0xbf1ff6cb,0xbf019573,0xbec1071e,0xbe75c35a
.long 0x0,0x3dc8bd36,0x3e47c5c2,0x3e94a031,0x0,0x3dcefdb7,0x3e4dee60,0x3e9920fe
.long 0x0,0x3dd53db9,0x3e541501,0x3e9d9e78,0x0,0x3ddb7d37,0x3e5a3997,0x3ea21887
.long 0x0,0x3de1bc2e,0x3e605c13,0x3ea68f12,0x0,0x3de7fa9a,0x3e667c66,0x3eab0201
.long 0x0,0x3dee3876,0x3e6c9a7f,0x3eaf713a,0x0,0x3df475c0,0x3e72b651,0x3eb3dca5
.long 0x0,0x3dfab273,0x3e78cfcc,0x3eb8442a,0x0,0x3e007745,0x3e7ee6e1,0x3ebca7af
.long 0x0,0x3e039502,0x3e827dc0,0x3ec1071e,0x0,0x3e06b26e,0x3e8586ce,0x3ec5625c
.long 0x0,0x3e09cf86,0x3e888e93,0x3ec9b953,0x0,0x3e0cec4a,0x3e8b9507,0x3ece0bea
.long 0x0,0x3e1008b7,0x3e8e9a22,0x3ed25a09,0x0,0x3e1324ca,0x3e919ddd,0x3ed6a399
.long 0x3ec3ef15,0x3ef15aea,0x3f0e39da,0x3f226799,0x3ec9b953,0x3ef840c8,0x3f121eb0,0x3f269de3
.long 0x3ecf7bca,0x3eff17b2,0x3f15f6d9,0x3f2ac082,0x3ed53641,0x3f02ef9f,0x3f19c200,0x3f2ecef7
.long 0x3edae880,0x3f064b82,0x3f1d7fd1,0x3f32c8c9,0x3ee0924f,0x3f099f4e,0x3f212ff9,0x3f36ad7f
.long 0x3ee63375,0x3f0cead0,0x3f24d225,0x3f3a7ca4,0x3eebcbbb,0x3f102dd5,0x3f286605,0x3f3e35c5
.long 0x3ef15aea,0x3f13682a,0x3f2beb4a,0x3f41d870,0x3ef6e0cb,0x3f16999f,0x3f2f61a5,0x3f456439
.long 0x3efc5d27,0x3f19c200,0x3f32c8c9,0x3f48d8b3,0x3f00e7e4,0x3f1ce11f,0x3f36206c,0x3f4c3578
.long 0x3f039c3d,0x3f1ff6cb,0x3f396842,0x3f4f7a1f,0x3f064b82,0x3f2302d3,0x3f3ca003,0x3f52a649
.long 0x3f08f59b,0x3f26050a,0x3f3fc767,0x3f55b993,0x3f0b9a6b,0x3f28fd41,0x3f42de29,0x3f58b3a1
.long 0x3f3504f3,0x3f45e403,0x3f54db31,0x3f61c598,0x3f396842,0x3f4a4c87,0x3f591e6a,0x3f65b710
.long 0x3f3daef9,0x3f4e8d90,0x3f5d2d53,0x3f696591,0x3f41d870,0x3f52a649,0x3f6106f2,0x3f6cd007
.long 0x3f45e403,0x3f5695e5,0x3f64aa59,0x3f6ff573,0x3f49d112,0x3f5a5ba0,0x3f6816a8,0x3f72d4eb
.long 0x3f4d9f02,0x3f5df6be,0x3f6b4b0c,0x3f756d97,0x3f514d3d,0x3f61668a,0x3f6e46be,0x3f77beb7
.long 0x3f54db31,0x3f64aa59,0x3f710908,0x3f79c79d,0x3f584853,0x3f67c187,0x3f73913f,0x3f7b87b2
.long 0x3f5b941a,0x3f6aab7b,0x3f75dec6,0x3f7cfe73,0x3f5ebe05,0x3f6d67a1,0x3f77f110,0x3f7e2b72
.long 0x3f61c598,0x3f6ff573,0x3f79c79d,0x3f7f0e58,0x3f64aa59,0x3f725470,0x3f7b61fc,0x3f7fa6e3
.long 0x3f676bd8,0x3f748422,0x3f7cbfc9,0x3f7ff4e6,0x3f6a09a7,0x3f76841b,0x3f7de0b1,0x3f7ff84a
.long 0x3f6c835e,0x3f74fa0b,0x3f7b14be,0x3f7ec46d,0x3f6ff573,0x3f77beb7,0x3f7cfe73,0x3f7fa6e3
.long 0x3f731447,0x3f7a1e84,0x3f7e70b0,0x3f7ffec4,0x3f75dec6,0x3f7c187a,0x3f7f6ac7,0x3f7fcbe2
.long 0x3f7853f8,0x3f7dabcc,0x3f7fec43,0x3f7f0e58,0x3f7a7302,0x3f7ed7d4,0x3f7ff4e6,0x3f7dc68c
.long 0x3f7c3b28,0x3f7f9c18,0x3f7f84ab,0x3f7bf531,0x3f7dabcc,0x3f7ff84a,0x3f7e9bc9,0x3f799b43
.long 0x3f7ec46d,0x3f7fec43,0x3f7d3aac,0x3f76ba07,0x3f7f84ab,0x3f7f7808,0x3f7b61fc,0x3f73530e
.long 0x3f7fec43,0x3f7e9bc9,0x3f791298,0x3f6f6830,0x3f7ffb11,0x3f7d57de,0x3f764d97,0x3f6afb8c
.long 0x3f7fb10f,0x3f7baccd,0x3f731447,0x3f660f88,0x3f7f0e58,0x3f799b43,0x3f6f6830,0x3f60a6cf
.long 0x3f7e1324,0x3f772417,0x3f6b4b0c,0x3f5ac450,0x3f7cbfc9,0x3f74484b,0x3f66becc,0x3f546b3b
.long 0x3f800000,0x3f7ec46d,0x3f7b14be,0x3f74fa0b,0x3f7fb10f,0x3f7d1cdd,0x3f77f110,0x3f703b37
.long 0x3f7ec46d,0x3f7ac516,0x3f740bdd,0x3f6aab7b,0x3f7d3aac,0x3f77beb7,0x3f6f6830,0x3f644fac
.long 0x3f7b14be,0x3f740bdd,0x3f6a09a7,0x3f5d2d53,0x3f7853f8,0x3f6faf1b,0x3f63f473,0x3f554aa4
.long 0x3f74fa0b,0x3f6aab7b,0x3f5d2d53,0x3f4cae79,0x3f710908,0x3f650479,0x3f55b993,0x3f436051
.long 0x3f6c835e,0x3f5ebe05,0x3f4d9f02,0x3f396842,0x3f676bd8,0x3f57dc7f,0x3f44e3f5,0x3f2ecef7
.long 0x3f61c598,0x3f5064af,0x3f3b8f3b,0x3f239da9,0x3f5b941a,0x3f485bca,0x3f31a81d,0x3f17de12
.long 0x3f54db31,0x3f3fc767,0x3f273656,0x3f0b9a6b,0x3f4d9f02,0x3f36ad7f,0x3f1c420c,0x3efdbabb
.long 0x3f45e403,0x3f2d1469,0x3f10d3cd,0x3ee363fa,0x3f3daef9,0x3f2302d3,0x3f04f484,0x3ec8477c
.long 0x3f6c835e,0x3f61c598,0x3f54db31,0x3f45e403,0x3f660f88,0x3f5988ad,0x3f4ac77f,0x3f39f2ac
.long 0x3f5ebe05,0x3f5064af,0x3f3fc767,0x3f2d1469,0x3f5695e5,0x3f466354,0x3f33e7bc,0x3f1f599f
.long 0x3f4d9f02,0x3f3b8f3b,0x3f273656,0x3f10d3cd,0x3f43e200,0x3f2ff3e6,0x3f19c200,0x3f019573
.long 0x3f396842,0x3f239da9,0x3f0b9a6b,0x3ee363fa,0x3f2e3bde,0x3f16999f,0x3ef9a02d,0x3ec27b55
.long 0x3f226799,0x3f08f59b,0x3edae880,0x3ea09ae5,0x3f15f6d9,0x3ef58035,0x3ebb31a0,0x3e7bdba4
.long 0x3f08f59b,0x3ed8106b,0x3e9aa086,0x3e354098,0x3ef6e0cb,0x3eb9bb1e,0x3e72b651,0x3ddb7d37
.long 0x3edae880,0x3e9aa086,0x3e2f10a2,0x3d16c32c,0x3ebe1d4a,0x3e75c35a,0x3dd53db9,0xbd0a342f
.long 0x3ea09ae5,0x3e354098,0x3d16c32c,0xbdd53db9,0x3e827dc0,0x3de7fa9a,0xbcfb49ba,0xbe3228d4
.long 0x3f3504f3,0x3f226799,0x3f0e39da,0x3ef15aea,0x3f273656,0x3f12c39a,0x3ef9a02d,0x3ecb2aae
.long 0x3f187fc0,0x3f0242b1,0x3ed53641,0x3ea395c5,0x3f08f59b,0x3ee1fb6a,0x3eaf713a,0x3e75c35a
.long 0x3ef15aea,0x3ebe1d4a,0x3e888e93,0x3e22abb6,0x3ecf7bca,0x3e9920fe,0x3e419b37,0x3d9cecf9
.long 0x3eac7cd4,0x3e667c66,0x3de1bc2e,0xbbc90f88,0x3e888e93,0x3e195be0,0x3cfb49ba,0xbdb5f8da
.long 0x3e47c5c2,0x3d96a905,0xbd48fb30,0xbe2f10a2,0x3dfab273,0xbb490fc6,0xbe039502,0xbe80f8c0
.long 0x3d48fb30,0xbda3308c,0xbe541501,0xbea986c4,0xbcc90ab0,0xbe1f917b,0xbe919ddd,0xbed0eb2a
.long 0xbdc8bd36,0xbe6c9a7f,0xbeb8442a,0xbef6e0cb,0xbe2f10a2,0xbe9c1faf,0xbeddbe79,0xbf0d9281
.long 0xbe78cfcc,0xbec1071e,0xbf00e7e4,0xbf1ebc12,0xbea09ae5,0xbee4cbfe,0xbf121eb0,0xbf2ecef7
.long 0x3ec3ef15,0x3e94a031,0x3e47c5c2,0x3dc8bd36,0x3e9aa086,0x3e5101f1,0x3dd53db9,0x3b490fc6
.long 0x3e605c13,0x3dee3876,0x3c490e90,0xbdbc3ac3,0x3e09cf86,0x3ce22a7a,0xbda3308c,0xbe3e853e
.long 0x3d48fb30,0xbd7b2b74,0xbe2f10a2,0xbe8e9a22,0xbd16c32c,0xbe195be0,0xbe8586ce,0xbebca7af
.long 0xbdfab273,0xbe72b651,0xbeb263ef,0xbee900b7,0xbe541501,0xbea5129f,0xbeddbe79,0xbf099f4e
.long 0xbe94a031,0xbecf7bca,0xbf039c3d,0xbf1d7fd1,0xbebe1d4a,0xbef840c8,0xbf173c07,0xbf2ff3e6
.long 0xbee63375,0xbf0f8784,0xbf299415,0xbf40d0da,0xbf064b82,0xbf21cbfb,0xbf3a7ca4,0xbf4fefa8
.long 0xbf187fc0,0xbf32c8c9,0xbf49d112,0xbf5d2d53,0xbf299415,0xbf425b89,0xbf577026,0xbf686b39
.long 0xbf396842,0xbf5064af,0xbf633c5a,0xbf718f57,0xbf47de65,0xbf5cc7d1,0xbf6d1c1d,0xbf788486
.long 0x3f800000,0x3f800000,0x3f800000,0x3f800000,0x3f7ec46d,0x3f7eb069,0x3f7e9bc9,0x3f7e868b
.long 0x3f7b14be,0x3f7ac516,0x3f7a7302,0x3f7a1e84,0x3f74fa0b,0x3f74484b,0x3f73913f,0x3f72d4eb
.long 0x3f6c835e,0x3f6b4b0c,0x3f6a09a7,0x3f68bf3c,0x3f61c598,0x3f5fe4e9,0x3f5df6be,0x3f5bfb34
.long 0x3f54db31,0x3f5233c6,0x3f4f7a1f,0x3f4cae79,0x3f45e403,0x3f425b89,0x3f3ebc1b,0x3f3b0629
.long 0x3f3504f3,0x3f3085bb,0x3f2beb4a,0x3f273656,0x3f226799,0x3f1ce11f,0x3f173c07,0x3f11796b
.long 0x3f0e39da,0x3f07a136,0x3f00e7e4,0x3ef41f07,0x3ef15aea,0x3ee1fb6a,0x3ed25a09,0x3ec27b55
.long 0x3ec3ef15,0x3eb263ef,0x3ea09ae5,0x3e8e9a22,0x3e94a031,0x3e80f8c0,0x3e5a3997,0x3e3228d4
.long 0x3e47c5c2,0x3e1c76de,0x3de1bc2e,0x3d8a200a,0x3dc8bd36,0x3d55880e,0x3bc90f88,0xbd2351cb
.long 0x3f800000,0x3f800000,0x3f800000,0x3f800000,0x3f7e70b0,0x3f7e5a38,0x3f7e4323,0x3f7e2b72
.long 0x3f79c79d,0x3f796e4e,0x3f791298,0x3f78b47b,0x3f721352,0x3f714c7a,0x3f708066,0x3f6faf1b
.long 0x3f676bd8,0x3f660f88,0x3f64aa59,0x3f633c5a,0x3f59f26a,0x3f57dc7f,0x3f55b993,0x3f5389c7
.long 0x3f49d112,0x3f46e22a,0x3f43e200,0x3f40d0da,0x3f373a23,0x3f33587a,0x3f2f61a5,0x3f2b561b
.long 0x3f226799,0x3f1d7fd1,0x3f187fc0,0x3f13682a,0x3f0b9a6b,0x3f05a02c,0x3eff17b2,0x3ef2bd43
.long 0x3ee63375,0x3ed8106b,0x3ec9b953,0x3ebb31a0,0x3eb263ef,0x3ea21887,0x3e919ddd,0x3e80f8c0
.long 0x3e78cfcc,0x3e541501,0x3e2f10a2,0x3e09cf86,0x3e09cf86,0x3dc27c39,0x3d621469,0x3c7b514b
.long 0x3cc90ab0,0xbc96c9b6,0xbd7b2b74,0xbdd53db9,0xbdafb680,0xbe06b26e,0xbe354098,0xbe636c83
.long 0x3f800000,0x3f800000,0x3f800000,0x3f800000,0x3f7e1324,0x3f7dfa38,0x3f7de0b1,0x3f7dc68c
.long 0x3f7853f8,0x3f77f110,0x3f778bc5,0x3f772417,0x3f6ed89e,0x3f6dfcf2,0x3f6d1c1d,0x3f6c3624
.long 0x3f61c598,0x3f604621,0x3f5ebe05,0x3f5d2d53,0x3f514d3d,0x3f4f0417,0x3f4cae79,0x3f4a4c87
.long 0x3f3daef9,0x3f3a7ca4,0x3f373a23,0x3f33e7bc,0x3f273656,0x3f2302d3,0x3f1ebc12,0x3f1a6293
.long 0x3f0e39da,0x3f08f59b,0x3f039c3d,0x3efc5d27,0x3ee63375,0x3ed97cb9,0x3ecc9b8b,0x3ebf926f
.long 0x3eac7cd4,0x3e9d9e78,0x3e8e9a22,0x3e7ee6e1,0x3e605c13,0x3e3e853e,0x3e1c76de,0x3df475c0
.long 0x3dc8bd36,0x3d7b2b74,0x3cc90ab0,0xbc490e90,0xbcc90ab0,0xbd83db0a,0xbdd53db9,0xbe1324ca
.long 0xbe164083,0xbe419b37,0xbe6c9a7f,0xbe8b9507,0xbe888e93,0xbe9f1cdf,0xbeb554ec,0xbecb2aae
.long 0x3f800000,0x3f800000,0x3f800000,0x3f800000,0x3f7dabcc,0x3f7d906e,0x3f7d7474,0x3f7d57de
.long 0x3f76ba07,0x3f764d97,0x3f75dec6,0x3f756d97,0x3f6b4b0c,0x3f6a5ad9,0x3f696591,0x3f686b39
.long 0x3f5b941a,0x3f59f26a,0x3f584853,0x3f5695e5,0x3f47de65,0x3f456439,0x3f42de29,0x3f404c5c
.long 0x3f3085bb,0x3f2d1469,0x3f299415,0x3f26050a,0x3f15f6d9,0x3f11796b,0x3f0cead0,0x3f084b92
.long 0x3ef15aea,0x3ee63375,0x3edae880,0x3ecf7bca,0x3eb263ef,0x3ea5129f,0x3e97a117,0x3e8a11f7
.long 0x3e605c13,0x3e419b37,0x3e22abb6,0x3e039502,0x3dafb680,0x3d55880e,0x3c96c9b6,0xbc7b514b
.long 0xbd48fb30,0xbdafb680,0xbdfab273,0xbe22abb6,0xbe3b6ecf,0xbe636c83,0xbe8586ce,0xbe9920fe
.long 0xbea09ae5,0xbeb554ec,0xbec9b953,0xbeddbe79,0xbee0924f,0xbef58035,0xbf04f484,0xbf0ee0db
.long 0x248d3132,0xbd48fb30,0xbdc8bd36,0xbe164083,0xbdc8bd36,0xbe195be0,0xbe4dee60,0xbe80f8c0
.long 0xbe47c5c2,0xbe7ee6e1,0xbe9aa086,0xbeb554ec,0xbe94a031,0xbeb0eacb,0xbecc9b8b,0xbee79a5d
.long 0xbec3ef15,0xbee0924f,0xbefc5d27,0xbf0b9a6b,0xbef15aea,0xbf06f686,0xbf14b039,0xbf21cbfb
.long 0xbf0e39da,0xbf1c420c,0xbf299415,0xbf36206c,0xbf226799,0xbf2ff3e6,0xbf3ca003,0xbf485bca
.long 0xbf3504f3,0xbf41d870,0xbf4d9f02,0xbf584853,0xbf45e403,0xbf51c0c2,0xbf5c61c7,0xbf65b710
.long 0xbf54db31,0xbf5f8327,0xbf68bf3c,0xbf708066,0xbf61c598,0xbf6afb8c,0xbf7294f8,0xbf788486
.long 0xbf6c835e,0xbf740bdd,0xbf79c79d,0xbf7dabcc,0xbf74fa0b,0xbf7a9c59,0xbf7e4323,0xbf7fe705
.long 0xbf7b14be,0xbf7e9bc9,0xbf7ffb11,0xbf7f2f9d,0xbf7ec46d,0xbf7fffb1,0xbf7eea9d,0xbf7b87b2
.long 0xbe47c5c2,0xbe78cfcc,0xbe94a031,0xbeac7cd4,0xbe9aa086,0xbeb3dca5,0xbecc9b8b,0xbee4cbfe
.long 0xbecf7bca,0xbee900b7,0xbf00e7e4,0xbf0cead0,0xbf00e7e4,0xbf0d9281,0xbf19c200,0xbf256bcb
.long 0xbf187fc0,0xbf24d225,0xbf3085bb,0xbf3b8f3b,0xbf2e3bde,0xbf39f2ac,0xbf44e3f5,0xbf4f0417
.long 0xbf41d870,0xbf4cae79,0xbf5695e5,0xbf5f8327,0xbf531849,0xbf5cc7d1,0xbf655e0b,0xbf6cd007
.long 0xbf61c598,0xbf6a09a7,0xbf710908,0xbf76ba07,0xbf6db293,0xbf74484b,0xbf796e4e,0xbf7d1cdd
.long 0xbf76ba07,0xbf7b61fc,0xbf7e70b0,0xbf7fe129,0xbf7cbfc9,0xbf7f3f54,0xbf7ffec4,0xbf7efcc9
.long 0xbf7fb10f,0xbf7fd397,0xbf7e1324,0xbf7a7302,0xbf7f84ab,0xbf7d1cdd,0xbf78b47b,0xbf725470
.long 0xbf7c3b28,0xbf772417,0xbf6ff573,0xbf66becc,0xbf75dec6,0xbf6dfcf2,0xbf63f473,0xbf57dc7f
.long 0xbec3ef15,0xbedae880,0xbef15aea,0xbf039c3d,0xbefc5d27,0xbf099f4e,0xbf14b039,0xbf1f599f
.long 0xbf187fc0,0xbf239da9,0xbf2e3bde,0xbf385216,0xbf3085bb,0xbf3b0629,0xbf44e3f5,0xbf4e1689
.long 0xbf45e403,0xbf4f7a1f,0xbf584853,0xbf604621,0xbf584853,0xbf60a6cf,0xbf6816a8,0xbf6e8ff8
.long 0xbf676bd8,0xbf6e46be,0xbf740bdd,0xbf78b47b,0xbf731447,0xbf7822d1,0xbf7bf531,0xbf7e868b
.long 0xbf7b14be,0xbf7e1324,0xbf7fb10f,0xbf7fec43,0xbf7f4e6d,0xbf7fffb1,0xbf7f2f9d,0xbf7cdf6c
.long 0xbf7fb10f,0xbf7de0b1,0xbf7a7302,0xbf756d97,0xbf7c3b28,0xbf77beb7,0xbf718f57,0xbf69b7e4
.long 0xbf74fa0b,0xbf6db293,0xbf64aa59,0xbf59f26a,0xbf6a09a7,0xbf5fe4e9,0xbf53fac3,0xbf466354
.long 0xbf5b941a,0xbf4e8d90,0xbf3fc767,0xbf2f61a5,0xbf49d112,0xbf39f2ac,0xbf286605,0xbf1553b7
.long 0xbf0e39da,0xbf187fc0,0xbf226799,0xbf2beb4a,0xbf299415,0xbf33587a,0xbf3ca003,0xbf456439
.long 0xbf41d870,0xbf4ac77f,0xbf531849,0xbf5ac450,0xbf5695e5,0xbf5e5aa6,0xbf655e0b,0xbf6b99fb
.long 0xbf676bd8,0xbf6db293,0xbf731447,0xbf778bc5,0xbf740bdd,0xbf788486,0xbf7bf531,0xbf7e5a38
.long 0xbf7c3b28,0xbf7e9bc9,0xbf7fd397,0xbf7fe129,0xbf7fd397,0xbf7fdaaf,0xbf7e9bc9,0xbf7c187a
.long 0xbf7ec46d,0xbf7c3b28,0xbf7853f8,0xbf731447,0xbf791298,0xbf73ced9,0xbf6d1c1d,0xbf650479
.long 0xbf6ed89e,0xbf66becc,0xbf5d2d53,0xbf5233c6,0xbf604621,0xbf554aa4,0xbf48d8b3,0xbf3b0629
.long 0xbf4d9f02,0xbf3fc767,0xbf3085bb,0xbf1ff6cb,0xbf373a23,0xbf269de3,0xbf14b039,0xbf019573
.long 0xbf1d7fd1,0xbf0a48ad,0xbeebcbbb,0xbec1071e,0xbf00e7e4,0xbed6a399,0xbea986c4,0xbe75c35a
.long 0x0,0x0,0x0,0x0,0x3dc8bd36,0x3dcefdb7,0x3dd53db9,0x3ddb7d37
.long 0x3e47c5c2,0x3e4dee60,0x3e541501,0x3e5a3997,0x3e94a031,0x3e9920fe,0x3e9d9e78,0x3ea21887
.long 0x3ec3ef15,0x3ec9b953,0x3ecf7bca,0x3ed53641,0x3ef15aea,0x3ef840c8,0x3eff17b2,0x3f02ef9f
.long 0x3f0e39da,0x3f121eb0,0x3f15f6d9,0x3f19c200,0x3f226799,0x3f269de3,0x3f2ac082,0x3f2ecef7
.long 0x3f3504f3,0x3f396842,0x3f3daef9,0x3f41d870,0x3f45e403,0x3f4a4c87,0x3f4e8d90,0x3f52a649
.long 0x3f54db31,0x3f591e6a,0x3f5d2d53,0x3f6106f2,0x3f61c598,0x3f65b710,0x3f696591,0x3f6cd007
.long 0x3f6c835e,0x3f6ff573,0x3f731447,0x3f75dec6,0x3f74fa0b,0x3f77beb7,0x3f7a1e84,0x3f7c187a
.long 0x3f7b14be,0x3f7cfe73,0x3f7e70b0,0x3f7f6ac7,0x3f7ec46d,0x3f7fa6e3,0x3f7ffec4,0x3f7fcbe2
.long 0x0,0x0,0x0,0x0,0x3de1bc2e,0x3de7fa9a,0x3dee3876,0x3df475c0
.long 0x3e605c13,0x3e667c66,0x3e6c9a7f,0x3e72b651,0x3ea68f12,0x3eab0201,0x3eaf713a,0x3eb3dca5
.long 0x3edae880,0x3ee0924f,0x3ee63375,0x3eebcbbb,0x3f064b82,0x3f099f4e,0x3f0cead0,0x3f102dd5
.long 0x3f1d7fd1,0x3f212ff9,0x3f24d225,0x3f286605,0x3f32c8c9,0x3f36ad7f,0x3f3a7ca4,0x3f3e35c5
.long 0x3f45e403,0x3f49d112,0x3f4d9f02,0x3f514d3d,0x3f5695e5,0x3f5a5ba0,0x3f5df6be,0x3f61668a
.long 0x3f64aa59,0x3f6816a8,0x3f6b4b0c,0x3f6e46be,0x3f6ff573,0x3f72d4eb,0x3f756d97,0x3f77beb7
.long 0x3f7853f8,0x3f7a7302,0x3f7c3b28,0x3f7dabcc,0x3f7dabcc,0x3f7ed7d4,0x3f7f9c18,0x3f7ff84a
.long 0x3f7fec43,0x3f7ff4e6,0x3f7f84ab,0x3f7e9bc9,0x3f7f0e58,0x3f7dc68c,0x3f7bf531,0x3f799b43
.long 0x0,0x0,0x0,0x0,0x3dfab273,0x3e007745,0x3e039502,0x3e06b26e
.long 0x3e78cfcc,0x3e7ee6e1,0x3e827dc0,0x3e8586ce,0x3eb8442a,0x3ebca7af,0x3ec1071e,0x3ec5625c
.long 0x3ef15aea,0x3ef6e0cb,0x3efc5d27,0x3f00e7e4,0x3f13682a,0x3f16999f,0x3f19c200,0x3f1ce11f
.long 0x3f2beb4a,0x3f2f61a5,0x3f32c8c9,0x3f36206c,0x3f41d870,0x3f456439,0x3f48d8b3,0x3f4c3578
.long 0x3f54db31,0x3f584853,0x3f5b941a,0x3f5ebe05,0x3f64aa59,0x3f67c187,0x3f6aab7b,0x3f6d67a1
.long 0x3f710908,0x3f73913f,0x3f75dec6,0x3f77f110,0x3f79c79d,0x3f7b87b2,0x3f7cfe73,0x3f7e2b72
.long 0x3f7ec46d,0x3f7f84ab,0x3f7fec43,0x3f7ffb11,0x3f7fec43,0x3f7f7808,0x3f7e9bc9,0x3f7d57de
.long 0x3f7d3aac,0x3f7b61fc,0x3f791298,0x3f764d97,0x3f76ba07,0x3f73530e,0x3f6f6830,0x3f6afb8c
.long 0x0,0x0,0x0,0x0,0x3e09cf86,0x3e0cec4a,0x3e1008b7,0x3e1324ca
.long 0x3e888e93,0x3e8b9507,0x3e8e9a22,0x3e919ddd,0x3ec9b953,0x3ece0bea,0x3ed25a09,0x3ed6a399
.long 0x3f039c3d,0x3f064b82,0x3f08f59b,0x3f0b9a6b,0x3f1ff6cb,0x3f2302d3,0x3f26050a,0x3f28fd41
.long 0x3f396842,0x3f3ca003,0x3f3fc767,0x3f42de29,0x3f4f7a1f,0x3f52a649,0x3f55b993,0x3f58b3a1
.long 0x3f61c598,0x3f64aa59,0x3f676bd8,0x3f6a09a7,0x3f6ff573,0x3f725470,0x3f748422,0x3f76841b
.long 0x3f79c79d,0x3f7b61fc,0x3f7cbfc9,0x3f7de0b1,0x3f7f0e58,0x3f7fa6e3,0x3f7ff4e6,0x3f7ff84a
.long 0x3f7fb10f,0x3f7f0e58,0x3f7e1324,0x3f7cbfc9,0x3f7baccd,0x3f799b43,0x3f772417,0x3f74484b
.long 0x3f731447,0x3f6f6830,0x3f6b4b0c,0x3f66becc,0x3f660f88,0x3f60a6cf,0x3f5ac450,0x3f546b3b
.long 0x3f800000,0x3f7fb10f,0x3f7ec46d,0x3f7d3aac,0x3f7ec46d,0x3f7d1cdd,0x3f7ac516,0x3f77beb7
.long 0x3f7b14be,0x3f77f110,0x3f740bdd,0x3f6f6830,0x3f74fa0b,0x3f703b37,0x3f6aab7b,0x3f644fac
.long 0x3f6c835e,0x3f660f88,0x3f5ebe05,0x3f5695e5,0x3f61c598,0x3f5988ad,0x3f5064af,0x3f466354
.long 0x3f54db31,0x3f4ac77f,0x3f3fc767,0x3f33e7bc,0x3f45e403,0x3f39f2ac,0x3f2d1469,0x3f1f599f
.long 0x3f3504f3,0x3f273656,0x3f187fc0,0x3f08f59b,0x3f226799,0x3f12c39a,0x3f0242b1,0x3ee1fb6a
.long 0x3f0e39da,0x3ef9a02d,0x3ed53641,0x3eaf713a,0x3ef15aea,0x3ecb2aae,0x3ea395c5,0x3e75c35a
.long 0x3ec3ef15,0x3e9aa086,0x3e605c13,0x3e09cf86,0x3e94a031,0x3e5101f1,0x3dee3876,0x3ce22a7a
.long 0x3e47c5c2,0x3dd53db9,0x3c490e90,0xbda3308c,0x3dc8bd36,0x3b490fc6,0xbdbc3ac3,0xbe3e853e
.long 0x3f7b14be,0x3f7853f8,0x3f74fa0b,0x3f710908,0x3f740bdd,0x3f6faf1b,0x3f6aab7b,0x3f650479
.long 0x3f6a09a7,0x3f63f473,0x3f5d2d53,0x3f55b993,0x3f5d2d53,0x3f554aa4,0x3f4cae79,0x3f436051
.long 0x3f4d9f02,0x3f43e200,0x3f396842,0x3f2e3bde,0x3f3b8f3b,0x3f2ff3e6,0x3f239da9,0x3f16999f
.long 0x3f273656,0x3f19c200,0x3f0b9a6b,0x3ef9a02d,0x3f10d3cd,0x3f019573,0x3ee363fa,0x3ec27b55
.long 0x3ef15aea,0x3ecf7bca,0x3eac7cd4,0x3e888e93,0x3ebe1d4a,0x3e9920fe,0x3e667c66,0x3e195be0
.long 0x3e888e93,0x3e419b37,0x3de1bc2e,0x3cfb49ba,0x3e22abb6,0x3d9cecf9,0xbbc90f88,0xbdb5f8da
.long 0x3d48fb30,0xbd16c32c,0xbdfab273,0xbe541501,0xbd7b2b74,0xbe195be0,0xbe72b651,0xbea5129f
.long 0xbe2f10a2,0xbe8586ce,0xbeb263ef,0xbeddbe79,0xbe8e9a22,0xbebca7af,0xbee900b7,0xbf099f4e
.long 0x3f6c835e,0x3f676bd8,0x3f61c598,0x3f5b941a,0x3f5ebe05,0x3f57dc7f,0x3f5064af,0x3f485bca
.long 0x3f4d9f02,0x3f44e3f5,0x3f3b8f3b,0x3f31a81d,0x3f396842,0x3f2ecef7,0x3f239da9,0x3f17de12
.long 0x3f226799,0x3f15f6d9,0x3f08f59b,0x3ef6e0cb,0x3f08f59b,0x3ef58035,0x3ed8106b,0x3eb9bb1e
.long 0x3edae880,0x3ebb31a0,0x3e9aa086,0x3e72b651,0x3ea09ae5,0x3e7bdba4,0x3e354098,0x3ddb7d37
.long 0x3e47c5c2,0x3dfab273,0x3d48fb30,0xbcc90ab0,0x3d96a905,0xbb490fc6,0xbda3308c,0xbe1f917b
.long 0xbd48fb30,0xbe039502,0xbe541501,0xbe919ddd,0xbe2f10a2,0xbe80f8c0,0xbea986c4,0xbed0eb2a
.long 0xbe94a031,0xbebe1d4a,0xbee63375,0xbf064b82,0xbecf7bca,0xbef840c8,0xbf0f8784,0xbf21cbfb
.long 0xbf039c3d,0xbf173c07,0xbf299415,0xbf3a7ca4,0xbf1d7fd1,0xbf2ff3e6,0xbf40d0da,0xbf4fefa8
.long 0x3f54db31,0x3f4d9f02,0x3f45e403,0x3f3daef9,0x3f3fc767,0x3f36ad7f,0x3f2d1469,0x3f2302d3
.long 0x3f273656,0x3f1c420c,0x3f10d3cd,0x3f04f484,0x3f0b9a6b,0x3efdbabb,0x3ee363fa,0x3ec8477c
.long 0x3edae880,0x3ebe1d4a,0x3ea09ae5,0x3e827dc0,0x3e9aa086,0x3e75c35a,0x3e354098,0x3de7fa9a
.long 0x3e2f10a2,0x3dd53db9,0x3d16c32c,0xbcfb49ba,0x3d16c32c,0xbd0a342f,0xbdd53db9,0xbe3228d4
.long 0xbdc8bd36,0xbe2f10a2,0xbe78cfcc,0xbea09ae5,0xbe6c9a7f,0xbe9c1faf,0xbec1071e,0xbee4cbfe
.long 0xbeb8442a,0xbeddbe79,0xbf00e7e4,0xbf121eb0,0xbef6e0cb,0xbf0d9281,0xbf1ebc12,0xbf2ecef7
.long 0xbf187fc0,0xbf299415,0xbf396842,0xbf47de65,0xbf32c8c9,0xbf425b89,0xbf5064af,0xbf5cc7d1
.long 0xbf49d112,0xbf577026,0xbf633c5a,0xbf6d1c1d,0xbf5d2d53,0xbf686b39,0xbf718f57,0xbf788486
.long 0x3f800000,0x3f7d3aac,0x3f74fa0b,0x3f676bd8,0x3f800000,0x3f7d1cdd,0x3f748422,0x3f666771
.long 0x3f800000,0x3f7cfe73,0x3f740bdd,0x3f655e0b,0x3f800000,0x3f7cdf6c,0x3f73913f,0x3f644fac
.long 0x3f800000,0x3f7cbfc9,0x3f731447,0x3f633c5a,0x3f800000,0x3f7c9f8a,0x3f7294f8,0x3f62241a
.long 0x3f800000,0x3f7c7eb0,0x3f721352,0x3f6106f2,0x3f800000,0x3f7c5d3a,0x3f718f57,0x3f5fe4e9
.long 0x3f800000,0x3f7c3b28,0x3f710908,0x3f5ebe05,0x3f800000,0x3f7c187a,0x3f708066,0x3f5d924d
.long 0x3f800000,0x3f7bf531,0x3f6ff573,0x3f5c61c7,0x3f800000,0x3f7bd14d,0x3f6f6830,0x3f5b2c79
.long 0x3f800000,0x3f7baccd,0x3f6ed89e,0x3f59f26a,0x3f800000,0x3f7b87b2,0x3f6e46be,0x3f58b3a1
.long 0x3f800000,0x3f7b61fc,0x3f6db293,0x3f577026,0x3f800000,0x3f7b3bab,0x3f6d1c1d,0x3f5627fe
.long 0x3f54db31,0x3f3daef9,0x3f226799,0x3f039c3d,0x3f531849,0x3f3b0629,0x3f1ebc12,0x3efdbabb
.long 0x3f514d3d,0x3f385216,0x3f1b02c6,0x3ef41f07,0x3f4f7a1f,0x3f3592e7,0x3f173c07,0x3eea6681
.long 0x3f4d9f02,0x3f32c8c9,0x3f13682a,0x3ee0924f,0x3f4bbbf8,0x3f2ff3e6,0x3f0f8784,0x3ed6a399
.long 0x3f49d112,0x3f2d1469,0x3f0b9a6b,0x3ecc9b8b,0x3f47de65,0x3f2a2a80,0x3f07a136,0x3ec27b55
.long 0x3f45e403,0x3f273656,0x3f039c3d,0x3eb8442a,0x3f43e200,0x3f24381a,0x3eff17b2,0x3eadf73c
.long 0x3f41d870,0x3f212ff9,0x3ef6e0cb,0x3ea395c5,0x3f3fc767,0x3f1e1e22,0x3eee9479,0x3e9920fe
.long 0x3f3daef9,0x3f1b02c6,0x3ee63375,0x3e8e9a22,0x3f3b8f3b,0x3f17de12,0x3eddbe79,0x3e840270
.long 0x3f396842,0x3f14b039,0x3ed53641,0x3e72b651,0x3f373a23,0x3f11796b,0x3ecc9b8b,0x3e5d4b1a
.long 0x3ec3ef15,0x3e78cfcc,0x3dc8bd36,0xbd48fb30,0x3eb8442a,0x3e5d4b1a,0x3d8a200a,0xbda973ba
.long 0x3eac7cd4,0x3e419b37,0x3d16c32c,0xbdee3876,0x3ea09ae5,0x3e25c58c,0x3bc90f88,0xbe195be0
.long 0x3e94a031,0x3e09cf86,0xbcc90ab0,0xbe3b6ecf,0x3e888e93,0x3ddb7d37,0xbd621469,0xbe5d4b1a
.long 0x3e78cfcc,0x3da3308c,0xbdafb680,0xbe7ee6e1,0x3e605c13,0x3d55880e,0xbdee3876,0xbe901c2c
.long 0x3e47c5c2,0x3cc90ab0,0xbe164083,0xbea09ae5,0x3e2f10a2,0xbb490fc6,0xbe354098,0xbeb0eacb
.long 0x3e164083,0xbcfb49ba,0xbe541501,0xbec1071e,0x3dfab273,0xbd6ea038,0xbe72b651,0xbed0eb2a
.long 0x3dc8bd36,0xbdafb680,0xbe888e93,0xbee0924f,0x3d96a905,0xbde7fa9a,0xbe97a117,0xbeeff7fb
.long 0x3d48fb30,0xbe1008b7,0xbea68f12,0xbeff17b2,0x3cc90ab0,0xbe2bf804,0xbeb554ec,0xbf06f686
.long 0xbe47c5c2,0xbeac7cd4,0xbef15aea,0xbf187fc0,0xbe6c9a7f,0xbebf926f,0xbf0242b1,0xbf21cbfb
.long 0xbe888e93,0xbed25a09,0xbf0b9a6b,0xbf2ac082,0xbe9aa086,0xbee4cbfe,0xbf14b039,0xbf33587a
.long 0xbeac7cd4,0xbef6e0cb,0xbf1d7fd1,0xbf3b8f3b,0xbebe1d4a,0xbf044889,0xbf26050a,0xbf436051
.long 0xbecf7bca,0xbf0cead0,0xbf2e3bde,0xbf4ac77f,0xbee0924f,0xbf1553b7,0xbf36206c,0xbf51c0c2
.long 0xbef15aea,0xbf1d7fd1,0xbf3daef9,0xbf584853,0xbf00e7e4,0xbf256bcb,0xbf44e3f5,0xbf5e5aa6
.long 0xbf08f59b,0xbf2d1469,0xbf4bbbf8,0xbf63f473,0xbf10d3cd,0xbf34768f,0xbf5233c6,0xbf6912ae
.long 0xbf187fc0,0xbf3b8f3b,0xbf584853,0xbf6db293,0xbf1ff6cb,0xbf425b89,0xbf5df6be,0xbf71d19f
.long 0xbf273656,0xbf48d8b3,0xbf633c5a,0xbf756d97,0xbf2e3bde,0xbf4f0417,0xbf6816a8,0xbf788486
.long 0xbf3504f3,0xbf4d9f02,0xbf61c598,0xbf710908,0xbf3daef9,0xbf554aa4,0xbf6816a8,0xbf75a67b
.long 0xbf45e403,0xbf5c61c7,0xbf6db293,0xbf796e4e,0xbf4d9f02,0xbf62df7b,0xbf7294f8,0xbf7c5d3a
.long 0xbf54db31,0xbf68bf3c,0xbf76ba07,0xbf7e70b0,0xbf5b941a,0xbf6dfcf2,0xbf7a1e84,0xbf7fa6e3
.long 0xbf61c598,0xbf7294f8,0xbf7cbfc9,0xbf7ffec4,0xbf676bd8,0xbf76841b,0xbf7e9bc9,0xbf7f7808
.long 0xbf6c835e,0xbf79c79d,0xbf7fb10f,0xbf7e1324,0xbf710908,0xbf7c5d3a,0xbf7ffec4,0xbf7bd14d
.long 0xbf74fa0b,0xbf7e4323,0xbf7f84ab,0xbf78b47b,0xbf7853f8,0xbf7f7808,0xbf7e4323,0xbf74bf62
.long 0xbf7b14be,0xbf7ffb11,0xbf7c3b28,0xbf6ff573,0xbf7d3aac,0xbf7fcbe2,0xbf796e4e,0xbf6a5ad9
.long 0xbf7ec46d,0xbf7eea9d,0xbf75dec6,0xbf63f473,0xbf7fb10f,0xbf7d57de,0xbf718f57,0xbf5cc7d1
.long 0xbf7b14be,0xbf7fb10f,0xbf7ec46d,0xbf7853f8,0xbf7dabcc,0xbf7ff84a,0xbf7c7eb0,0xbf73530e
.long 0xbf7f4e6d,0xbf7f2f9d,0xbf791298,0xbf6d1c1d,0xbf7ffb11,0xbf7d57de,0xbf748422,0xbf65b710
.long 0xbf7fb10f,0xbf7a7302,0xbf6ed89e,0xbf5d2d53,0xbf7e70b0,0xbf76841b,0xbf6816a8,0xbf5389c7
.long 0xbf7c3b28,0xbf718f57,0xbf604621,0xbf48d8b3,0xbf791298,0xbf6b99fb,0xbf577026,0xbf3d27b8
.long 0xbf74fa0b,0xbf64aa59,0xbf4d9f02,0xbf3085bb,0xbf6ff573,0xbf5cc7d1,0xbf42de29,0xbf2302d3
.long 0xbf6a09a7,0xbf53fac3,0xbf373a23,0xbf14b039,0xbf633c5a,0xbf4a4c87,0xbf2ac082,0xbf05a02c
.long 0xbf5b941a,0xbf3fc767,0xbf1d7fd1,0xbeebcbbb,0xbf531849,0xbf34768f,0xbf0f8784,0xbecb2aae
.long 0xbf49d112,0xbf286605,0xbf00e7e4,0xbea986c4,0xbf3fc767,0xbf1ba299,0xbee363fa,0xbe870ada
.long 0xbf6c835e,0xbf5b941a,0xbf45e403,0xbf2beb4a,0xbf64aa59,0xbf50d937,0xbf385216,0xbf1ba299
.long 0xbf5b941a,0xbf44e3f5,0xbf299415,0xbf0a48ad,0xbf514d3d,0xbf37c655,0xbf19c200,0xbeeff7fb
.long 0xbf45e403,0xbf299415,0xbf08f59b,0xbec9b953,0xbf396842,0xbf1a6293,0xbeee9479,0xbea21887
.long 0xbf2beb4a,0xbf0a48ad,0xbec9b953,0xbe72b651,0xbf1d7fd1,0xbef2bd43,0xbea395c5,0xbe1f917b
.long 0xbf0e39da,0xbecf7bca,0xbe78cfcc,0xbd96a905,0xbefc5d27,0xbeab0201,0xbe28defc,0x3c16cb58
.long 0xbedae880,0xbe8586ce,0xbdafb680,0x3dbc3ac3,0xbeb8442a,0xbe3e853e,0xbbc90f88,0x3e3228d4
.long 0xbe94a031,0xbde1bc2e,0x3d96a905,0x3e827dc0,0xbe605c13,0xbd0a342f,0x3e1c76de,0x3eab0201
.long 0xbe164083,0x3d2fe007,0x3e6c9a7f,0x3ed25a09,0xbd96a905,0x3df475c0,0x3e9d9e78,0x3ef840c8
.long 0xbf0e39da,0xbedae880,0xbe94a031,0xbe164083,0xbef6e0cb,0xbeb0eacb,0xbe4dee60,0xbd55880e
.long 0xbecf7bca,0xbe8586ce,0xbde1bc2e,0x3d2fe007,0xbea68f12,0xbe3228d4,0xbc96c9b6,0x3e0cec4a
.long 0xbe78cfcc,0xbdafb680,0x3d96a905,0x3e6c9a7f,0xbe22abb6,0x3b490fc6,0x3e28defc,0x3ea5129f
.long 0xbd96a905,0x3dbc3ac3,0x3e827dc0,0x3ed25a09,0x3c490e90,0x3e3857ec,0x3eaf713a,0x3efdbabb
.long 0x3dc8bd36,0x3e888e93,0x3edae880,0x3f13682a,0x3e3b6ecf,0x3eb3dca5,0x3f0242b1,0x3f269de3
.long 0x3e888e93,0x3eddbe79,0x3f15f6d9,0x3f385216,0x3eb263ef,0x3f02ef9f,0x3f286605,0x3f485bca
.long 0x3edae880,0x3f15f6d9,0x3f396842,0x3f5695e5,0x3f00e7e4,0x3f27ce61,0x3f48d8b3,0x3f62df7b
.long 0x3f13682a,0x3f385216,0x3f5695e5,0x3f6d1c1d,0x3f24d225,0x3f476085,0x3f628210,0x3f75341d
.long 0x0,0x3e164083,0x3e94a031,0x3edae880,0x0,0x3e195be0,0x3e97a117,0x3edf28a9
.long 0x0,0x3e1c76de,0x3e9aa086,0x3ee363fa,0x0,0x3e1f917b,0x3e9d9e78,0x3ee79a5d
.long 0x0,0x3e22abb6,0x3ea09ae5,0x3eebcbbb,0x0,0x3e25c58c,0x3ea395c5,0x3eeff7fb
.long 0x0,0x3e28defc,0x3ea68f12,0x3ef41f07,0x0,0x3e2bf804,0x3ea986c4,0x3ef840c8
.long 0x0,0x3e2f10a2,0x3eac7cd4,0x3efc5d27,0x0,0x3e3228d4,0x3eaf713a,0x3f003a06
.long 0x0,0x3e354098,0x3eb263ef,0x3f0242b1,0x0,0x3e3857ec,0x3eb554ec,0x3f044889
.long 0x0,0x3e3b6ecf,0x3eb8442a,0x3f064b82,0x0,0x3e3e853e,0x3ebb31a0,0x3f084b92
.long 0x0,0x3e419b37,0x3ebe1d4a,0x3f0a48ad,0x0,0x3e44b0b9,0x3ec1071e,0x3f0c42c9
.long 0x3f0e39da,0x3f2beb4a,0x3f45e403,0x3f5b941a,0x3f10d3cd,0x3f2ecef7,0x3f48d8b3,0x3f5e5aa6
.long 0x3f13682a,0x3f31a81d,0x3f4bbbf8,0x3f6106f2,0x3f15f6d9,0x3f34768f,0x3f4e8d90,0x3f6398ac
.long 0x3f187fc0,0x3f373a23,0x3f514d3d,0x3f660f88,0x3f1b02c6,0x3f39f2ac,0x3f53fac3,0x3f686b39
.long 0x3f1d7fd1,0x3f3ca003,0x3f5695e5,0x3f6aab7b,0x3f1ff6cb,0x3f3f41fc,0x3f591e6a,0x3f6cd007
.long 0x3f226799,0x3f41d870,0x3f5b941a,0x3f6ed89e,0x3f24d225,0x3f446337,0x3f5df6be,0x3f70c501
.long 0x3f273656,0x3f46e22a,0x3f604621,0x3f7294f8,0x3f299415,0x3f495521,0x3f628210,0x3f74484b
.long 0x3f2beb4a,0x3f4bbbf8,0x3f64aa59,0x3f75dec6,0x3f2e3bde,0x3f4e1689,0x3f66becc,0x3f77583a
.long 0x3f3085bb,0x3f5064af,0x3f68bf3c,0x3f78b47b,0x3f32c8c9,0x3f52a649,0x3f6aab7b,0x3f79f35e
.long 0x3f6c835e,0x3f7853f8,0x3f7ec46d,0x3f7fb10f,0x3f6ed89e,0x3f79f35e,0x3f7f6ac7,0x3f7f1f49
.long 0x3f710908,0x3f7b61fc,0x3f7fd397,0x3f7e4323,0x3f731447,0x3f7c9f8a,0x3f7ffec4,0x3f7d1cdd
.long 0x3f74fa0b,0x3f7dabcc,0x3f7fec43,0x3f7baccd,0x3f76ba07,0x3f7e868b,0x3f7f9c18,0x3f79f35e
.long 0x3f7853f8,0x3f7f2f9d,0x3f7f0e58,0x3f77f110,0x3f79c79d,0x3f7fa6e3,0x3f7e4323,0x3f75a67b
.long 0x3f7b14be,0x3f7fec43,0x3f7d3aac,0x3f731447,0x3f7c3b28,0x3f7fffb1,0x3f7bf531,0x3f703b37
.long 0x3f7d3aac,0x3f7fe129,0x3f7a7302,0x3f6d1c1d,0x3f7e1324,0x3f7f90b1,0x3f78b47b,0x3f69b7e4
.long 0x3f7ec46d,0x3f7f0e58,0x3f76ba07,0x3f660f88,0x3f7f4e6d,0x3f7e5a38,0x3f748422,0x3f62241a
.long 0x3f7fb10f,0x3f7d7474,0x3f721352,0x3f5df6be,0x3f7fec43,0x3f7c5d3a,0x3f6f6830,0x3f5988ad
.long 0x3f7b14be,0x3f710908,0x3f61c598,0x3f4d9f02,0x3f791298,0x3f6d67a1,0x3f5c61c7,0x3f466354
.long 0x3f76ba07,0x3f696591,0x3f5695e5,0x3f3ebc1b,0x3f740bdd,0x3f650479,0x3f5064af,0x3f36ad7f
.long 0x3f710908,0x3f604621,0x3f49d112,0x3f2e3bde,0x3f6db293,0x3f5b2c79,0x3f42de29,0x3f256bcb
.long 0x3f6a09a7,0x3f55b993,0x3f3b8f3b,0x3f1c420c,0x3f660f88,0x3f4fefa8,0x3f33e7bc,0x3f12c39a
.long 0x3f61c598,0x3f49d112,0x3f2beb4a,0x3f08f59b,0x3f5d2d53,0x3f436051,0x3f239da9,0x3efdbabb
.long 0x3f584853,0x3f3ca003,0x3f1b02c6,0x3ee900b7,0x3f531849,0x3f3592e7,0x3f121eb0,0x3ed3c867
.long 0x3f4d9f02,0x3f2e3bde,0x3f08f59b,0x3ebe1d4a,0x3f47de65,0x3f269de3,0x3eff17b2,0x3ea80b1f
.long 0x3f41d870,0x3f1ebc12,0x3eebcbbb,0x3e919ddd,0x3f3b8f3b,0x3f16999f,0x3ed8106b,0x3e75c35a
.long 0x3f3504f3,0x3f187fc0,0x3ef15aea,0x3eac7cd4,0x3f2beb4a,0x3f0d9281,0x3ed8106b,0x3e901c2c
.long 0x3f226799,0x3f0242b1,0x3ebe1d4a,0x3e667c66,0x3f187fc0,0x3eed3063,0x3ea395c5,0x3e2bf804
.long 0x3f0e39da,0x3ed53641,0x3e888e93,0x3de1bc2e,0x3f039c3d,0x3ebca7af,0x3e5a3997,0x3d55880e
.long 0x3ef15aea,0x3ea395c5,0x3e22abb6,0xbbc90f88,0x3edae880,0x3e8a11f7,0x3dd53db9,0xbd83db0a
.long 0x3ec3ef15,0x3e605c13,0x3d48fb30,0xbdfab273,0x3eac7cd4,0x3e2bf804,0xbbc90f88,0xbe3857ec
.long 0x3e94a031,0x3dee3876,0xbd7b2b74,0xbe72b651,0x3e78cfcc,0x3d83db0a,0xbdee3876,0xbe9620d2
.long 0x3e47c5c2,0x3c490e90,0xbe2f10a2,0xbeb263ef,0x3e164083,0xbd2351cb,0xbe667c66,0xbece0bea
.long 0x3dc8bd36,0xbdbc3ac3,0xbe8e9a22,0xbee900b7,0x3d48fb30,0xbe1324ca,0xbea986c4,0xbf019573
.long 0x3e47c5c2,0x3d48fb30,0xbdc8bd36,0xbe78cfcc,0x3e09cf86,0xbc7b514b,0xbe28defc,0xbe9f1cdf
.long 0x3d96a905,0xbda3308c,0xbe6c9a7f,0xbec1071e,0x3c490e90,0xbe1324ca,0xbe97a117,0xbee1fb6a
.long 0xbd48fb30,0xbe541501,0xbeb8442a,0xbf00e7e4,0xbde1bc2e,0xbe8a11f7,0xbed8106b,0xbf102dd5
.long 0xbe2f10a2,0xbea986c4,0xbef6e0cb,0xbf1ebc12,0xbe6c9a7f,0xbec8477c,0xbf0a48ad,0xbf2c800f
.long 0xbe94a031,0xbee63375,0xbf187fc0,0xbf396842,0xbeb263ef,0xbf019573,0xbf26050a,0xbf456439
.long 0xbecf7bca,0xbf0f8784,0xbf32c8c9,0xbf5064af,0xbeebcbbb,0xbf1ce11f,0xbf3ebc1b,0xbf5a5ba0
.long 0xbf039c3d,0xbf299415,0xbf49d112,0xbf633c5a,0xbf10d3cd,0xbf3592e7,0xbf53fac3,0xbf6afb8c
.long 0xbf1d7fd1,0xbf40d0da,0xbf5d2d53,0xbf718f57,0xbf299415,0xbf4b41fa,0xbf655e0b,0xbf76ef5b
.long 0xbec3ef15,0xbf039c3d,0xbf226799,0xbf3daef9,0xbee63375,0xbf140c5f,0xbf31a81d,0xbf4b41fa
.long 0xbf039c3d,0xbf239da9,0xbf3fc767,0xbf577026,0xbf13682a,0xbf3238aa,0xbf4cae79,0xbf62241a
.long 0xbf226799,0xbf3fc767,0xbf584853,0xbf6b4b0c,0xbf3085bb,0xbf4c3578,0xbf628210,0xbf72d4eb
.long 0xbf3daef9,0xbf577026,0xbf6b4b0c,0xbf78b47b,0xbf49d112,0xbf61668a,0xbf7294f8,0xbf7cdf6c
.long 0xbf54db31,0xbf6a09a7,0xbf7853f8,0xbf7f4e6d,0xbf5ebe05,0xbf714c7a,0xbf7c7eb0,0xbf7ffd39
.long 0xbf676bd8,0xbf772417,0xbf7f0e58,0xbf7eea9d,0xbf6ed89e,0xbf7b87b2,0xbf7ffec4,0xbf7c187a
.long 0xbf74fa0b,0xbf7e70b0,0xbf7f4e6d,0xbf778bc5,0xbf79c79d,0xbf7fdaaf,0xbf7cfe73,0xbf714c7a
.long 0xbf7d3aac,0xbf7fc38f,0xbf791298,0xbf696591,0xbf7f4e6d,0xbf7e2b72,0xbf73913f,0xbf5fe4e9
.long 0xbf54db31,0xbf676bd8,0xbf74fa0b,0xbf7d3aac,0xbf604621,0xbf703b37,0xbf7ac516,0xbf7fa6e3
.long 0xbf6a09a7,0xbf772417,0xbf7e70b0,0xbf7fc38f,0xbf721352,0xbf7c187a,0xbf7ff4e6,0xbf7d906e
.long 0xbf7853f8,0xbf7f0e58,0xbf7f4e6d,0xbf791298,0xbf7cbfc9,0xbf7fffb1,0xbf7c7eb0,0xbf725470
.long 0xbf7f4e6d,0xbf7eea9d,0xbf778bc5,0xbf696591,0xbf7ffb11,0xbf7bd14d,0xbf708066,0xbf5e5aa6
.long 0xbf7ec46d,0xbf76ba07,0xbf676bd8,0xbf514d3d,0xbf7baccd,0xbf6faf1b,0xbf5c61c7,0xbf425b89
.long 0xbf76ba07,0xbf66becc,0xbf4f7a1f,0xbf31a81d,0xbf6ff573,0xbf5bfb34,0xbf40d0da,0xbf1f599f
.long 0xbf676bd8,0xbf4f7a1f,0xbf3085bb,0xbf0b9a6b,0xbf5d2d53,0xbf4154e1,0xbf1ebc12,0xbeed3063
.long 0xbf514d3d,0xbf31a81d,0xbf0b9a6b,0xbec1071e,0xbf43e200,0xbf209393,0xbeee9479,0xbe931f35
.long 0x3f800000,0x3f800000,0x3f800000,0x3f800000,0x3f7d3aac,0x3f7d1cdd,0x3f7cfe73,0x3f7cdf6c
.long 0x3f74fa0b,0x3f748422,0x3f740bdd,0x3f73913f,0x3f676bd8,0x3f666771,0x3f655e0b,0x3f644fac
.long 0x3f54db31,0x3f531849,0x3f514d3d,0x3f4f7a1f,0x3f3daef9,0x3f3b0629,0x3f385216,0x3f3592e7
.long 0x3f226799,0x3f1ebc12,0x3f1b02c6,0x3f173c07,0x3f039c3d,0x3efdbabb,0x3ef41f07,0x3eea6681
.long 0x3ec3ef15,0x3eb8442a,0x3eac7cd4,0x3ea09ae5,0x3e78cfcc,0x3e5d4b1a,0x3e419b37,0x3e25c58c
.long 0x3dc8bd36,0x3d8a200a,0x3d16c32c,0x3bc90f88,0xbd48fb30,0xbda973ba,0xbdee3876,0xbe195be0
.long 0xbe47c5c2,0xbe6c9a7f,0xbe888e93,0xbe9aa086,0xbeac7cd4,0xbebf926f,0xbed25a09,0xbee4cbfe
.long 0xbef15aea,0xbf0242b1,0xbf0b9a6b,0xbf14b039,0xbf187fc0,0xbf21cbfb,0xbf2ac082,0xbf33587a
.long 0x3f800000,0x3f800000,0x3f800000,0x3f800000,0x3f7cbfc9,0x3f7c9f8a,0x3f7c7eb0,0x3f7c5d3a
.long 0x3f731447,0x3f7294f8,0x3f721352,0x3f718f57,0x3f633c5a,0x3f62241a,0x3f6106f2,0x3f5fe4e9
.long 0x3f4d9f02,0x3f4bbbf8,0x3f49d112,0x3f47de65,0x3f32c8c9,0x3f2ff3e6,0x3f2d1469,0x3f2a2a80
.long 0x3f13682a,0x3f0f8784,0x3f0b9a6b,0x3f07a136,0x3ee0924f,0x3ed6a399,0x3ecc9b8b,0x3ec27b55
.long 0x3e94a031,0x3e888e93,0x3e78cfcc,0x3e605c13,0x3e09cf86,0x3ddb7d37,0x3da3308c,0x3d55880e
.long 0xbcc90ab0,0xbd621469,0xbdafb680,0xbdee3876,0xbe3b6ecf,0xbe5d4b1a,0xbe7ee6e1,0xbe901c2c
.long 0xbeac7cd4,0xbebe1d4a,0xbecf7bca,0xbee0924f,0xbef6e0cb,0xbf044889,0xbf0cead0,0xbf1553b7
.long 0xbf1d7fd1,0xbf26050a,0xbf2e3bde,0xbf36206c,0xbf3b8f3b,0xbf436051,0xbf4ac77f,0xbf51c0c2
.long 0x3f800000,0x3f800000,0x3f800000,0x3f800000,0x3f7c3b28,0x3f7c187a,0x3f7bf531,0x3f7bd14d
.long 0x3f710908,0x3f708066,0x3f6ff573,0x3f6f6830,0x3f5ebe05,0x3f5d924d,0x3f5c61c7,0x3f5b2c79
.long 0x3f45e403,0x3f43e200,0x3f41d870,0x3f3fc767,0x3f273656,0x3f24381a,0x3f212ff9,0x3f1e1e22
.long 0x3f039c3d,0x3eff17b2,0x3ef6e0cb,0x3eee9479,0x3eb8442a,0x3eadf73c,0x3ea395c5,0x3e9920fe
.long 0x3e47c5c2,0x3e2f10a2,0x3e164083,0x3dfab273,0x3cc90ab0,0xbb490fc6,0xbcfb49ba,0xbd6ea038
.long 0xbe164083,0xbe354098,0xbe541501,0xbe72b651,0xbea09ae5,0xbeb0eacb,0xbec1071e,0xbed0eb2a
.long 0xbef15aea,0xbf00e7e4,0xbf08f59b,0xbf10d3cd,0xbf1d7fd1,0xbf256bcb,0xbf2d1469,0xbf34768f
.long 0xbf3daef9,0xbf44e3f5,0xbf4bbbf8,0xbf5233c6,0xbf584853,0xbf5e5aa6,0xbf63f473,0xbf6912ae
.long 0x3f800000,0x3f800000,0x3f800000,0x3f800000,0x3f7baccd,0x3f7b87b2,0x3f7b61fc,0x3f7b3bab
.long 0x3f6ed89e,0x3f6e46be,0x3f6db293,0x3f6d1c1d,0x3f59f26a,0x3f58b3a1,0x3f577026,0x3f5627fe
.long 0x3f3daef9,0x3f3b8f3b,0x3f396842,0x3f373a23,0x3f1b02c6,0x3f17de12,0x3f14b039,0x3f11796b
.long 0x3ee63375,0x3eddbe79,0x3ed53641,0x3ecc9b8b,0x3e8e9a22,0x3e840270,0x3e72b651,0x3e5d4b1a
.long 0x3dc8bd36,0x3d96a905,0x3d48fb30,0x3cc90ab0,0xbdafb680,0xbde7fa9a,0xbe1008b7,0xbe2bf804
.long 0xbe888e93,0xbe97a117,0xbea68f12,0xbeb554ec,0xbee0924f,0xbeeff7fb,0xbeff17b2,0xbf06f686
.long 0xbf187fc0,0xbf1ff6cb,0xbf273656,0xbf2e3bde,0xbf3b8f3b,0xbf425b89,0xbf48d8b3,0xbf4f0417
.long 0xbf584853,0xbf5df6be,0xbf633c5a,0xbf6816a8,0xbf6db293,0xbf71d19f,0xbf756d97,0xbf788486
.long 0xbf3504f3,0xbf3daef9,0xbf45e403,0xbf4d9f02,0xbf4d9f02,0xbf554aa4,0xbf5c61c7,0xbf62df7b
.long 0xbf61c598,0xbf6816a8,0xbf6db293,0xbf7294f8,0xbf710908,0xbf75a67b,0xbf796e4e,0xbf7c5d3a
.long 0xbf7b14be,0xbf7dabcc,0xbf7f4e6d,0xbf7ffb11,0xbf7fb10f,0xbf7ff84a,0xbf7f2f9d,0xbf7d57de
.long 0xbf7ec46d,0xbf7c7eb0,0xbf791298,0xbf748422,0xbf7853f8,0xbf73530e,0xbf6d1c1d,0xbf65b710
.long 0xbf6c835e,0xbf64aa59,0xbf5b941a,0xbf514d3d,0xbf5b941a,0xbf50d937,0xbf44e3f5,0xbf37c655
.long 0xbf45e403,0xbf385216,0xbf299415,0xbf19c200,0xbf2beb4a,0xbf1ba299,0xbf0a48ad,0xbeeff7fb
.long 0xbf0e39da,0xbef6e0cb,0xbecf7bca,0xbea68f12,0xbedae880,0xbeb0eacb,0xbe8586ce,0xbe3228d4
.long 0xbe94a031,0xbe4dee60,0xbde1bc2e,0xbc96c9b6,0xbe164083,0xbd55880e,0x3d2fe007,0x3e0cec4a
.long 0xbf54db31,0xbf5b941a,0xbf61c598,0xbf676bd8,0xbf68bf3c,0xbf6dfcf2,0xbf7294f8,0xbf76841b
.long 0xbf76ba07,0xbf7a1e84,0xbf7cbfc9,0xbf7e9bc9,0xbf7e70b0,0xbf7fa6e3,0xbf7ffec4,0xbf7f7808
.long 0xbf7fb10f,0xbf7e70b0,0xbf7c3b28,0xbf791298,0xbf7a7302,0xbf76841b,0xbf718f57,0xbf6b99fb
.long 0xbf6ed89e,0xbf6816a8,0xbf604621,0xbf577026,0xbf5d2d53,0xbf5389c7,0xbf48d8b3,0xbf3d27b8
.long 0xbf45e403,0xbf396842,0xbf2beb4a,0xbf1d7fd1,0xbf299415,0xbf1a6293,0xbf0a48ad,0xbef2bd43
.long 0xbf08f59b,0xbeee9479,0xbec9b953,0xbea395c5,0xbec9b953,0xbea21887,0xbe72b651,0xbe1f917b
.long 0xbe78cfcc,0xbe22abb6,0xbd96a905,0x3c490e90,0xbdafb680,0x3b490fc6,0x3dbc3ac3,0x3e3857ec
.long 0x3d96a905,0x3e28defc,0x3e827dc0,0x3eaf713a,0x3e6c9a7f,0x3ea5129f,0x3ed25a09,0x3efdbabb
.long 0xbf6c835e,0xbf710908,0xbf74fa0b,0xbf7853f8,0xbf79c79d,0xbf7c5d3a,0xbf7e4323,0xbf7f7808
.long 0xbf7fb10f,0xbf7ffec4,0xbf7f84ab,0xbf7e4323,0xbf7e1324,0xbf7bd14d,0xbf78b47b,0xbf74bf62
.long 0xbf74fa0b,0xbf6ff573,0xbf6a09a7,0xbf633c5a,0xbf64aa59,0xbf5cc7d1,0xbf53fac3,0xbf4a4c87
.long 0xbf4d9f02,0xbf42de29,0xbf373a23,0xbf2ac082,0xbf3085bb,0xbf2302d3,0xbf14b039,0xbf05a02c
.long 0xbf0e39da,0xbefc5d27,0xbedae880,0xbeb8442a,0xbecf7bca,0xbeab0201,0xbe8586ce,0xbe3e853e
.long 0xbe78cfcc,0xbe28defc,0xbdafb680,0xbbc90f88,0xbd96a905,0x3c16cb58,0x3dbc3ac3,0x3e3228d4
.long 0x3dc8bd36,0x3e3b6ecf,0x3e888e93,0x3eb263ef,0x3e888e93,0x3eb3dca5,0x3eddbe79,0x3f02ef9f
.long 0x3edae880,0x3f0242b1,0x3f15f6d9,0x3f286605,0x3f13682a,0x3f269de3,0x3f385216,0x3f485bca
.long 0xbf7b14be,0xbf7d3aac,0xbf7ec46d,0xbf7fb10f,0xbf7ffb11,0xbf7fcbe2,0xbf7eea9d,0xbf7d57de
.long 0xbf7c3b28,0xbf796e4e,0xbf75dec6,0xbf718f57,0xbf6ff573,0xbf6a5ad9,0xbf63f473,0xbf5cc7d1
.long 0xbf5b941a,0xbf531849,0xbf49d112,0xbf3fc767,0xbf3fc767,0xbf34768f,0xbf286605,0xbf1ba299
.long 0xbf1d7fd1,0xbf0f8784,0xbf00e7e4,0xbee363fa,0xbeebcbbb,0xbecb2aae,0xbea986c4,0xbe870ada
.long 0xbe94a031,0xbe605c13,0xbe164083,0xbd96a905,0xbde1bc2e,0xbd0a342f,0x3d2fe007,0x3df475c0
.long 0x3d96a905,0x3e1c76de,0x3e6c9a7f,0x3e9d9e78,0x3e827dc0,0x3eab0201,0x3ed25a09,0x3ef840c8
.long 0x3edae880,0x3f00e7e4,0x3f13682a,0x3f24d225,0x3f15f6d9,0x3f27ce61,0x3f385216,0x3f476085
.long 0x3f396842,0x3f48d8b3,0x3f5695e5,0x3f628210,0x3f5695e5,0x3f62df7b,0x3f6d1c1d,0x3f75341d
.long 0x0,0x0,0x0,0x0,0x3e164083,0x3e195be0,0x3e1c76de,0x3e1f917b
.long 0x3e94a031,0x3e97a117,0x3e9aa086,0x3e9d9e78,0x3edae880,0x3edf28a9,0x3ee363fa,0x3ee79a5d
.long 0x3f0e39da,0x3f10d3cd,0x3f13682a,0x3f15f6d9,0x3f2beb4a,0x3f2ecef7,0x3f31a81d,0x3f34768f
.long 0x3f45e403,0x3f48d8b3,0x3f4bbbf8,0x3f4e8d90,0x3f5b941a,0x3f5e5aa6,0x3f6106f2,0x3f6398ac
.long 0x3f6c835e,0x3f6ed89e,0x3f710908,0x3f731447,0x3f7853f8,0x3f79f35e,0x3f7b61fc,0x3f7c9f8a
.long 0x3f7ec46d,0x3f7f6ac7,0x3f7fd397,0x3f7ffec4,0x3f7fb10f,0x3f7f1f49,0x3f7e4323,0x3f7d1cdd
.long 0x3f7b14be,0x3f791298,0x3f76ba07,0x3f740bdd,0x3f710908,0x3f6d67a1,0x3f696591,0x3f650479
.long 0x3f61c598,0x3f5c61c7,0x3f5695e5,0x3f5064af,0x3f4d9f02,0x3f466354,0x3f3ebc1b,0x3f36ad7f
.long 0x0,0x0,0x0,0x0,0x3e22abb6,0x3e25c58c,0x3e28defc,0x3e2bf804
.long 0x3ea09ae5,0x3ea395c5,0x3ea68f12,0x3ea986c4,0x3eebcbbb,0x3eeff7fb,0x3ef41f07,0x3ef840c8
.long 0x3f187fc0,0x3f1b02c6,0x3f1d7fd1,0x3f1ff6cb,0x3f373a23,0x3f39f2ac,0x3f3ca003,0x3f3f41fc
.long 0x3f514d3d,0x3f53fac3,0x3f5695e5,0x3f591e6a,0x3f660f88,0x3f686b39,0x3f6aab7b,0x3f6cd007
.long 0x3f74fa0b,0x3f76ba07,0x3f7853f8,0x3f79c79d,0x3f7dabcc,0x3f7e868b,0x3f7f2f9d,0x3f7fa6e3
.long 0x3f7fec43,0x3f7f9c18,0x3f7f0e58,0x3f7e4323,0x3f7baccd,0x3f79f35e,0x3f77f110,0x3f75a67b
.long 0x3f710908,0x3f6db293,0x3f6a09a7,0x3f660f88,0x3f604621,0x3f5b2c79,0x3f55b993,0x3f4fefa8
.long 0x3f49d112,0x3f42de29,0x3f3b8f3b,0x3f33e7bc,0x3f2e3bde,0x3f256bcb,0x3f1c420c,0x3f12c39a
.long 0x0,0x0,0x0,0x0,0x3e2f10a2,0x3e3228d4,0x3e354098,0x3e3857ec
.long 0x3eac7cd4,0x3eaf713a,0x3eb263ef,0x3eb554ec,0x3efc5d27,0x3f003a06,0x3f0242b1,0x3f044889
.long 0x3f226799,0x3f24d225,0x3f273656,0x3f299415,0x3f41d870,0x3f446337,0x3f46e22a,0x3f495521
.long 0x3f5b941a,0x3f5df6be,0x3f604621,0x3f628210,0x3f6ed89e,0x3f70c501,0x3f7294f8,0x3f74484b
.long 0x3f7b14be,0x3f7c3b28,0x3f7d3aac,0x3f7e1324,0x3f7fec43,0x3f7fffb1,0x3f7fe129,0x3f7f90b1
.long 0x3f7d3aac,0x3f7bf531,0x3f7a7302,0x3f78b47b,0x3f731447,0x3f703b37,0x3f6d1c1d,0x3f69b7e4
.long 0x3f61c598,0x3f5d2d53,0x3f584853,0x3f531849,0x3f49d112,0x3f436051,0x3f3ca003,0x3f3592e7
.long 0x3f2beb4a,0x3f239da9,0x3f1b02c6,0x3f121eb0,0x3f08f59b,0x3efdbabb,0x3ee900b7,0x3ed3c867
.long 0x0,0x0,0x0,0x0,0x3e3b6ecf,0x3e3e853e,0x3e419b37,0x3e44b0b9
.long 0x3eb8442a,0x3ebb31a0,0x3ebe1d4a,0x3ec1071e,0x3f064b82,0x3f084b92,0x3f0a48ad,0x3f0c42c9
.long 0x3f2beb4a,0x3f2e3bde,0x3f3085bb,0x3f32c8c9,0x3f4bbbf8,0x3f4e1689,0x3f5064af,0x3f52a649
.long 0x3f64aa59,0x3f66becc,0x3f68bf3c,0x3f6aab7b,0x3f75dec6,0x3f77583a,0x3f78b47b,0x3f79f35e
.long 0x3f7ec46d,0x3f7f4e6d,0x3f7fb10f,0x3f7fec43,0x3f7f0e58,0x3f7e5a38,0x3f7d7474,0x3f7c5d3a
.long 0x3f76ba07,0x3f748422,0x3f721352,0x3f6f6830,0x3f660f88,0x3f62241a,0x3f5df6be,0x3f5988ad
.long 0x3f4d9f02,0x3f47de65,0x3f41d870,0x3f3b8f3b,0x3f2e3bde,0x3f269de3,0x3f1ebc12,0x3f16999f
.long 0x3f08f59b,0x3eff17b2,0x3eebcbbb,0x3ed8106b,0x3ebe1d4a,0x3ea80b1f,0x3e919ddd,0x3e75c35a
.long 0x3f3504f3,0x3f2beb4a,0x3f226799,0x3f187fc0,0x3f187fc0,0x3f0d9281,0x3f0242b1,0x3eed3063
.long 0x3ef15aea,0x3ed8106b,0x3ebe1d4a,0x3ea395c5,0x3eac7cd4,0x3e901c2c,0x3e667c66,0x3e2bf804
.long 0x3e47c5c2,0x3e09cf86,0x3d96a905,0x3c490e90,0x3d48fb30,0xbc7b514b,0xbda3308c,0xbe1324ca
.long 0xbdc8bd36,0xbe28defc,0xbe6c9a7f,0xbe97a117,0xbe78cfcc,0xbe9f1cdf,0xbec1071e,0xbee1fb6a
.long 0xbec3ef15,0xbee63375,0xbf039c3d,0xbf13682a,0xbf039c3d,0xbf140c5f,0xbf239da9,0xbf3238aa
.long 0xbf226799,0xbf31a81d,0xbf3fc767,0xbf4cae79,0xbf3daef9,0xbf4b41fa,0xbf577026,0xbf62241a
.long 0xbf54db31,0xbf604621,0xbf6a09a7,0xbf721352,0xbf676bd8,0xbf703b37,0xbf772417,0xbf7c187a
.long 0xbf74fa0b,0xbf7ac516,0xbf7e70b0,0xbf7ff4e6,0xbf7d3aac,0xbf7fa6e3,0xbf7fc38f,0xbf7d906e
.long 0x3f0e39da,0x3f039c3d,0x3ef15aea,0x3edae880,0x3ed53641,0x3ebca7af,0x3ea395c5,0x3e8a11f7
.long 0x3e888e93,0x3e5a3997,0x3e22abb6,0x3dd53db9,0x3de1bc2e,0x3d55880e,0xbbc90f88,0xbd83db0a
.long 0xbd48fb30,0xbde1bc2e,0xbe2f10a2,0xbe6c9a7f,0xbe541501,0xbe8a11f7,0xbea986c4,0xbec8477c
.long 0xbeb8442a,0xbed8106b,0xbef6e0cb,0xbf0a48ad,0xbf00e7e4,0xbf102dd5,0xbf1ebc12,0xbf2c800f
.long 0xbf226799,0xbf3085bb,0xbf3daef9,0xbf49d112,0xbf3fc767,0xbf4c3578,0xbf577026,0xbf61668a
.long 0xbf584853,0xbf628210,0xbf6b4b0c,0xbf7294f8,0xbf6b4b0c,0xbf72d4eb,0xbf78b47b,0xbf7cdf6c
.long 0xbf7853f8,0xbf7cbfc9,0xbf7f4e6d,0xbf7ffb11,0xbf7f0e58,0xbf7fffb1,0xbf7eea9d,0xbf7bd14d
.long 0xbf7f4e6d,0xbf7c7eb0,0xbf778bc5,0xbf708066,0xbf791298,0xbf725470,0xbf696591,0xbf5e5aa6
.long 0x3ec3ef15,0x3eac7cd4,0x3e94a031,0x3e78cfcc,0x3e605c13,0x3e2bf804,0x3dee3876,0x3d83db0a
.long 0x3d48fb30,0xbbc90f88,0xbd7b2b74,0xbdee3876,0xbdfab273,0xbe3857ec,0xbe72b651,0xbe9620d2
.long 0xbe94a031,0xbeb263ef,0xbecf7bca,0xbeebcbbb,0xbee63375,0xbf019573,0xbf0f8784,0xbf1ce11f
.long 0xbf187fc0,0xbf26050a,0xbf32c8c9,0xbf3ebc1b,0xbf396842,0xbf456439,0xbf5064af,0xbf5a5ba0
.long 0xbf54db31,0xbf5ebe05,0xbf676bd8,0xbf6ed89e,0xbf6a09a7,0xbf714c7a,0xbf772417,0xbf7b87b2
.long 0xbf7853f8,0xbf7c7eb0,0xbf7f0e58,0xbf7ffec4,0xbf7f4e6d,0xbf7ffd39,0xbf7eea9d,0xbf7c187a
.long 0xbf7ec46d,0xbf7baccd,0xbf76ba07,0xbf6ff573,0xbf76ba07,0xbf6faf1b,0xbf66becc,0xbf5bfb34
.long 0xbf676bd8,0xbf5c61c7,0xbf4f7a1f,0xbf40d0da,0xbf514d3d,0xbf425b89,0xbf31a81d,0xbf1f599f
.long 0x3e47c5c2,0x3e164083,0x3dc8bd36,0x3d48fb30,0x3c490e90,0xbd2351cb,0xbdbc3ac3,0xbe1324ca
.long 0xbe2f10a2,0xbe667c66,0xbe8e9a22,0xbea986c4,0xbeb263ef,0xbece0bea,0xbee900b7,0xbf019573
.long 0xbf039c3d,0xbf10d3cd,0xbf1d7fd1,0xbf299415,0xbf299415,0xbf3592e7,0xbf40d0da,0xbf4b41fa
.long 0xbf49d112,0xbf53fac3,0xbf5d2d53,0xbf655e0b,0xbf633c5a,0xbf6afb8c,0xbf718f57,0xbf76ef5b
.long 0xbf74fa0b,0xbf79c79d,0xbf7d3aac,0xbf7f4e6d,0xbf7e70b0,0xbf7fdaaf,0xbf7fc38f,0xbf7e2b72
.long 0xbf7f4e6d,0xbf7cfe73,0xbf791298,0xbf73913f,0xbf778bc5,0xbf714c7a,0xbf696591,0xbf5fe4e9
.long 0xbf676bd8,0xbf5d2d53,0xbf514d3d,0xbf43e200,0xbf4f7a1f,0xbf4154e1,0xbf31a81d,0xbf209393
.long 0xbf3085bb,0xbf1ebc12,0xbf0b9a6b,0xbeee9479,0xbf0b9a6b,0xbeed3063,0xbec1071e,0xbe931f35

.section .rodata,"a"
.p2align 6
.amdhsa_kernel sequential_preLN__spectral_gfnet__dense_activation_squared_relu__prompt_kernel
  .amdhsa_next_free_vgpr 512
  .amdhsa_next_free_sgpr 102
  .amdhsa_accum_offset 256
  .amdhsa_group_segment_fixed_size 0
  .amdhsa_kernarg_size 88
  .amdhsa_user_sgpr_count 2
  .amdhsa_user_sgpr_kernarg_segment_ptr 1
  .amdhsa_system_sgpr_workgroup_id_x 1
.end_amdhsa_kernel
```
